```python
import torch

def _softmax(x, axis=-1):
    return torch.softmax(x, dim=axis)
def _gelu(x):
    return torch.nn.functional.gelu(x, approximate="tanh")
def _silu(x):
    return torch.nn.functional.silu(x)
def _sigmoid(x):
    return torch.sigmoid(x)
def _layernorm(x, axis=-1, eps=1e-5):
    m = x.mean(dim=axis, keepdim=True)
    v = x.var(dim=axis, keepdim=True, unbiased=False)
    return (x - m) / torch.sqrt(v + eps)
def _scatter_add(tgt, idx, src, axis=0):
    return tgt.clone().index_add_(axis, idx, src)
def _segment_sum(src, seg, n):
    out = torch.zeros((n,) + src.shape[1:], dtype=src.dtype)
    return out.index_add_(0, seg, src)
def _pad(x, pw):
    flat = tuple(v for pair in reversed(pw) for v in pair)
    return torch.nn.functional.pad(x, flat)

kernel_name = 'parallel_sum__linear_kernel_hedgehog__glu_gated_geglu__prompt'

def setup_inputs():

    _w = (lambda a: (lambda t: t.to(torch.bfloat16) if t.is_floating_point() else t)(torch.as_tensor(a)))
    def _A_setup():
        B, S, D, H = 1, 2048, 448, 16
        Dh = D // H
        return {
            "x": _w((lambda *s: torch.randn(*s, dtype=torch.bfloat16) * 0.05)(B, S, D)),
            "wqkv": _w((lambda *s: torch.randn(*s, dtype=torch.bfloat16) * 0.2)(D, 3 * D)),
            "w_phi": _w((lambda *s: torch.randn(*s, dtype=torch.bfloat16) * 0.2)(H, Dh, Dh) * (Dh ** -0.5)),
            "wo": _w((lambda *s: torch.randn(*s, dtype=torch.bfloat16) * 0.05)(D, D)),
        }
    _A_in = _A_setup()

    def _B_setup():
        B, S, Dm, Df = 1, 2048, 448, 1792
        return {
            "x": _w((lambda *s: torch.randn(*s, dtype=torch.bfloat16) * 0.05)(B, S, Dm)),
            "w_gate": _w((lambda *s: torch.randn(*s, dtype=torch.bfloat16) * 0.4)(Dm, Df) * (Dm ** -0.5)),
            "w_up": _w((lambda *s: torch.randn(*s, dtype=torch.bfloat16) * 0.4)(Dm, Df) * (Dm ** -0.5)),
            "w_down": _w((lambda *s: torch.randn(*s, dtype=torch.bfloat16) * 0.4)(Df, Dm) * (Df ** -0.5)),
        }
    _B_in = _B_setup()

    return {
        "A_x": _A_in["x"],
        "A_wqkv": _A_in["wqkv"],
        "A_w_phi": _A_in["w_phi"],
        "A_wo": _A_in["wo"],
        "B_x": _B_in["x"],
        "B_w_gate": _B_in["w_gate"],
        "B_w_up": _B_in["w_up"],
        "B_w_down": _B_in["w_down"],
    }

def reference(A_x, A_wqkv, A_w_phi, A_wo, B_x, B_w_gate, B_w_up, B_w_down):
    def _A_ref(x, wqkv, w_phi, wo):
        B, S, D = x.shape
        H = 16; Dh = D // H
        qkv = (lambda x, *d: x.permute(*d))((x @ wqkv).reshape(B, S, 3, H, Dh), 2, 0, 3, 1, 4)
        q, k, v = qkv[0], qkv[1], qkv[2]
        pq = torch.einsum("bhsd,hdf->bhsf", q, w_phi)
        pk = torch.einsum("bhsd,hdf->bhsf", k, w_phi)
        phi_q = torch.concatenate([_softmax(pq, axis=-1), _softmax(-pq, axis=-1)], axis=-1)
        phi_k = torch.concatenate([_softmax(pk, axis=-1), _softmax(-pk, axis=-1)], axis=-1)
        kv = torch.einsum("bhsf,bhsd->bhfd", phi_k, v)
        z  = torch.einsum("bhsf->bhf", phi_k)
        num = torch.einsum("bhqf,bhfd->bhqd", phi_q, kv)
        den = torch.einsum("bhqf,bhf->bhq", phi_q, z)[..., None] + 1e-6
        o = num / den
        return (lambda x, *d: x.permute(*d))(o, 0, 2, 1, 3).reshape(B, S, D) @ wo

    def _B_ref(x, w_gate, w_up, w_down):
        g = torch.einsum("bsd,df->bsf", x, w_gate)
        u = torch.einsum("bsd,df->bsf", x, w_up)
        h = _gelu(g) * u
        return torch.einsum("bsf,fd->bsd", h, w_down)

    x = A_x
    xn = _layernorm(x, axis=-1)
    return x + _A_ref(xn, A_wqkv, A_w_phi, A_wo) + _B_ref(xn, B_w_gate, B_w_up, B_w_down)
```

```asm
; @launch grid=(256,1,1) block=(512,1,1) lds=163840
.amdgcn_target "amdgcn-amd-amdhsa--gfx950"
.text
.globl parallel_sum__linear_kernel_hedgehog__glu_gated_geglu__prompt_kernel
.p2align 8
.type parallel_sum__linear_kernel_hedgehog__glu_gated_geglu__prompt_kernel,@function
parallel_sum__linear_kernel_hedgehog__glu_gated_geglu__prompt_kernel:
    s_cmp_lt_u32 s2, 256
    s_cbranch_scc1 L_go
    s_endpgm
L_go:
    s_load_dwordx2 s[28:29], s[0:1], 0
    s_load_dwordx2 s[32:33], s[0:1], 8
    s_load_dwordx2 s[36:37], s[0:1], 40
    s_load_dwordx2 s[40:41], s[0:1], 48
    v_lshrrev_b32 v1, 6, v0
    s_getpc_b64 s[20:21]
L_pc:
    v_readfirstlane_b32 s15, v1
    s_lshr_b32 s75, s2, 3
    v_and_b32 v2, 0x1e0, v0
    v_add_u32 v2, s75, v2
    v_lshlrev_b32 v2, 7, v2
    v_min_u32 v2, L_codeend-L_pc-4, v2
    s_mov_b32 exec_lo, 1
    s_mov_b32 exec_hi, 1
    global_load_dword a0, v2, s[20:21]
    s_mov_b64 exec, -1
    s_and_b32 s26, s15, 3
    s_load_dwordx2 s[52:53], s[0:1], 80
    s_load_dwordx2 s[44:45], s[0:1], 56
    s_load_dwordx2 s[48:49], s[0:1], 24
    s_load_dwordx2 s[60:61], s[0:1], 72
    s_load_dwordx2 s[64:65], s[0:1], 16
    s_load_dwordx2 s[56:57], s[0:1], 64
    v_and_b32_e64 v0, 63, v0
    s_and_b32 s72, s2, 3
    s_and_b32 s27, s75, 3
    s_and_b32 s3, s2, 4
    s_or_b32 s27, s27, s3
    s_lshr_b32 s73, s75, 2
    s_lshl_b32 s3, s27, 2
    s_lshr_b32 s76, 0x5316420, s3
    s_and_b32 s76, s76, 7
    s_lshr_b32 s74, s73, 1
    s_lshl_b32 s3, s72, 2
    s_or_b32 s74, s74, s3
    s_mul_i32 s25, s72, 28
    v_lshrrev_b32 v1, 3, v0
    v_and_b32 v2, 7, v0
    v_lshlrev_b32 v112, 4, v0
    v_and_b32_e64 v14, 3, v0
    s_lshl_b32 s23, s27, 2
    s_add_u32 s23, s23, s26
    s_mul_i32 s10, s26, 24576
    s_mov_b32 s30, 1835008
    s_mov_b32 s31, 0x20000
    s_mov_b32 s34, 1204224
    s_mov_b32 s35, 0x20000
    s_mov_b32 s38, 1605632
    s_mov_b32 s39, 0x20000
    s_mov_b32 s42, 1605632
    s_mov_b32 s43, 0x20000
    s_mov_b32 s70, 1605632
    s_mov_b32 s71, 0x20000
    s_cmp_ge_u32 s15, 4
    s_cbranch_scc1 L_proF
    v_mul_u32_u24 v3, 896, v1
    v_lshrrev_b32 v4, 1, v1
    v_xor_b32 v5, v2, v4
    v_lshl_add_u32 v104, v5, 4, v3
    v_xor_b32_e64 v5, 4, v5
    v_lshl_add_u32 v105, v5, 4, v3
    v_add_u32 v105, 6144, v105
    v_add_u32 v106, 12288, v104
    v_add_u32 v107, 12288, v105
    s_mul_i32 s77, s23, 57344
    s_waitcnt lgkmcnt(0)
    s_lshl_b32 s3, s26, 5
    s_or_b32 s14, s3, s2
    s_cmp_ge_u32 s14, 32
    s_cbranch_scc1 L_nz
    s_mul_i32 s3, s2, 2048
    s_add_u32 s3, s3, 13631488
    v_mul_u32_u24 v6, 128, v0
    v_add_u32 v6, s3, v6
    v_mov_b32_e64 v7, 0
    s_mov_b64 exec, 0xffff
    global_store_dword v6, v7, s[52:53] sc1
    s_mov_b64 exec, -1
L_nz:
    s_add_u32 m0, s10, 0
    s_lshl_b32 s4, s76, 7
    s_add_u32 s4, s4, s77
    buffer_load_dwordx4 v104, s[28:31], s4 offen offset:0 lds
    buffer_load_dwordx4 v105, s[28:31], s4 offen offset:1024 lds
    buffer_load_dwordx4 v106, s[28:31], s4 offen offset:2048 lds
    buffer_load_dwordx4 v107, s[28:31], s4 offen offset:3072 lds
    s_add_u32 m0, s10, 4096
    s_add_u32 s4, s4, 28672
    buffer_load_dwordx4 v104, s[28:31], s4 offen offset:0 lds
    buffer_load_dwordx4 v105, s[28:31], s4 offen offset:1024 lds
    buffer_load_dwordx4 v106, s[28:31], s4 offen offset:2048 lds
    buffer_load_dwordx4 v107, s[28:31], s4 offen offset:3072 lds
    v_and_b32 v9, 15, v0
    v_lshrrev_b32 v10, 4, v0
    v_lshrrev_b32 v18, 1, v9
    v_lshlrev_b32 v12, 7, v9
    v_add_u32 v12, s10, v12
    v_xor_b32 v13, v10, v18
    v_lshl_add_u32 v96, v13, 4, v12
    v_xor_b32_e64 v97, 64, v96
    v_bfe_u32 v13, v0, 2, 2
    v_and_b32_e64 v15, 1, v10
    v_lshl_add_u32 v16, v10, 3, v13
    s_bitcmp1_b32 s73, 0
    s_cbranch_scc1 L_QA
    s_branch L_KVA
L_proF:
    v_lshrrev_b32 v6, 2, v0
    v_mul_u32_u24 v6, 2688, v6
    v_lshrrev_b32 v8, 4, v0
    v_and_b32 v8, 2, v8
    v_xor_b32 v8, v8, v14
    v_lshlrev_b32 v8, 4, v8
    v_min_u32 v8, 40, v8
    v_add_u32 v101, v6, v8
    s_mul_i32 s78, s26, 43008
    s_mul_i32 s3, s74, 56
    s_add_u32 s78, s78, s3
    s_lshl_b32 s11, s26, 10
    s_add_u32 s11, s11, 98304
    s_bitcmp1_b32 s73, 0
    s_cbranch_scc1 L_proFQ
    s_lshl_b32 s3, s74, 1
    s_lshr_b32 s3, 0xe1e1b4b4, s3
    s_and_b32 s3, s3, 3
    s_mul_i32 s3, s3, 3
    s_add_u32 s25, s25, s3
    s_add_u32 s25, s25, 16
    s_add_u32 s78, s78, 896
    s_and_b32 s3, s26, 1
    s_mul_i32 s79, s3, 114688
    s_lshl_b32 s13, s25, 5
    s_add_u32 s79, s79, s13
    s_mul_i32 s12, s3, 3072
    s_lshr_b32 s3, s26, 1
    s_mul_i32 s3, s3, 6272
    s_add_u32 s12, s12, s3
    s_add_u32 s12, s12, 106496
    s_movk_i32 s3, 3488
    s_movk_i32 s13, 3584
    v_add_u32 v12, 0, v0
    v_mul_u32_u24 v19, 171, v12
    v_lshrrev_b32_e64 v19, 10, v19
    v_mad_u32_u24 v102, v19, s3, v112
    v_and_b32 v12, 4, v19
    v_lshrrev_b32 v19, 1, v19
    v_and_b32 v19, 4, v19
    v_sub_u32 v12, v12, v19
    v_mad_i32_i24 v102, v12, s13, v102
    v_add_u32_e64 v12, 64, v0
    v_mul_u32_u24 v19, 171, v12
    v_lshrrev_b32_e64 v19, 10, v19
    v_mad_u32_u24 v103, v19, s3, v112
    v_and_b32 v12, 4, v19
    v_lshrrev_b32 v19, 1, v19
    v_and_b32 v19, 4, v19
    v_sub_u32 v12, v12, v19
    v_mad_i32_i24 v103, v12, s13, v103
    v_add_u32 v12, 128, v0
    v_mul_u32_u24 v19, 171, v12
    v_lshrrev_b32_e64 v19, 10, v19
    v_mad_u32_u24 v104, v19, s3, v112
    v_and_b32 v12, 4, v19
    v_lshrrev_b32 v19, 1, v19
    v_and_b32 v19, 4, v19
    v_sub_u32 v12, v12, v19
    v_mad_i32_i24 v104, v12, s13, v104
    s_waitcnt lgkmcnt(0)
    s_cmp_lt_u32 s26, 2
    s_cselect_b32 s68, s36, s40
    s_cselect_b32 s69, s37, s41
    s_mul_i32 s6, s76, 172032
    s_add_u32 s6, s6, s78
    s_add_u32 m0, s11, 0
    s_mul_i32 s8, s76, 229376
    buffer_load_dwordx4 v101, s[32:35], s6 offen lds
    s_add_u32 m0, s11, 4096
    s_add_u32 s7, s6, 896
    buffer_load_dwordx4 v101, s[32:35], s7 offen lds
    s_add_u32 m0, s12, 0
    s_add_u32 s8, s8, s79
    buffer_load_dwordx4 v102, s[68:71], s8 offen lds
    buffer_load_dwordx4 v103, s[68:71], s8 offen offset:1024 lds
    buffer_load_dwordx4 v104, s[68:71], s8 offen offset:2048 lds
    v_and_b32 v9, 15, v0
    v_lshrrev_b32 v10, 4, v0
    v_lshrrev_b32 v18, 1, v9
    v_lshlrev_b32 v12, 7, v9
    v_add_u32 v12, s10, v12
    v_xor_b32 v13, v10, v18
    v_lshl_add_u32 v96, v13, 4, v12
    v_xor_b32_e64 v97, 64, v96
    v_bfe_u32 v13, v0, 2, 2
    v_and_b32_e64 v15, 1, v10
    v_lshl_add_u32 v16, v10, 3, v13
    s_branch L_KVF
L_proFQ:
    s_and_b32 s3, s74, 3
    s_lshl_b32 s3, s3, 2
    s_add_u32 s25, s25, s3
    s_mul_i32 s79, s26, 57344
    s_lshl_b32 s13, s25, 5
    s_add_u32 s79, s79, s13
    s_lshl_b32 s12, s26, 11
    s_add_u32 s12, s12, 102400
    v_and_b32 v12, 2, v1
    v_xor_b32_e64 v12, v2, v12
    v_mul_u32_u24 v19, 3584, v1
    v_lshl_add_u32 v102, v12, 4, v19
    v_xor_b32 v12, 4, v12
    v_lshl_add_u32 v103, v12, 4, v19
    s_waitcnt lgkmcnt(0)
    s_mul_i32 s6, s76, 172032
    s_add_u32 s6, s6, s78
    s_add_u32 m0, s11, 0
    s_mul_i32 s8, s76, 229376
    buffer_load_dwordx4 v101, s[32:35], s6 offen lds
    s_add_u32 m0, s12, 0
    s_add_u32 s8, s8, s79
    buffer_load_dwordx4 v102, s[36:39], s8 offen lds
    s_add_u32 s9, s8, 27648
    buffer_load_dwordx4 v103, s[36:39], s9 offen offset:1024 lds
    s_add_u32 m0, s12, 8192
    s_nop 0
    buffer_load_dwordx4 v102, s[40:43], s8 offen lds
    buffer_load_dwordx4 v103, s[40:43], s9 offen offset:1024 lds
    v_and_b32 v9, 15, v0
    v_lshrrev_b32 v10, 4, v0
    v_lshrrev_b32 v18, 1, v9
    v_lshlrev_b32 v12, 7, v9
    v_add_u32 v12, s10, v12
    v_xor_b32_e64 v13, v10, v18
    v_lshl_add_u32 v96, v13, 4, v12
    v_xor_b32_e64 v97, 64, v96
    v_bfe_u32 v13, v0, 2, 2
    v_and_b32_e64 v15, 1, v10
    v_lshl_add_u32 v16, v10, 3, v13
    s_branch L_QF
L_KVA:
    v_lshlrev_b32 v19, 2, v15
    v_sub_u32_e64 v19, v16, v19
    v_mul_u32_u24 v19, 96, v19
    v_lshl_add_u32 v19, v14, 3, v19
    s_min_u32 s3, s26, 2
    s_lshl_b32 s3, s3, 5
    s_add_u32 s3, s3, 106496
    v_add_u32 v101, s3, v19
    v_lshlrev_b32 v19, 6, v16
    v_lshl_add_u32 v19, v15, 5, v19
    v_add_u32 v19, 98304, v19
    v_lshl_add_u32 v98, v14, 3, v19
    v_lshrrev_b32 v18, 1, v14
    v_xor_b32 v18, v18, v14
    v_xor_b32_e64 v19, 32, v19
    v_lshl_add_u32 v99, v18, 3, v19
    s_and_b32 s3, s26, 1
    s_lshl_b32 s3, s3, 12
    v_add_u32_e64 v102, s3, v98
    v_add_u32 v103, s3, v99
    s_lshl_b32 s3, s74, 1
    s_lshr_b32 s3, 0xe1e1b4b4, s3
    s_and_b32 s3, s3, 3
    s_mul_i32 s3, s3, 3
    s_add_u32 s25, s25, s3
    s_add_u32 s25, s25, 16
    s_lshl_b32 s75, s72, 3
    s_or_b32 s75, s75, s73
    v_mov_b32_e64 v20, 0
    v_lshrrev_b32 v19, 2, v112
    v_add_u32 v19, 160768, v19
    ds_write_b32 v19, v20
    s_add_u32 s76, s76, 1
    s_cmp_eq_u32 s76, 7
    s_cselect_b32 s76, 0, s76
    s_add_u32 m0, s10, 8192
    s_lshl_b32 s4, s76, 7
    s_add_u32 s4, s4, s77
    buffer_load_dwordx4 v104, s[28:31], s4 offen offset:0 lds
    buffer_load_dwordx4 v105, s[28:31], s4 offen offset:1024 lds
    buffer_load_dwordx4 v106, s[28:31], s4 offen offset:2048 lds
    buffer_load_dwordx4 v107, s[28:31], s4 offen offset:3072 lds
    s_cmp_ge_u32 s14, 32
    s_cbranch_scc1 L_bt_1
    s_and_b32 s3, s2, 1
    s_lshl_b32 s3, s3, 7
    s_mov_b32 s42, 1
    s_waitcnt vmcnt(12)
    s_atomic_add s42, s[60:61], s3
L_bt_1:
    s_waitcnt vmcnt(4) lgkmcnt(0)
    s_barrier
    ds_read_b64_tr_b16 a[64:65], v98 offset:0
    ds_read_b64_tr_b16 a[66:67], v98 offset:256
    ds_read_b128 a[80:83], v96 offset:0
    ds_read_b128 a[84:87], v96 offset:2048
    ds_read_b128 a[88:91], v96 offset:4096
    ds_read_b128 a[92:95], v96 offset:6144
    ds_read_b64_tr_b16 a[68:69], v99 offset:0
    ds_read_b64_tr_b16 a[70:71], v99 offset:256
    s_setprio 2
    s_waitcnt lgkmcnt(0)
    v_mfma_f32_16x16x32_bf16 v[0:3], a[64:67], a[80:83], 0
    v_mfma_f32_16x16x32_bf16 v[4:7], a[64:67], a[84:87], 0
    ds_read_b64_tr_b16 a[72:73], v98 offset:4096
    ds_read_b64_tr_b16 a[74:75], v98 offset:4352
    ds_read_b64_tr_b16 a[76:77], v99 offset:4096
    ds_read_b64_tr_b16 a[78:79], v99 offset:4352
    ds_read_b128 a[96:99], v97 offset:0
    v_mfma_f32_16x16x32_bf16 v[16:19], a[64:67], a[88:91], 0
    v_mfma_f32_16x16x32_bf16 v[20:23], a[64:67], a[92:95], 0
    ds_read_b128 a[100:103], v97 offset:2048
    ds_read_b64_tr_b16 v[64:65], v101 offset:0
    ds_read_b64_tr_b16 v[66:67], v101 offset:768
    ds_read_b64_tr_b16 v[68:69], v101 offset:3072
    ds_read_b64_tr_b16 v[70:71], v101 offset:3840
    s_add_u32 m0, s10, 12288
    s_add_u32 s4, s4, 28672
    buffer_load_dwordx4 v104, s[28:31], s4 offen offset:0 lds
    buffer_load_dwordx4 v105, s[28:31], s4 offen offset:1024 lds
    v_mfma_f32_16x16x32_bf16 v[8:11], a[68:71], a[80:83], 0
    v_mfma_f32_16x16x32_bf16 v[12:15], a[68:71], a[84:87], 0
    ds_read_b64_tr_b16 v[72:73], v101 offset:6272
    ds_read_b64_tr_b16 v[74:75], v101 offset:7040
    ds_read_b64_tr_b16 v[76:77], v101 offset:9344
    ds_read_b64_tr_b16 v[78:79], v101 offset:10112
    buffer_load_dwordx4 v106, s[28:31], s4 offen offset:2048 lds
    v_mfma_f32_16x16x32_bf16 v[24:27], a[68:71], a[88:91], 0
    v_mfma_f32_16x16x32_bf16 v[28:31], a[68:71], a[92:95], 0
    buffer_load_dwordx4 v107, s[28:31], s4 offen offset:3072 lds
    s_setprio 0
    v_mov_b32 v115, 1073741824
    v_lshrrev_b32 v124, 4, v112
    v_and_b32 v125, 31, v124
    v_lshrrev_b32_e64 v126, 5, v124
    s_lshl_b32 s15, s27, 2
    s_add_u32 s15, s15, s72
    s_lshl_b32 s15, s15, 3
    s_add_u32 s15, s15, s73
    s_lshl_b32 s15, s15, 2
    s_add_u32 s15, s15, s26
    s_mul_i32 s14, s15, 1792
    v_mul_u32_u24 v109, 896, v126
    v_lshl_add_u32 v109, v125, 4, v109
    v_cmp_lt_u32 vcc, 27, v125
    s_and_b32 s6, s15, 7
    s_lshl_b32 s6, s6, 6
    v_cndmask_b32 v109, v109, v115, vcc
    s_setprio 2
    s_waitcnt lgkmcnt(0)
    v_mfma_f32_16x16x32_bf16 v[32:35], a[72:75], a[80:83], 0
    v_mfma_f32_16x16x32_bf16 v[36:39], a[72:75], a[84:87], 0
    ds_read_b64_tr_b16 a[64:65], v98 offset:2048
    ds_read_b64_tr_b16 a[66:67], v98 offset:2304
    ds_read_b64_tr_b16 a[68:69], v99 offset:2048
    ds_read_b64_tr_b16 a[70:71], v99 offset:2304
    ds_read_b128 a[104:107], v97 offset:4096
    v_mfma_f32_16x16x32_bf16 v[48:51], a[72:75], a[88:91], 0
    v_mfma_f32_16x16x32_bf16 v[52:55], a[72:75], a[92:95], 0
    ds_read_b128 a[108:111], v97 offset:6144
    ds_read_b64_tr_b16 v[80:81], v102 offset:0
    ds_read_b64_tr_b16 v[82:83], v102 offset:256
    ds_read_b64_tr_b16 v[84:85], v102 offset:2048
    ds_read_b64_tr_b16 v[86:87], v102 offset:2304
    s_add_u32 s76, s76, 1
    s_cmp_eq_u32 s76, 7
    s_cselect_b32 s76, 0, s76
    s_add_u32 m0, s10, 16384
    s_lshl_b32 s4, s76, 7
    s_add_u32 s4, s4, s77
    s_nop 0
    buffer_load_dwordx4 v104, s[28:31], s4 offen offset:0 lds
    v_mfma_f32_16x16x32_bf16 v[40:43], a[76:79], a[80:83], 0
    v_mfma_f32_16x16x32_bf16 v[44:47], a[76:79], a[84:87], 0
    ds_read_b64_tr_b16 v[88:89], v103 offset:0
    ds_read_b64_tr_b16 v[90:91], v103 offset:256
    ds_read_b64_tr_b16 v[92:93], v103 offset:2048
    ds_read_b64_tr_b16 v[94:95], v103 offset:2304
    buffer_load_dwordx4 v105, s[28:31], s4 offen offset:1024 lds
    v_mfma_f32_16x16x32_bf16 v[56:59], a[76:79], a[88:91], 0
    v_mfma_f32_16x16x32_bf16 v[60:63], a[76:79], a[92:95], 0
    s_setprio 0
    v_cmp_eq_u32 vcc, 0, v125
    v_lshlrev_b32_e64 v126, 5, v126
    s_and_b32 s3, s15, 24
    v_cndmask_b32 v110, v115, v126, vcc
    s_add_u32 s6, s6, s3
    s_lshr_b32 s15, s15, 5
    s_lshl_b32 s15, s15, 9
    s_add_u32 s15, s15, s6
    s_add_u32 s15, s15, 12582912
    s_mov_b32 s54, 268435456
    s_mov_b32 s55, 0x20000
    s_lshl_b32 s16, s23, 2
    s_add_u32 s16, s16, s72
    s_mul_i32 s16, s16, 512
    s_add_u32 s16, s16, 13631488
    s_mul_i32 s23, s23, 294912
    s_setprio 2
    s_waitcnt lgkmcnt(0)
    v_mfma_f32_16x16x32_bf16 v[0:3], a[64:67], a[96:99], v[0:3]
    v_mfma_f32_16x16x32_bf16 v[4:7], a[64:67], a[100:103], v[4:7]
    ds_read_b64_tr_b16 a[72:73], v98 offset:6144
    ds_read_b64_tr_b16 a[74:75], v98 offset:6400
    ds_read_b64_tr_b16 a[76:77], v99 offset:6144
    ds_read_b64_tr_b16 a[78:79], v99 offset:6400
    v_mfma_f32_16x16x32_bf16 v[16:19], a[64:67], a[104:107], v[16:19]
    v_mfma_f32_16x16x32_bf16 v[20:23], a[64:67], a[108:111], v[20:23]
    buffer_load_dwordx4 v106, s[28:31], s4 offen offset:2048 lds
    v_mfma_f32_16x16x32_bf16 v[8:11], a[68:71], a[96:99], v[8:11]
    v_mfma_f32_16x16x32_bf16 v[12:15], a[68:71], a[100:103], v[12:15]
    buffer_load_dwordx4 v107, s[28:31], s4 offen offset:3072 lds
    v_mfma_f32_16x16x32_bf16 v[24:27], a[68:71], a[104:107], v[24:27]
    v_mfma_f32_16x16x32_bf16 v[28:31], a[68:71], a[108:111], v[28:31]
    s_setprio 0
    buffer_load_dwordx4 v[136:139], v109, s[28:31], s14 offen offset:0
    v_mov_b32 v115, 1073741824
    v_mov_b32 v114, 1
    v_lshrrev_b32 v124, 4, v112
    v_and_b32_e64 v125, 31, v124
    s_lshl_b32 s17, s74, 2
    s_add_u32 s17, s17, s26
    s_andn2_b32 s3, s17, 1
    s_add_u32 s17, s17, s3
    s_mul_i32 s17, s17, 512
    s_add_u32 s17, s17, 13632896
    s_lshl_b32 s1, s74, 2
    s_add_u32 s1, s1, s26
    s_lshl_b32 s1, s1, 3
    s_setprio 2
    v_mov_b32 v132, 0x3f803f80
    v_mov_b32 v133, 0x3f803f80
    v_mov_b32 v134, 0x3f803f80
    v_mov_b32 v135, 0x3f803f80
    s_nop 1
    v_mfma_f32_16x16x32_bf16 a[16:19], v[132:135], v[64:67], 0
    v_mfma_f32_16x16x32_bf16 a[20:23], v[132:135], v[72:75], 0
    v_mfma_f32_16x16x32_bf16 a[24:27], v[132:135], v[80:83], 0
    v_mfma_f32_16x16x32_bf16 a[28:31], v[132:135], v[88:91], 0
    v_mfma_f32_16x16x32_bf16 a[16:19], v[132:135], v[68:71], a[16:19]
    v_mfma_f32_16x16x32_bf16 a[20:23], v[132:135], v[76:79], a[20:23]
    v_mfma_f32_16x16x32_bf16 a[24:27], v[132:135], v[84:87], a[24:27]
    v_mfma_f32_16x16x32_bf16 a[28:31], v[132:135], v[92:95], a[28:31]
    s_waitcnt lgkmcnt(0)
    v_mfma_f32_16x16x32_bf16 v[32:35], a[72:75], a[96:99], v[32:35]
    v_mfma_f32_16x16x32_bf16 v[36:39], a[72:75], a[100:103], v[36:39]
    s_waitcnt vmcnt(5)
    s_barrier
    ds_read_b64_tr_b16 a[64:65], v98 offset:20736
    ds_read_b64_tr_b16 a[66:67], v98 offset:20992
    ds_read_b128 a[80:83], v96 offset:8192
    ds_read_b128 a[84:87], v96 offset:10240
    v_mfma_f32_16x16x32_bf16 v[48:51], a[72:75], a[104:107], v[48:51]
    v_mfma_f32_16x16x32_bf16 v[52:55], a[72:75], a[108:111], v[52:55]
    ds_read_b128 a[88:91], v96 offset:12288
    ds_read_b128 a[92:95], v96 offset:14336
    ds_read_b64_tr_b16 a[68:69], v99 offset:20736
    ds_read_b64_tr_b16 a[70:71], v99 offset:20992
    s_add_u32 m0, s10, 20480
    s_add_u32 s4, s4, 28672
    buffer_load_dwordx4 v104, s[28:31], s4 offen offset:0 lds
    v_mfma_f32_16x16x32_bf16 v[40:43], a[76:79], a[96:99], v[40:43]
    v_mfma_f32_16x16x32_bf16 v[44:47], a[76:79], a[100:103], v[44:47]
    buffer_load_dwordx4 v105, s[28:31], s4 offen offset:1024 lds
    v_mfma_f32_16x16x32_bf16 v[56:59], a[76:79], a[104:107], v[56:59]
    v_mfma_f32_16x16x32_bf16 v[60:63], a[76:79], a[108:111], v[60:63]
    s_setprio 0
    s_add_u32 s1, s1, s27
    s_lshl_b32 s1, s1, 10
    s_add_u32 s1, s1, 10485760
    s_lshl_b32 s13, s75, 3
    s_add_u32 s13, s13, s27
    s_mul_i32 s13, s13, 640
    s_add_u32 s13, s13, 12615680
    v_lshl_add_u32 v108, v125, 2, s13
    s_add_u32 s3, s26, 2
    s_lshl_b32 s3, s3, 7
    s_cmp_lt_u32 s26, 3
    s_cselect_b32 s3, s3, 1073741824
    v_mov_b32 v128, s3
    s_lshl_b32 s3, s26, 7
    s_cmp_lt_u32 s26, 2
    s_cselect_b32 s3, s3, 1073741824
    v_mov_b32 v125, s3
    s_setprio 2
    s_waitcnt lgkmcnt(0)
    v_mfma_f32_16x16x32_bf16 v[0:3], a[64:67], a[80:83], v[0:3]
    v_mfma_f32_16x16x32_bf16 v[4:7], a[64:67], a[84:87], v[4:7]
    ds_read_b64_tr_b16 a[72:73], v98 offset:24832
    ds_read_b64_tr_b16 a[74:75], v98 offset:25088
    ds_read_b64_tr_b16 a[76:77], v99 offset:24832
    ds_read_b64_tr_b16 a[78:79], v99 offset:25088
    v_mfma_f32_16x16x32_bf16 v[16:19], a[64:67], a[88:91], v[16:19]
    v_mfma_f32_16x16x32_bf16 v[20:23], a[64:67], a[92:95], v[20:23]
    ds_read_b128 a[96:99], v97 offset:8192
    ds_read_b128 a[100:103], v97 offset:10240
    buffer_load_dwordx4 v106, s[28:31], s4 offen offset:2048 lds
    v_mfma_f32_16x16x32_bf16 v[8:11], a[68:71], a[80:83], v[8:11]
    v_mfma_f32_16x16x32_bf16 v[12:15], a[68:71], a[84:87], v[12:15]
    buffer_load_dwordx4 v107, s[28:31], s4 offen offset:3072 lds
    v_mfma_f32_16x16x32_bf16 v[24:27], a[68:71], a[88:91], v[24:27]
    v_mfma_f32_16x16x32_bf16 v[28:31], a[68:71], a[92:95], v[28:31]
    s_setprio 0
    s_mov_b32 s18, 0
    s_mov_b32 s19, -1
    v_cndmask_b32 v128, v128, v125, s[18:19]
    v_add_u32_e64 v108, v108, v128
    v_accvgpr_read_b32 v130, a16
    v_accvgpr_read_b32 v133, a20
    v_accvgpr_read_b32 v134, a24
    v_accvgpr_read_b32 v135, a28
    s_cmp_eq_u32 s27, 7
    s_cselect_b32 s13, 0, -1
    s_nop 1
    v_mov_b32_dpp v130, v133 quad_perm:[0,1,2,3] row_mask:2 bank_mask:0xf
    s_nop 1
    v_mov_b32_dpp v130, v134 quad_perm:[0,1,2,3] row_mask:4 bank_mask:0xf
    s_nop 1
    v_mov_b32_dpp v130, v135 quad_perm:[0,1,2,3] row_mask:8 bank_mask:0xf
    s_setprio 2
    s_waitcnt lgkmcnt(0)
    v_mfma_f32_16x16x32_bf16 v[32:35], a[72:75], a[80:83], v[32:35]
    v_mfma_f32_16x16x32_bf16 v[36:39], a[72:75], a[84:87], v[36:39]
    ds_read_b64_tr_b16 a[64:65], v98 offset:22784
    ds_read_b64_tr_b16 a[66:67], v98 offset:23040
    ds_read_b64_tr_b16 a[68:69], v99 offset:22784
    ds_read_b64_tr_b16 a[70:71], v99 offset:23040
    v_mfma_f32_16x16x32_bf16 v[48:51], a[72:75], a[88:91], v[48:51]
    v_mfma_f32_16x16x32_bf16 v[52:55], a[72:75], a[92:95], v[52:55]
    ds_read_b128 a[104:107], v97 offset:12288
    ds_read_b128 a[108:111], v97 offset:14336
    s_add_u32 s76, s76, 1
    s_cmp_eq_u32 s76, 7
    s_cselect_b32 s76, 0, s76
    s_add_u32 m0, s10, 0
    s_lshl_b32 s4, s76, 7
    s_add_u32 s4, s4, s77
    buffer_load_dwordx4 v104, s[28:31], s4 offen offset:0 lds
    v_mfma_f32_16x16x32_bf16 v[40:43], a[76:79], a[80:83], v[40:43]
    v_mfma_f32_16x16x32_bf16 v[44:47], a[76:79], a[84:87], v[44:47]
    buffer_load_dwordx4 v105, s[28:31], s4 offen offset:1024 lds
    v_mfma_f32_16x16x32_bf16 v[56:59], a[76:79], a[88:91], v[56:59]
    v_mfma_f32_16x16x32_bf16 v[60:63], a[76:79], a[92:95], v[60:63]
    s_setprio 0
    buffer_load_dwordx4 v[140:143], v109, s[28:31], s14 offen offset:448
    v_and_b32 v131, s13, v130
    buffer_store_dword v131, v108, s[52:55], 0 offen sc1
    s_setprio 2
    s_waitcnt lgkmcnt(0)
    v_mfma_f32_16x16x32_bf16 v[0:3], a[64:67], a[96:99], v[0:3]
    v_mfma_f32_16x16x32_bf16 v[4:7], a[64:67], a[100:103], v[4:7]
    ds_read_b64_tr_b16 a[72:73], v98 offset:26880
    ds_read_b64_tr_b16 a[74:75], v98 offset:27136
    ds_read_b64_tr_b16 a[76:77], v99 offset:26880
    ds_read_b64_tr_b16 a[78:79], v99 offset:27136
    v_mfma_f32_16x16x32_bf16 v[16:19], a[64:67], a[104:107], v[16:19]
    v_mfma_f32_16x16x32_bf16 v[20:23], a[64:67], a[108:111], v[20:23]
    buffer_load_dwordx4 v106, s[28:31], s4 offen offset:2048 lds
    v_mfma_f32_16x16x32_bf16 v[8:11], a[68:71], a[96:99], v[8:11]
    v_mfma_f32_16x16x32_bf16 v[12:15], a[68:71], a[100:103], v[12:15]
    buffer_load_dwordx4 v107, s[28:31], s4 offen offset:3072 lds
    v_mfma_f32_16x16x32_bf16 v[24:27], a[68:71], a[104:107], v[24:27]
    v_mfma_f32_16x16x32_bf16 v[28:31], a[68:71], a[108:111], v[28:31]
    s_waitcnt lgkmcnt(0)
    s_nop 0
    v_mfma_f32_16x16x32_bf16 v[32:35], a[72:75], a[96:99], v[32:35]
    v_mfma_f32_16x16x32_bf16 v[36:39], a[72:75], a[100:103], v[36:39]
    s_waitcnt vmcnt(6)
    s_barrier
    ds_read_b64_tr_b16 a[64:65], v98 offset:41472
    ds_read_b64_tr_b16 a[66:67], v98 offset:41728
    ds_read_b128 a[80:83], v96 offset:16384
    ds_read_b128 a[84:87], v96 offset:18432
    v_mfma_f32_16x16x32_bf16 v[48:51], a[72:75], a[104:107], v[48:51]
    v_mfma_f32_16x16x32_bf16 v[52:55], a[72:75], a[108:111], v[52:55]
    ds_read_b128 a[88:91], v96 offset:20480
    ds_read_b128 a[92:95], v96 offset:22528
    ds_read_b64_tr_b16 a[68:69], v99 offset:41472
    ds_read_b64_tr_b16 a[70:71], v99 offset:41728
    s_add_u32 m0, s10, 4096
    s_add_u32 s4, s4, 28672
    buffer_load_dwordx4 v104, s[28:31], s4 offen offset:0 lds
    v_mfma_f32_16x16x32_bf16 v[40:43], a[76:79], a[96:99], v[40:43]
    v_mfma_f32_16x16x32_bf16 v[44:47], a[76:79], a[100:103], v[44:47]
    buffer_load_dwordx4 v105, s[28:31], s4 offen offset:1024 lds
    v_mfma_f32_16x16x32_bf16 v[56:59], a[76:79], a[104:107], v[56:59]
    v_mfma_f32_16x16x32_bf16 v[60:63], a[76:79], a[108:111], v[60:63]
    s_setprio 0
    s_waitcnt vmcnt(5)
    v_lshlrev_b32_e64 v128, 16, v136
    v_and_b32 v136, 0xffff0000, v136
    v_lshlrev_b32_e64 v129, 16, v137
    v_and_b32 v137, 0xffff0000, v137
    v_lshlrev_b32_e64 v130, 16, v138
    v_and_b32 v138, 0xffff0000, v138
    v_lshlrev_b32_e64 v131, 16, v139
    v_and_b32 v139, 0xffff0000, v139
    v_lshlrev_b32_e64 v132, 16, v140
    v_and_b32 v140, 0xffff0000, v140
    v_lshlrev_b32_e64 v133, 16, v141
    v_and_b32 v141, 0xffff0000, v141
    v_lshlrev_b32_e64 v134, 16, v142
    v_and_b32 v142, 0xffff0000, v142
    v_lshlrev_b32_e64 v135, 16, v143
    s_setprio 2
    s_waitcnt lgkmcnt(0)
    v_mfma_f32_16x16x32_bf16 v[0:3], a[64:67], a[80:83], v[0:3]
    v_mfma_f32_16x16x32_bf16 v[4:7], a[64:67], a[84:87], v[4:7]
    ds_read_b64_tr_b16 a[72:73], v98 offset:45568
    ds_read_b64_tr_b16 a[74:75], v98 offset:45824
    ds_read_b64_tr_b16 a[76:77], v99 offset:45568
    ds_read_b64_tr_b16 a[78:79], v99 offset:45824
    v_mfma_f32_16x16x32_bf16 v[16:19], a[64:67], a[88:91], v[16:19]
    v_mfma_f32_16x16x32_bf16 v[20:23], a[64:67], a[92:95], v[20:23]
    ds_read_b128 a[96:99], v97 offset:16384
    ds_read_b128 a[100:103], v97 offset:18432
    buffer_load_dwordx4 v106, s[28:31], s4 offen offset:2048 lds
    v_mfma_f32_16x16x32_bf16 v[8:11], a[68:71], a[80:83], v[8:11]
    v_mfma_f32_16x16x32_bf16 v[12:15], a[68:71], a[84:87], v[12:15]
    buffer_load_dwordx4 v107, s[28:31], s4 offen offset:3072 lds
    v_mfma_f32_16x16x32_bf16 v[24:27], a[68:71], a[88:91], v[24:27]
    v_mfma_f32_16x16x32_bf16 v[28:31], a[68:71], a[92:95], v[28:31]
    s_setprio 0
    v_and_b32 v143, 0xffff0000, v143
    v_add_f32 v125, v128, v136
    v_add_f32 v124, v129, v137
    v_add_f32 v125, v125, v130
    v_add_f32 v124, v124, v138
    v_add_f32 v125, v125, v131
    v_add_f32 v124, v124, v139
    v_add_f32 v125, v125, v132
    v_add_f32 v124, v124, v140
    v_add_f32 v125, v125, v133
    v_add_f32 v124, v124, v141
    v_add_f32 v125, v125, v134
    v_add_f32 v124, v124, v142
    v_add_f32 v125, v125, v135
    v_add_f32 v124, v124, v143
    v_add_f32 v125, v125, v124
    s_setprio 2
    s_waitcnt lgkmcnt(0)
    v_mfma_f32_16x16x32_bf16 v[32:35], a[72:75], a[80:83], v[32:35]
    v_mfma_f32_16x16x32_bf16 v[36:39], a[72:75], a[84:87], v[36:39]
    ds_read_b64_tr_b16 a[64:65], v98 offset:43520
    ds_read_b64_tr_b16 a[66:67], v98 offset:43776
    ds_read_b64_tr_b16 a[68:69], v99 offset:43520
    ds_read_b64_tr_b16 a[70:71], v99 offset:43776
    v_mfma_f32_16x16x32_bf16 v[48:51], a[72:75], a[88:91], v[48:51]
    v_mfma_f32_16x16x32_bf16 v[52:55], a[72:75], a[92:95], v[52:55]
    ds_read_b128 a[104:107], v97 offset:20480
    ds_read_b128 a[108:111], v97 offset:22528
    s_add_u32 s76, s76, 1
    s_cmp_eq_u32 s76, 7
    s_cselect_b32 s76, 0, s76
    s_add_u32 m0, s10, 8192
    s_lshl_b32 s4, s76, 7
    s_add_u32 s4, s4, s77
    s_nop 0
    buffer_load_dwordx4 v104, s[28:31], s4 offen offset:0 lds
    v_mfma_f32_16x16x32_bf16 v[40:43], a[76:79], a[80:83], v[40:43]
    v_mfma_f32_16x16x32_bf16 v[44:47], a[76:79], a[84:87], v[44:47]
    buffer_load_dwordx4 v105, s[28:31], s4 offen offset:1024 lds
    v_mfma_f32_16x16x32_bf16 v[56:59], a[76:79], a[88:91], v[56:59]
    v_mfma_f32_16x16x32_bf16 v[60:63], a[76:79], a[92:95], v[60:63]
    s_setprio 0
    s_nop 1
    v_add_f32_dpp v125, v125, v125 quad_perm:[1,0,3,2] row_mask:0xf bank_mask:0xf
    s_nop 1
    v_add_f32_dpp v125, v125, v125 quad_perm:[2,3,0,1] row_mask:0xf bank_mask:0xf
    s_nop 1
    v_add_f32_dpp v125, v125, v125 row_half_mirror row_mask:0xf bank_mask:0xf
    s_nop 1
    v_add_f32_dpp v125, v125, v125 row_mirror row_mask:0xf bank_mask:0xf
    v_mov_b32 v127, v125
    s_nop 1
    v_permlane16_swap_b32 v125, v127
    v_add_f32_e64 v125, v125, v127
    v_mul_f32 v125, 0xbb124925, v125
    v_add_f32 v128, v128, v125
    v_add_f32 v136, v136, v125
    v_add_f32_e64 v129, v129, v125
    s_setprio 2
    s_waitcnt lgkmcnt(0)
    v_mfma_f32_16x16x32_bf16 v[0:3], a[64:67], a[96:99], v[0:3]
    v_mfma_f32_16x16x32_bf16 v[4:7], a[64:67], a[100:103], v[4:7]
    ds_read_b64_tr_b16 a[72:73], v98 offset:47616
    ds_read_b64_tr_b16 a[74:75], v98 offset:47872
    ds_read_b64_tr_b16 a[76:77], v99 offset:47616
    ds_read_b64_tr_b16 a[78:79], v99 offset:47872
    v_mfma_f32_16x16x32_bf16 v[16:19], a[64:67], a[104:107], v[16:19]
    v_mfma_f32_16x16x32_bf16 v[20:23], a[64:67], a[108:111], v[20:23]
    buffer_load_dwordx4 v106, s[28:31], s4 offen offset:2048 lds
    v_mfma_f32_16x16x32_bf16 v[8:11], a[68:71], a[96:99], v[8:11]
    v_mfma_f32_16x16x32_bf16 v[12:15], a[68:71], a[100:103], v[12:15]
    buffer_load_dwordx4 v107, s[28:31], s4 offen offset:3072 lds
    v_mfma_f32_16x16x32_bf16 v[24:27], a[68:71], a[104:107], v[24:27]
    v_mfma_f32_16x16x32_bf16 v[28:31], a[68:71], a[108:111], v[28:31]
    s_setprio 0
    v_add_f32 v137, v137, v125
    v_add_f32 v130, v130, v125
    v_add_f32 v138, v138, v125
    v_add_f32 v131, v131, v125
    v_add_f32 v139, v139, v125
    v_add_f32 v132, v132, v125
    v_add_f32 v140, v140, v125
    v_add_f32 v133, v133, v125
    v_add_f32 v141, v141, v125
    v_add_f32 v134, v134, v125
    v_add_f32 v142, v142, v125
    v_add_f32 v135, v135, v125
    v_add_f32 v143, v143, v125
    v_mul_f32 v124, v128, v128
    v_mul_f32 v126, v136, v136
    v_fmac_f32_e64 v124, v129, v129
    s_setprio 2
    s_waitcnt lgkmcnt(0)
    v_mfma_f32_16x16x32_bf16 v[32:35], a[72:75], a[96:99], v[32:35]
    v_mfma_f32_16x16x32_bf16 v[36:39], a[72:75], a[100:103], v[36:39]
    s_waitcnt vmcnt(4)
    s_barrier
    ds_read_b64_tr_b16 a[64:65], v98 offset:0
    ds_read_b64_tr_b16 a[66:67], v98 offset:256
    ds_read_b128 a[80:83], v96 offset:0
    ds_read_b128 a[84:87], v96 offset:2048
    v_mfma_f32_16x16x32_bf16 v[48:51], a[72:75], a[104:107], v[48:51]
    v_mfma_f32_16x16x32_bf16 v[52:55], a[72:75], a[108:111], v[52:55]
    ds_read_b128 a[88:91], v96 offset:4096
    ds_read_b128 a[92:95], v96 offset:6144
    ds_read_b64_tr_b16 a[68:69], v99 offset:0
    ds_read_b64_tr_b16 a[70:71], v99 offset:256
    s_add_u32 m0, s10, 12288
    s_add_u32 s4, s4, 28672
    buffer_load_dwordx4 v104, s[28:31], s4 offen offset:0 lds
    v_mfma_f32_16x16x32_bf16 v[40:43], a[76:79], a[96:99], v[40:43]
    v_mfma_f32_16x16x32_bf16 v[44:47], a[76:79], a[100:103], v[44:47]
    buffer_load_dwordx4 v105, s[28:31], s4 offen offset:1024 lds
    v_mfma_f32_16x16x32_bf16 v[56:59], a[76:79], a[104:107], v[56:59]
    v_mfma_f32_16x16x32_bf16 v[60:63], a[76:79], a[108:111], v[60:63]
    s_setprio 0
    s_mov_b32 s62, 256
    s_mov_b32 s63, 0x20000
    v_lshlrev_b32 v116, 3, v112
    buffer_load_dword v115, v116, s[60:63], 0 offen sc1
    v_fmac_f32 v126, v137, v137
    v_fmac_f32 v124, v130, v130
    v_fmac_f32 v126, v138, v138
    v_fmac_f32 v124, v131, v131
    v_fmac_f32 v126, v139, v139
    v_fmac_f32 v124, v132, v132
    v_fmac_f32 v126, v140, v140
    v_fmac_f32 v124, v133, v133
    v_fmac_f32 v126, v141, v141
    v_fmac_f32 v124, v134, v134
    s_setprio 2
    s_waitcnt lgkmcnt(0)
    v_mfma_f32_16x16x32_bf16 v[0:3], a[64:67], a[80:83], v[0:3]
    v_mfma_f32_16x16x32_bf16 v[4:7], a[64:67], a[84:87], v[4:7]
    ds_read_b64_tr_b16 a[72:73], v98 offset:4096
    ds_read_b64_tr_b16 a[74:75], v98 offset:4352
    ds_read_b64_tr_b16 a[76:77], v99 offset:4096
    ds_read_b64_tr_b16 a[78:79], v99 offset:4352
    v_mfma_f32_16x16x32_bf16 v[16:19], a[64:67], a[88:91], v[16:19]
    v_mfma_f32_16x16x32_bf16 v[20:23], a[64:67], a[92:95], v[20:23]
    ds_read_b128 a[96:99], v97 offset:0
    ds_read_b128 a[100:103], v97 offset:2048
    buffer_load_dwordx4 v106, s[28:31], s4 offen offset:2048 lds
    v_mfma_f32_16x16x32_bf16 v[8:11], a[68:71], a[80:83], v[8:11]
    v_mfma_f32_16x16x32_bf16 v[12:15], a[68:71], a[84:87], v[12:15]
    buffer_load_dwordx4 v107, s[28:31], s4 offen offset:3072 lds
    v_mfma_f32_16x16x32_bf16 v[24:27], a[68:71], a[88:91], v[24:27]
    v_mfma_f32_16x16x32_bf16 v[28:31], a[68:71], a[92:95], v[28:31]
    s_setprio 0
    v_fmac_f32 v126, v142, v142
    v_fmac_f32 v124, v135, v135
    v_fmac_f32 v126, v143, v143
    s_mov_b32 vcc_lo, 0xf0000000
    s_mov_b32 vcc_hi, 0xf0000000
    v_add_f32_e64 v126, v126, v124
    v_cndmask_b32 v126, v126, 0, vcc
    s_nop 1
    v_add_f32_dpp v126, v126, v126 quad_perm:[1,0,3,2] row_mask:0xf bank_mask:0xf
    s_nop 1
    v_add_f32_dpp v126, v126, v126 quad_perm:[2,3,0,1] row_mask:0xf bank_mask:0xf
    s_nop 1
    v_add_f32_dpp v126, v126, v126 row_half_mirror row_mask:0xf bank_mask:0xf
    s_nop 1
    v_add_f32_dpp v126, v126, v126 row_mirror row_mask:0xf bank_mask:0xf
    v_mov_b32_e64 v127, v126
    s_setprio 2
    s_waitcnt lgkmcnt(0)
    v_mfma_f32_16x16x32_bf16 v[32:35], a[72:75], a[80:83], v[32:35]
    v_mfma_f32_16x16x32_bf16 v[36:39], a[72:75], a[84:87], v[36:39]
    ds_read_b64_tr_b16 a[64:65], v98 offset:2048
    ds_read_b64_tr_b16 a[66:67], v98 offset:2304
    ds_read_b64_tr_b16 a[68:69], v99 offset:2048
    ds_read_b64_tr_b16 a[70:71], v99 offset:2304
    v_mfma_f32_16x16x32_bf16 v[48:51], a[72:75], a[88:91], v[48:51]
    v_mfma_f32_16x16x32_bf16 v[52:55], a[72:75], a[92:95], v[52:55]
    ds_read_b128 a[104:107], v97 offset:4096
    ds_read_b128 a[108:111], v97 offset:6144
    s_add_u32 s76, s76, 1
    s_cmp_eq_u32 s76, 7
    s_cselect_b32 s76, 0, s76
    s_add_u32 m0, s10, 16384
    s_lshl_b32 s4, s76, 7
    s_add_u32 s4, s4, s77
    s_nop 0
    buffer_load_dwordx4 v104, s[28:31], s4 offen offset:0 lds
    v_mfma_f32_16x16x32_bf16 v[40:43], a[76:79], a[80:83], v[40:43]
    v_mfma_f32_16x16x32_bf16 v[44:47], a[76:79], a[84:87], v[44:47]
    buffer_load_dwordx4 v105, s[28:31], s4 offen offset:1024 lds
    v_mfma_f32_16x16x32_bf16 v[56:59], a[76:79], a[88:91], v[56:59]
    v_mfma_f32_16x16x32_bf16 v[60:63], a[76:79], a[92:95], v[60:63]
    s_setprio 0
    s_nop 1
    v_permlane16_swap_b32 v126, v127
    v_add_f32 v126, v126, v127
    v_mov_b32 v124, 0x3727c5ac
    v_fmac_f32 v124, 0x3b124925, v126
    buffer_store_dwordx2 v[124:125], v110, s[52:55], s15 offen sc1
    s_setprio 2
    s_waitcnt lgkmcnt(0)
    v_mfma_f32_16x16x32_bf16 v[0:3], a[64:67], a[96:99], v[0:3]
    v_mfma_f32_16x16x32_bf16 v[4:7], a[64:67], a[100:103], v[4:7]
    ds_read_b64_tr_b16 a[72:73], v98 offset:6144
    ds_read_b64_tr_b16 a[74:75], v98 offset:6400
    ds_read_b64_tr_b16 a[76:77], v99 offset:6144
    ds_read_b64_tr_b16 a[78:79], v99 offset:6400
    v_mfma_f32_16x16x32_bf16 v[16:19], a[64:67], a[104:107], v[16:19]
    v_mfma_f32_16x16x32_bf16 v[20:23], a[64:67], a[108:111], v[20:23]
    buffer_load_dwordx4 v106, s[28:31], s4 offen offset:2048 lds
    v_mfma_f32_16x16x32_bf16 v[8:11], a[68:71], a[96:99], v[8:11]
    v_mfma_f32_16x16x32_bf16 v[12:15], a[68:71], a[100:103], v[12:15]
    buffer_load_dwordx4 v107, s[28:31], s4 offen offset:3072 lds
    v_mfma_f32_16x16x32_bf16 v[24:27], a[68:71], a[104:107], v[24:27]
    v_mfma_f32_16x16x32_bf16 v[28:31], a[68:71], a[108:111], v[28:31]
    s_waitcnt lgkmcnt(0)
    v_mfma_f32_16x16x32_bf16 v[32:35], a[72:75], a[96:99], v[32:35]
    v_mfma_f32_16x16x32_bf16 v[36:39], a[72:75], a[100:103], v[36:39]
    s_waitcnt vmcnt(2)
    v_cmp_gt_u32 vcc, 16, v115
    s_and_b32 s3, vcc_lo, 3
    s_cbranch_scc1 L_in_2f
L_in_2b:
    s_barrier
    ds_read_b64_tr_b16 a[64:65], v98 offset:20736
    ds_read_b64_tr_b16 a[66:67], v98 offset:20992
    ds_read_b128 a[80:83], v96 offset:8192
    ds_read_b128 a[84:87], v96 offset:10240
    v_mfma_f32_16x16x32_bf16 v[48:51], a[72:75], a[104:107], v[48:51]
    v_mfma_f32_16x16x32_bf16 v[52:55], a[72:75], a[108:111], v[52:55]
    ds_read_b128 a[88:91], v96 offset:12288
    ds_read_b128 a[92:95], v96 offset:14336
    ds_read_b64_tr_b16 a[68:69], v99 offset:20736
    ds_read_b64_tr_b16 a[70:71], v99 offset:20992
    s_add_u32 m0, s10, 20480
    s_add_u32 s4, s4, 28672
    buffer_load_dwordx4 v104, s[28:31], s4 offen offset:0 lds
    ds_read_b32 a2, v112
    ds_read_b32 a3, v112
    v_mfma_f32_16x16x32_bf16 v[40:43], a[76:79], a[96:99], v[40:43]
    v_mfma_f32_16x16x32_bf16 v[44:47], a[76:79], a[100:103], v[44:47]
    buffer_load_dwordx4 v105, s[28:31], s4 offen offset:1024 lds
    v_mfma_f32_16x16x32_bf16 v[56:59], a[76:79], a[104:107], v[56:59]
    s_nop 0
    v_mfma_f32_16x16x32_bf16 v[60:63], a[76:79], a[108:111], v[60:63]
    s_setprio 0
    s_mul_i32 s3, s75, 2048
    s_add_u32 s14, s3, 13632384
    s_cmp_lg_u32 s26, 0
    s_cbranch_scc1 L_pb_3
    s_lshl_b32 s3, s27, 2
    s_add_u32 s3, s3, s72
    s_mul_i32 s3, s3, 2048
    s_add_u32 s6, s3, 13631872
    s_mov_b32 s42, 1
    s_atomic_add s42, s[52:53], s6
    s_mov_b32 s42, 1
    s_atomic_add s42, s[52:53], s14
L_pb_3:
    s_mov_b32 s46, 1605632
    s_mov_b32 s47, 0x20000
    s_mov_b32 s50, 401408
    s_mov_b32 s51, 0x20000
    s_mov_b32 s58, 1835008
    s_mov_b32 s59, 0x20000
    s_and_b32 s20, s2, 7
    s_lshl_b32 s20, s20, 2
    s_bfe_u32 s21, s2, 0x20003
    s_or_b32 s20, s20, s21
    s_lshr_b32 s21, s2, 5
    s_lshl_b32 s22, s21, 7
    s_mul_i32 s3, s26, 401408
    s_add_u32 s22, s22, s3
    v_lshrrev_b32_e64 v128, 4, v112
    s_setprio 2
    s_waitcnt lgkmcnt(2)
    v_mfma_f32_16x16x32_bf16 v[0:3], a[64:67], a[80:83], v[0:3]
    v_mfma_f32_16x16x32_bf16 v[4:7], a[64:67], a[84:87], v[4:7]
    ds_read_b64_tr_b16 a[72:73], v98 offset:24832
    ds_read_b64_tr_b16 a[74:75], v98 offset:25088
    ds_read_b64_tr_b16 a[76:77], v99 offset:24832
    ds_read_b64_tr_b16 a[78:79], v99 offset:25088
    v_mfma_f32_16x16x32_bf16 v[16:19], a[64:67], a[88:91], v[16:19]
    v_mfma_f32_16x16x32_bf16 v[20:23], a[64:67], a[92:95], v[20:23]
    ds_read_b128 a[96:99], v97 offset:8192
    ds_read_b128 a[100:103], v97 offset:10240
    buffer_load_dwordx4 v106, s[28:31], s4 offen offset:2048 lds
    ds_read_b32 a2, v112
    ds_read_b32 a3, v112
    v_mfma_f32_16x16x32_bf16 v[8:11], a[68:71], a[80:83], v[8:11]
    v_mfma_f32_16x16x32_bf16 v[12:15], a[68:71], a[84:87], v[12:15]
    buffer_load_dwordx4 v107, s[28:31], s4 offen offset:3072 lds
    v_mfma_f32_16x16x32_bf16 v[24:27], a[68:71], a[88:91], v[24:27]
    v_mfma_f32_16x16x32_bf16 v[28:31], a[68:71], a[92:95], v[28:31]
    s_setprio 0
    v_lshrrev_b32 v129, 3, v128
    v_mul_u32_u24 v130, 896, v129
    v_and_b32 v129, 2, v129
    v_lshlrev_b32 v129, 1, v129
    v_and_b32 v131, 7, v128
    v_xor_b32 v129, v129, v131
    v_lshl_add_u32 v119, v129, 4, v130
    s_cmp_eq_u32 s21, 7
    s_cselect_b32 s3, 1073741824, 0
    v_add_u32_e64 v119, s3, v119
    v_add_u32 v120, 6144, v119
    v_add_u32 v121, 12288, v119
    v_add_u32 v122, 18432, v119
    v_bfe_u32 v129, v128, 2, 2
    v_lshrrev_b32_e64 v130, 5, v128
    v_lshl_add_u32 v130, v130, 3, v129
    s_setprio 2
    s_waitcnt lgkmcnt(2)
    v_mfma_f32_16x16x32_bf16 v[32:35], a[72:75], a[80:83], v[32:35]
    v_mfma_f32_16x16x32_bf16 v[36:39], a[72:75], a[84:87], v[36:39]
    ds_read_b64_tr_b16 a[64:65], v98 offset:22784
    ds_read_b64_tr_b16 a[66:67], v98 offset:23040
    ds_read_b64_tr_b16 a[68:69], v99 offset:22784
    ds_read_b64_tr_b16 a[70:71], v99 offset:23040
    v_mfma_f32_16x16x32_bf16 v[48:51], a[72:75], a[88:91], v[48:51]
    v_mfma_f32_16x16x32_bf16 v[52:55], a[72:75], a[92:95], v[52:55]
    ds_read_b128 a[104:107], v97 offset:12288
    ds_read_b128 a[108:111], v97 offset:14336
    s_add_u32 s76, s76, 1
    s_cmp_eq_u32 s76, 7
    s_cselect_b32 s76, 0, s76
    s_add_u32 m0, s10, 0
    s_lshl_b32 s4, s76, 7
    s_add_u32 s4, s4, s77
    buffer_load_dwordx4 v104, s[28:31], s4 offen offset:0 lds
    ds_read_b32 a2, v112
    ds_read_b32 a3, v112
    v_mfma_f32_16x16x32_bf16 v[40:43], a[76:79], a[80:83], v[40:43]
    v_mfma_f32_16x16x32_bf16 v[44:47], a[76:79], a[84:87], v[44:47]
    buffer_load_dwordx4 v105, s[28:31], s4 offen offset:1024 lds
    v_mfma_f32_16x16x32_bf16 v[56:59], a[76:79], a[88:91], v[56:59]
    v_mfma_f32_16x16x32_bf16 v[60:63], a[76:79], a[92:95], v[60:63]
    s_setprio 0
    v_bfe_u32 v131, v128, 4, 1
    v_and_b32 v132, 3, v128
    v_lshl_add_u32 v131, v131, 2, v132
    v_lshlrev_b32_e64 v132, 7, v130
    v_lshl_add_u32 v132, v131, 3, v132
    v_add_u32 v132, s10, v132
    v_lshrrev_b32 v129, 1, v129
    v_lshl_add_u32 v117, v129, 6, v132
    v_xor_b32_e64 v129, 1, v129
    v_lshl_add_u32 v118, v129, 6, v132
    v_mul_u32_u24 v130, 56, v130
    v_min_u32 v131, 6, v131
    v_lshl_add_u32 v130, v131, 3, v130
    v_add_u32 v123, 161792, v130
    s_and_b32 s3, s2, 7
    s_lshl_b32 s3, s3, 2
    s_lshr_b32 s43, 0x6543210, s3
    s_sub_u32 s3, 28, s3
    s_lshl_b32 s3, 0x6543210, s3
    s_or_b32 s43, s43, s3
    s_lshl_b32 s35, s20, 2
    s_add_u32 s34, s35, s26
    s_mul_i32 s34, s34, 512
    s_add_u32 s34, s34, 13631488
    s_lshl_b32 s35, s35, 1
    s_add_u32 s35, s35, s26
    s_mul_i32 s35, s35, 7168
    s_lshl_b32 s36, s21, 7
    s_add_u32 s35, s35, s36
    s_mul_i32 s37, s20, 294912
    s_mul_i32 s33, s26, 57344
    s_add_u32 s33, s33, s37
    s_mul_i32 s40, s26, 14336
    s_add_u32 s40, s40, 98304
    s_mul_i32 s41, s26, -301056
    s_add_u32 s41, s41, s22
    s_add_u32 s32, s35, 28672
    s_setprio 2
    s_waitcnt lgkmcnt(2)
    v_mfma_f32_16x16x32_bf16 v[0:3], a[64:67], a[96:99], v[0:3]
    v_mfma_f32_16x16x32_bf16 v[4:7], a[64:67], a[100:103], v[4:7]
    ds_read_b64_tr_b16 a[72:73], v98 offset:26880
    ds_read_b64_tr_b16 a[74:75], v98 offset:27136
    ds_read_b64_tr_b16 a[76:77], v99 offset:26880
    ds_read_b64_tr_b16 a[78:79], v99 offset:27136
    v_mfma_f32_16x16x32_bf16 v[16:19], a[64:67], a[104:107], v[16:19]
    v_mfma_f32_16x16x32_bf16 v[20:23], a[64:67], a[108:111], v[20:23]
    buffer_load_dwordx4 v106, s[28:31], s4 offen offset:2048 lds
    v_mfma_f32_16x16x32_bf16 v[8:11], a[68:71], a[96:99], v[8:11]
    v_mfma_f32_16x16x32_bf16 v[12:15], a[68:71], a[100:103], v[12:15]
    buffer_load_dwordx4 v107, s[28:31], s4 offen offset:3072 lds
    v_mfma_f32_16x16x32_bf16 v[24:27], a[68:71], a[104:107], v[24:27]
    v_mfma_f32_16x16x32_bf16 v[28:31], a[68:71], a[108:111], v[28:31]
    s_waitcnt lgkmcnt(0)
    s_nop 0
    v_mfma_f32_16x16x32_bf16 v[32:35], a[72:75], a[96:99], v[32:35]
    v_mfma_f32_16x16x32_bf16 v[36:39], a[72:75], a[100:103], v[36:39]
    s_waitcnt vmcnt(4)
    s_barrier
    ds_read_b64_tr_b16 a[64:65], v98 offset:41472
    ds_read_b64_tr_b16 a[66:67], v98 offset:41728
    ds_read_b128 a[80:83], v96 offset:16384
    ds_read_b128 a[84:87], v96 offset:18432
    v_mfma_f32_16x16x32_bf16 v[48:51], a[72:75], a[104:107], v[48:51]
    v_mfma_f32_16x16x32_bf16 v[52:55], a[72:75], a[108:111], v[52:55]
    ds_read_b128 a[88:91], v96 offset:20480
    ds_read_b128 a[92:95], v96 offset:22528
    ds_read_b64_tr_b16 a[68:69], v99 offset:41472
    ds_read_b64_tr_b16 a[70:71], v99 offset:41728
    s_add_u32 m0, s10, 4096
    s_add_u32 s4, s4, 28672
    buffer_load_dwordx4 v104, s[28:31], s4 offen offset:0 lds
    v_mfma_f32_16x16x32_bf16 v[40:43], a[76:79], a[96:99], v[40:43]
    v_mfma_f32_16x16x32_bf16 v[44:47], a[76:79], a[100:103], v[44:47]
    ds_read_b64_tr_b16 v[88:89], v123 offset:0
    ds_read_b64_tr_b16 v[90:91], v123 offset:224
    ds_read_b64_tr_b16 v[92:93], v123 offset:896
    ds_read_b64_tr_b16 v[94:95], v123 offset:1120
    buffer_load_dwordx4 v105, s[28:31], s4 offen offset:1024 lds
    v_mfma_f32_16x16x32_bf16 v[56:59], a[76:79], a[104:107], v[56:59]
    v_mfma_f32_16x16x32_bf16 v[60:63], a[76:79], a[108:111], v[60:63]
    s_setprio 0
    v_lshrrev_b32 v78, 4, v112
    v_and_b32_e64 v76, 31, v78
    v_mul_u32_u24 v76, 208, v76
    v_and_b32_e64 v77, 32, v78
    s_mul_i32 s7, s26, 13312
    s_add_u32 s7, s7, 98304
    v_add3_u32 v100, v76, v77, s7
    v_and_b32_e64 v76, 15, v78
    v_mul_u32_u24 v76, 208, v76
    v_and_b32_e64 v77, 48, v78
    v_add3_u32 v84, v76, v77, s7
    v_lshrrev_b32 v76, 4, v78
    v_lshlrev_b32 v76, 3, v76
    v_bfe_u32 v77, v78, 2, 1
    v_add_u32_e64 v76, v76, v77
    v_bfe_u32 v77, v78, 3, 1
    s_setprio 2
    s_waitcnt lgkmcnt(0)
    v_mfma_f32_16x16x32_bf16 v[0:3], a[64:67], a[80:83], v[0:3]
    v_mfma_f32_16x16x32_bf16 v[4:7], a[64:67], a[84:87], v[4:7]
    ds_read_b64_tr_b16 a[72:73], v98 offset:45568
    ds_read_b64_tr_b16 a[74:75], v98 offset:45824
    ds_read_b64_tr_b16 a[76:77], v99 offset:45568
    ds_read_b64_tr_b16 a[78:79], v99 offset:45824
    v_mfma_f32_16x16x32_bf16 v[16:19], a[64:67], a[88:91], v[16:19]
    v_mfma_f32_16x16x32_bf16 v[20:23], a[64:67], a[92:95], v[20:23]
    ds_read_b128 a[96:99], v97 offset:16384
    ds_read_b128 a[100:103], v97 offset:18432
    buffer_load_dwordx4 v106, s[28:31], s4 offen offset:2048 lds
    v_mfma_f32_16x16x32_bf16 v[8:11], a[68:71], a[80:83], v[8:11]
    v_mfma_f32_16x16x32_bf16 v[12:15], a[68:71], a[84:87], v[12:15]
    buffer_load_dwordx4 v107, s[28:31], s4 offen offset:3072 lds
    v_mfma_f32_16x16x32_bf16 v[24:27], a[68:71], a[88:91], v[24:27]
    v_mfma_f32_16x16x32_bf16 v[28:31], a[68:71], a[92:95], v[28:31]
    s_setprio 0
    s_nop 0
    v_mov_b32_dpp v88, v88 quad_perm:[2,3,2,3] row_mask:0xa bank_mask:0x8
    v_mov_b32_dpp v89, v89 quad_perm:[2,3,2,3] row_mask:0xa bank_mask:0x8
    v_mov_b32_dpp v90, v90 quad_perm:[2,3,2,3] row_mask:0xa bank_mask:0x8
    v_mov_b32_dpp v91, v91 quad_perm:[2,3,2,3] row_mask:0xa bank_mask:0x8
    v_mov_b32_dpp v92, v92 quad_perm:[2,3,2,3] row_mask:0xa bank_mask:0x8
    v_mov_b32_dpp v93, v93 quad_perm:[2,3,2,3] row_mask:0xa bank_mask:0x8
    v_mov_b32_dpp v94, v94 quad_perm:[2,3,2,3] row_mask:0xa bank_mask:0x8
    v_mov_b32_dpp v95, v95 quad_perm:[2,3,2,3] row_mask:0xa bank_mask:0x8
    v_cndmask_b32 v94, v94, 0, s[18:19]
    v_cndmask_b32 v95, v95, 0, s[18:19]
    v_lshl_add_u32 v76, v77, 2, v76
    v_mul_u32_u24 v76, 208, v76
    v_add_u32 v76, 98304, v76
    v_and_b32_e64 v77, 3, v78
    v_lshl_add_u32 v102, v77, 4, v76
    v_and_b32_e64 v77, 1, v78
    s_setprio 2
    s_waitcnt lgkmcnt(0)
    v_mfma_f32_16x16x32_bf16 v[32:35], a[72:75], a[80:83], v[32:35]
    v_mfma_f32_16x16x32_bf16 v[36:39], a[72:75], a[84:87], v[36:39]
    ds_read_b64_tr_b16 a[64:65], v98 offset:43520
    ds_read_b64_tr_b16 a[66:67], v98 offset:43776
    ds_read_b64_tr_b16 a[68:69], v99 offset:43520
    ds_read_b64_tr_b16 a[70:71], v99 offset:43776
    v_mfma_f32_16x16x32_bf16 v[48:51], a[72:75], a[88:91], v[48:51]
    v_mfma_f32_16x16x32_bf16 v[52:55], a[72:75], a[92:95], v[52:55]
    ds_read_b128 a[104:107], v97 offset:20480
    ds_read_b128 a[108:111], v97 offset:22528
    v_mfma_f32_16x16x32_bf16 v[40:43], a[76:79], a[80:83], v[40:43]
    v_mfma_f32_16x16x32_bf16 v[44:47], a[76:79], a[84:87], v[44:47]
    v_mfma_f32_16x16x32_bf16 v[56:59], a[76:79], a[88:91], v[56:59]
    v_mfma_f32_16x16x32_bf16 v[60:63], a[76:79], a[92:95], v[60:63]
    s_setprio 0
    v_lshl_add_u32 v76, v77, 5, v76
    v_bfe_u32 v77, v78, 1, 1
    v_lshl_add_u32 v76, v77, 3, v76
    s_lshl_b32 s3, s26, 3
    s_lshr_b32 s3, 0x50401000, s3
    s_and_b32 s3, s3, 0xff
    v_add_u32_e64 v101, s3, v76
    v_bfe_u32 v76, v78, 4, 1
    v_lshlrev_b32 v76, 9, v76
    v_lshrrev_b32 v77, 5, v78
    v_lshl_add_u32 v76, v77, 8, v76
    v_and_b32_e64 v77, 15, v78
    v_lshl_add_u32 v103, v77, 4, v76
    s_setprio 2
    s_bfe_u32 s4, s43, 0x40000
    s_mul_i32 s4, s4, 28672
    s_add_u32 m0, s10, 8192
    s_add_u32 s4, s4, s22
    buffer_load_dwordx4 v119, s[44:47], s4 offen offset:0 lds
    buffer_load_dwordx4 v120, s[44:47], s4 offen offset:1024 lds
    buffer_load_dwordx4 v121, s[44:47], s4 offen offset:2048 lds
    buffer_load_dwordx4 v122, s[44:47], s4 offen offset:3072 lds
    s_bfe_u32 s4, s43, 0x40004
    s_mul_i32 s4, s4, 28672
    s_add_u32 m0, s10, 12288
    s_add_u32 s4, s4, s22
    buffer_load_dwordx4 v119, s[44:47], s4 offen offset:0 lds
    buffer_load_dwordx4 v120, s[44:47], s4 offen offset:1024 lds
    buffer_load_dwordx4 v121, s[44:47], s4 offen offset:2048 lds
    buffer_load_dwordx4 v122, s[44:47], s4 offen offset:3072 lds
    s_waitcnt lgkmcnt(0)
    v_mfma_f32_16x16x32_bf16 v[0:3], a[64:67], a[96:99], v[0:3]
    v_mfma_f32_16x16x32_bf16 v[4:7], a[64:67], a[100:103], v[4:7]
    ds_read_b64_tr_b16 a[72:73], v98 offset:47616
    ds_read_b64_tr_b16 a[74:75], v98 offset:47872
    ds_read_b64_tr_b16 a[76:77], v99 offset:47616
    ds_read_b64_tr_b16 a[78:79], v99 offset:47872
    s_lshl_b32 s3, s27, 2
    s_add_u32 s3, s3, s26
    s_mul_i32 s3, s3, 2048
    s_add_u32 s6, s3, 13631872
    s_load_dword s68, s[52:53], s6
    s_load_dword s69, s[52:53], s14
    ds_read_b32 a2, v112
    ds_read_b32 a3, v112
    v_mfma_f32_16x16x32_bf16 v[16:19], a[64:67], a[104:107], v[16:19]
    v_mfma_f32_16x16x32_bf16 v[20:23], a[64:67], a[108:111], v[20:23]
    v_mfma_f32_16x16x32_bf16 v[8:11], a[68:71], a[96:99], v[8:11]
    v_mfma_f32_16x16x32_bf16 v[12:15], a[68:71], a[100:103], v[12:15]
    v_mfma_f32_16x16x32_bf16 v[24:27], a[68:71], a[104:107], v[24:27]
    v_mfma_f32_16x16x32_bf16 v[28:31], a[68:71], a[108:111], v[28:31]
    s_waitcnt lgkmcnt(2)
    s_nop 0
    v_mfma_f32_16x16x32_bf16 v[32:35], a[72:75], a[96:99], v[32:35]
    v_mfma_f32_16x16x32_bf16 v[36:39], a[72:75], a[100:103], v[36:39]
    s_waitcnt lgkmcnt(0)
    s_min_u32 s3, s68, s69
    s_cmp_lt_u32 s3, 8
    s_cbranch_scc1 L_sc_4f
L_sc_4b:
    s_waitcnt vmcnt(8)
    s_barrier
    ds_read_b64_tr_b16 a[64:65], v98 offset:0
    ds_read_b64_tr_b16 a[66:67], v98 offset:256
    ds_read_b128 a[80:83], v96 offset:0
    ds_read_b128 a[84:87], v96 offset:2048
    v_mfma_f32_16x16x32_bf16 v[48:51], a[72:75], a[104:107], v[48:51]
    v_mfma_f32_16x16x32_bf16 v[52:55], a[72:75], a[108:111], v[52:55]
    ds_read_b128 a[88:91], v96 offset:4096
    ds_read_b128 a[92:95], v96 offset:6144
    ds_read_b64_tr_b16 a[68:69], v99 offset:0
    ds_read_b64_tr_b16 a[70:71], v99 offset:256
    v_mfma_f32_16x16x32_bf16 v[40:43], a[76:79], a[96:99], v[40:43]
    v_mfma_f32_16x16x32_bf16 v[44:47], a[76:79], a[100:103], v[44:47]
    v_mfma_f32_16x16x32_bf16 v[56:59], a[76:79], a[104:107], v[56:59]
    v_mfma_f32_16x16x32_bf16 v[60:63], a[76:79], a[108:111], v[60:63]
    s_setprio 0
    v_and_b32 v116, 0xf0, v112
    v_lshlrev_b32 v116, 1, v116
    s_lshl_b32 s15, s27, 2
    s_add_u32 s15, s15, s26
    s_lshl_b32 s15, s15, 9
    s_add_u32 s15, s15, 12582912
    v_lshrrev_b32 v115, 9, v112
    v_mul_u32_u24 v115, 2560, v115
    v_bfe_u32 v113, v112, 2, 7
    v_add_u32 v113, v113, v115
    s_movk_i32 s3, 512
    s_cmp_lg_u32 s26, 0
    s_cselect_b32 s3, 1073741824, s3
    v_add_u32 v115, s3, v113
    s_mul_i32 s8, s75, 40
    s_add_u32 s8, s8, s26
    s_lshl_b32 s8, s8, 7
    s_add_u32 s8, s8, 12615680
    buffer_load_dwordx4 v[124:127], v116, s[52:55], s15 offen offset:0 sc1
    buffer_load_dwordx4 v[108:111], v116, s[52:55], s15 offen offset:16 sc1
    buffer_load_dword v64, v113, s[52:55], s8 offen offset:0 sc1
    buffer_load_dword v65, v113, s[52:55], s8 offen offset:640 sc1
    buffer_load_dword v66, v113, s[52:55], s8 offen offset:1280 sc1
    buffer_load_dword v67, v113, s[52:55], s8 offen offset:1920 sc1
    buffer_load_dword v68, v115, s[52:55], s8 offen offset:0 sc1
    buffer_load_dword v69, v115, s[52:55], s8 offen offset:640 sc1
    buffer_load_dword v70, v115, s[52:55], s8 offen offset:1280 sc1
    buffer_load_dword v71, v115, s[52:55], s8 offen offset:1920 sc1
    s_setprio 2
    s_bfe_u32 s4, s43, 0x40008
    s_mul_i32 s4, s4, 28672
    s_add_u32 m0, s10, 16384
    s_add_u32 s4, s4, s22
    buffer_load_dwordx4 v119, s[44:47], s4 offen offset:0 lds
    buffer_load_dwordx4 v120, s[44:47], s4 offen offset:1024 lds
    buffer_load_dwordx4 v121, s[44:47], s4 offen offset:2048 lds
    buffer_load_dwordx4 v122, s[44:47], s4 offen offset:3072 lds
    s_bfe_u32 s4, s43, 0x4000c
    s_mul_i32 s4, s4, 28672
    s_add_u32 m0, s10, 20480
    s_add_u32 s4, s4, s22
    buffer_load_dwordx4 v119, s[44:47], s4 offen offset:0 lds
    buffer_load_dwordx4 v120, s[44:47], s4 offen offset:1024 lds
    buffer_load_dwordx4 v121, s[44:47], s4 offen offset:2048 lds
    buffer_load_dwordx4 v122, s[44:47], s4 offen offset:3072 lds
    s_waitcnt lgkmcnt(0)
    v_mfma_f32_16x16x32_bf16 v[0:3], a[64:67], a[80:83], v[0:3]
    v_mfma_f32_16x16x32_bf16 v[4:7], a[64:67], a[84:87], v[4:7]
    ds_read_b64_tr_b16 a[72:73], v98 offset:4096
    ds_read_b64_tr_b16 a[74:75], v98 offset:4352
    ds_read_b64_tr_b16 a[76:77], v99 offset:4096
    ds_read_b64_tr_b16 a[78:79], v99 offset:4352
    v_mfma_f32_16x16x32_bf16 v[16:19], a[64:67], a[88:91], v[16:19]
    v_mfma_f32_16x16x32_bf16 v[20:23], a[64:67], a[92:95], v[20:23]
    ds_read_b128 a[96:99], v97 offset:0
    ds_read_b128 a[100:103], v97 offset:2048
    v_mfma_f32_16x16x32_bf16 v[8:11], a[68:71], a[80:83], v[8:11]
    v_mfma_f32_16x16x32_bf16 v[12:15], a[68:71], a[84:87], v[12:15]
    v_mfma_f32_16x16x32_bf16 v[24:27], a[68:71], a[88:91], v[24:27]
    v_mfma_f32_16x16x32_bf16 v[28:31], a[68:71], a[92:95], v[28:31]
    s_waitcnt lgkmcnt(0)
    s_nop 0
    v_mfma_f32_16x16x32_bf16 v[32:35], a[72:75], a[80:83], v[32:35]
    v_mfma_f32_16x16x32_bf16 v[36:39], a[72:75], a[84:87], v[36:39]
    ds_read_b64_tr_b16 a[64:65], v98 offset:2048
    ds_read_b64_tr_b16 a[66:67], v98 offset:2304
    ds_read_b64_tr_b16 a[68:69], v99 offset:2048
    ds_read_b64_tr_b16 a[70:71], v99 offset:2304
    v_mfma_f32_16x16x32_bf16 v[48:51], a[72:75], a[88:91], v[48:51]
    v_mfma_f32_16x16x32_bf16 v[52:55], a[72:75], a[92:95], v[52:55]
    ds_read_b128 a[104:107], v97 offset:4096
    ds_read_b128 a[108:111], v97 offset:6144
    v_mfma_f32_16x16x32_bf16 v[40:43], a[76:79], a[80:83], v[40:43]
    v_mfma_f32_16x16x32_bf16 v[44:47], a[76:79], a[84:87], v[44:47]
    v_mfma_f32_16x16x32_bf16 v[56:59], a[76:79], a[88:91], v[56:59]
    v_mfma_f32_16x16x32_bf16 v[60:63], a[76:79], a[92:95], v[60:63]
    s_setprio 0
    s_waitcnt vmcnt(8)
    v_add_f32 v64, v64, v65
    v_add_f32 v66, v66, v67
    v_add_f32_e64 v64, v64, v66
    v_cvt_pk_bf16_f32 v65, v64, v64
    v_lshlrev_b32 v65, 16, v65
    v_sub_f32 v65, v64, v65
    v_cvt_pk_bf16_f32 v64, v64, v65
    v_add_f32 v68, v68, v69
    v_add_f32 v70, v70, v71
    v_add_f32_e64 v68, v68, v70
    v_cvt_pk_bf16_f32 v69, v68, v68
    v_lshlrev_b32 v69, 16, v69
    v_sub_f32 v69, v68, v69
    v_cvt_pk_bf16_f32 v68, v68, v69
    v_bfe_u32 v115, v112, 1, 8
    v_lshrrev_b32 v116, 9, v112
    v_lshl_add_u32 v115, v116, 2, v115
    s_lshl_b32 s3, s26, 8
    s_add_u32 s3, s3, 155648
    v_add_u32 v115, s3, v115
    v_mov_b32 v66, 0
    ds_write_b32 v115, v64
    ds_write_b32 v115, v68 offset:1024
    ds_write_b32 v115, v66 offset:2048
    v_and_b32 v123, 0x130, v112
    v_lshrrev_b32 v123, 1, v123
    v_and_b32 v116, 0x40, v112
    v_add_u32 v123, v123, v116
    s_mov_b32 vcc_lo, 0xff00ff00
    s_mov_b32 vcc_hi, 0x00ff00ff
    v_mov_b32 v116, 1280
    v_cndmask_b32 v123, v123, v116, vcc
    v_add_u32 v123, 155648, v123
    s_mov_b32 vcc_lo, 0
    s_mov_b32 vcc_hi, -1
    v_cndmask_b32 v136, v125, v127, vcc
    v_cndmask_b32 v140, v109, v111, vcc
    v_cvt_pk_bf16_f32 v136, v136, v136
    v_cvt_pk_bf16_f32 v140, v140, v140
    s_mov_b32 vcc_lo, 0xffff0000
    s_mov_b32 vcc_hi, 0xffff0000
    v_cndmask_b32 v138, 0, v136, vcc
    v_cndmask_b32 v139, 0, v136, vcc
    v_cndmask_b32 v137, v136, 0, vcc
    v_cndmask_b32 v136, v136, 0, vcc
    v_cndmask_b32 v142, 0, v140, vcc
    v_cndmask_b32 v143, 0, v140, vcc
    v_cndmask_b32 v141, v140, 0, vcc
    v_cndmask_b32 v140, v140, 0, vcc
    v_rsq_f32 v129, v124
    v_rsq_f32 v131, v126
    v_rsq_f32_e64 v133, v108
    v_rsq_f32 v135, v110
    s_setprio 2
    ds_read_b64_tr_b16 a[0:1], v117 offset:8192
    ds_read_b64_tr_b16 a[2:3], v117 offset:8704
    ds_read_b64_tr_b16 a[4:5], v118 offset:8192
    ds_read_b64_tr_b16 a[6:7], v118 offset:8704
    ds_read_b64_tr_b16 a[8:9], v117 offset:10240
    ds_read_b64_tr_b16 a[10:11], v117 offset:10752
    ds_read_b64_tr_b16 a[12:13], v118 offset:10240
    ds_read_b64_tr_b16 a[14:15], v118 offset:10752
    ds_read_b64_tr_b16 a[16:17], v117 offset:12288
    ds_read_b64_tr_b16 a[18:19], v117 offset:12800
    ds_read_b64_tr_b16 a[20:21], v118 offset:12288
    ds_read_b64_tr_b16 a[22:23], v118 offset:12800
    ds_read_b64_tr_b16 a[24:25], v117 offset:14336
    ds_read_b64_tr_b16 a[26:27], v117 offset:14848
    ds_read_b64_tr_b16 a[28:29], v118 offset:14336
    ds_read_b64_tr_b16 a[30:31], v118 offset:14848
    s_waitcnt lgkmcnt(0)
    s_nop 0
    v_mfma_f32_16x16x32_bf16 v[0:3], a[64:67], a[96:99], v[0:3]
    v_mfma_f32_16x16x32_bf16 v[4:7], a[64:67], a[100:103], v[4:7]
    ds_read_b64_tr_b16 a[72:73], v98 offset:6144
    ds_read_b64_tr_b16 a[74:75], v98 offset:6400
    ds_read_b64_tr_b16 a[76:77], v99 offset:6144
    ds_read_b64_tr_b16 a[78:79], v99 offset:6400
    v_mfma_f32_16x16x32_bf16 v[16:19], a[64:67], a[104:107], v[16:19]
    v_mfma_f32_16x16x32_bf16 v[20:23], a[64:67], a[108:111], v[20:23]
    v_mfma_f32_16x16x32_bf16 v[8:11], a[68:71], a[96:99], v[8:11]
    v_mfma_f32_16x16x32_bf16 v[12:15], a[68:71], a[100:103], v[12:15]
    v_mfma_f32_16x16x32_bf16 v[24:27], a[68:71], a[104:107], v[24:27]
    v_mfma_f32_16x16x32_bf16 v[28:31], a[68:71], a[108:111], v[28:31]
    s_bfe_u32 s4, s43, 0x40010
    s_mul_i32 s4, s4, 28672
    s_add_u32 m0, s10, 8192
    s_add_u32 s4, s4, s22
    buffer_load_dwordx4 v119, s[44:47], s4 offen offset:0 lds
    buffer_load_dwordx4 v120, s[44:47], s4 offen offset:1024 lds
    buffer_load_dwordx4 v121, s[44:47], s4 offen offset:2048 lds
    buffer_load_dwordx4 v122, s[44:47], s4 offen offset:3072 lds
    s_bfe_u32 s4, s43, 0x40014
    s_mul_i32 s4, s4, 28672
    s_add_u32 m0, s10, 12288
    s_add_u32 s4, s4, s22
    buffer_load_dwordx4 v119, s[44:47], s4 offen offset:0 lds
    buffer_load_dwordx4 v120, s[44:47], s4 offen offset:1024 lds
    buffer_load_dwordx4 v121, s[44:47], s4 offen offset:2048 lds
    buffer_load_dwordx4 v122, s[44:47], s4 offen offset:3072 lds
    s_waitcnt lgkmcnt(0)
    v_mfma_f32_16x16x32_bf16 v[32:35], a[72:75], a[96:99], v[32:35]
    v_mfma_f32_16x16x32_bf16 v[36:39], a[72:75], a[100:103], v[36:39]
    s_barrier
    ds_read2_b64 a[64:67], v123 offset0:0 offset1:4
    ds_read2_b64 a[68:71], v123 offset0:32 offset1:36
    v_mfma_f32_16x16x32_bf16 v[48:51], a[72:75], a[104:107], v[48:51]
    v_mfma_f32_16x16x32_bf16 v[52:55], a[72:75], a[108:111], v[52:55]
    v_mfma_f32_16x16x32_bf16 v[40:43], a[76:79], a[96:99], v[40:43]
    v_mfma_f32_16x16x32_bf16 v[44:47], a[76:79], a[100:103], v[44:47]
    v_mfma_f32_16x16x32_bf16 v[56:59], a[76:79], a[104:107], v[56:59]
    v_mfma_f32_16x16x32_bf16 v[60:63], a[76:79], a[108:111], v[60:63]
    s_waitcnt vmcnt(12)
    s_nop 0
    ds_read_b64_tr_b16 a[32:33], v117 offset:16384
    ds_read_b64_tr_b16 a[34:35], v117 offset:16896
    ds_read_b64_tr_b16 a[36:37], v118 offset:16384
    ds_read_b64_tr_b16 a[38:39], v118 offset:16896
    ds_read_b64_tr_b16 a[40:41], v117 offset:18432
    ds_read_b64_tr_b16 a[42:43], v117 offset:18944
    ds_read_b64_tr_b16 a[44:45], v118 offset:18432
    ds_read_b64_tr_b16 a[46:47], v118 offset:18944
    s_waitcnt lgkmcnt(0)
    v_mfma_f32_32x32x16_bf16 v[0:15], a[64:67], v[136:139], v[0:15]
    s_bfe_u32 s4, s43, 0x40018
    s_mul_i32 s4, s4, 28672
    s_add_u32 m0, s10, 16384
    s_add_u32 s4, s4, s22
    buffer_load_dwordx4 v119, s[44:47], s4 offen offset:0 lds
    buffer_load_dwordx4 v120, s[44:47], s4 offen offset:1024 lds
    buffer_load_dwordx4 v121, s[44:47], s4 offen offset:2048 lds
    buffer_load_dwordx4 v122, s[44:47], s4 offen offset:3072 lds
    v_mfma_f32_32x32x16_bf16 v[16:31], a[64:67], v[140:143], v[16:31]
    v_mfma_f32_32x32x16_bf16 v[32:47], a[68:71], v[136:139], v[32:47]
    v_mfma_f32_32x32x16_bf16 v[48:63], a[68:71], v[140:143], v[48:63]
    s_setprio 1
    s_nop 4
    v_cvt_pk_bf16_f32 v64, v0, v1
    v_cvt_pk_bf16_f32 v65, v2, v3
    v_cvt_pk_bf16_f32 v66, v4, v5
    v_cvt_pk_bf16_f32 v67, v6, v7
    v_cvt_pk_bf16_f32 v68, v8, v9
    v_cvt_pk_bf16_f32 v69, v10, v11
    v_cvt_pk_bf16_f32 v70, v12, v13
    v_cvt_pk_bf16_f32 v71, v14, v15
    v_cvt_pk_bf16_f32 v72, v16, v17
    v_cvt_pk_bf16_f32 v73, v18, v19
    v_cvt_pk_bf16_f32 v74, v20, v21
    v_cvt_pk_bf16_f32 v75, v22, v23
    v_cvt_pk_bf16_f32 v76, v24, v25
    v_cvt_pk_bf16_f32 v77, v26, v27
    v_cvt_pk_bf16_f32 v78, v28, v29
    v_cvt_pk_bf16_f32 v79, v30, v31
    v_permlane16_swap_b32 v64, v66
    v_permlane16_swap_b32 v65, v67
    v_permlane16_swap_b32 v68, v70
    v_permlane16_swap_b32 v69, v71
    v_permlane16_swap_b32 v72, v74
    v_permlane16_swap_b32 v73, v75
    v_permlane16_swap_b32 v76, v78
    v_permlane16_swap_b32 v77, v79
    s_nop 1
    v_mfma_f32_32x32x16_bf16 v[0:15], v[88:91], v[64:67], 0
    v_mfma_f32_32x32x16_bf16 v[0:15], v[92:95], v[68:71], v[0:15]
    v_mfma_f32_32x32x16_bf16 v[16:31], v[88:91], v[72:75], 0
    v_mfma_f32_32x32x16_bf16 v[16:31], v[92:95], v[76:79], v[16:31]
    s_mov_b32 s6, 0
    s_mov_b32 s7, 0xffff0000
    v_mov_b32 v80, 0x3f80
    v_mul_f32 v32, v32, v129
    v_mul_f32 v33, v33, v129
    v_mul_f32 v34, v34, v129
    v_mul_f32 v35, v35, v129
    v_mul_f32 v40, v40, v129
    v_mul_f32 v41, v41, v129
    v_mul_f32 v42, v42, v129
    v_mul_f32 v43, v43, v129
    v_mul_f32 v36, v36, v131
    v_mul_f32 v37, v37, v131
    v_mul_f32 v38, v38, v131
    v_mul_f32 v39, v39, v131
    v_mul_f32 v44, v44, v131
    v_mul_f32 v45, v45, v131
    v_mul_f32 v46, v46, v131
    v_mul_f32 v47, v47, v131
    v_mul_f32 v48, v48, v133
    v_mul_f32 v49, v49, v133
    v_mul_f32 v50, v50, v133
    v_mul_f32 v51, v51, v133
    v_mul_f32 v56, v56, v133
    v_mul_f32 v57, v57, v133
    v_mul_f32 v58, v58, v133
    v_mul_f32 v59, v59, v133
    v_mul_f32 v52, v52, v135
    v_mul_f32 v53, v53, v135
    v_mul_f32 v54, v54, v135
    v_mul_f32 v55, v55, v135
    v_mul_f32 v60, v60, v135
    v_mul_f32 v61, v61, v135
    v_mul_f32 v62, v62, v135
    v_mul_f32 v63, v63, v135
    v_cvt_pk_bf16_f32 v64, v32, v33
    v_cvt_pk_bf16_f32 v65, v34, v35
    v_cvt_pk_bf16_f32 v66, v40, v41
    v_cvt_pk_bf16_f32 v67, v42, v43
    v_cndmask_b32 v66, v66, v80, s[6:7]
    v_cndmask_b32 v67, v67, 0, s[6:7]
    ds_write_b128 v84, v[64:67] offset:128
    v_cvt_pk_bf16_f32 v68, v36, v37
    v_cvt_pk_bf16_f32 v69, v38, v39
    v_cvt_pk_bf16_f32 v70, v44, v45
    v_cvt_pk_bf16_f32 v71, v46, v47
    v_cndmask_b32 v70, v70, v80, s[6:7]
    v_cndmask_b32 v71, v71, 0, s[6:7]
    ds_write_b128 v84, v[68:71] offset:3456
    v_cvt_pk_bf16_f32 v72, v48, v49
    v_cvt_pk_bf16_f32 v73, v50, v51
    v_cvt_pk_bf16_f32 v74, v56, v57
    v_cvt_pk_bf16_f32 v75, v58, v59
    v_cndmask_b32 v74, v74, v80, s[6:7]
    v_cndmask_b32 v75, v75, 0, s[6:7]
    ds_write_b128 v84, v[72:75] offset:6784
    v_cvt_pk_bf16_f32 v76, v52, v53
    v_cvt_pk_bf16_f32 v77, v54, v55
    v_cvt_pk_bf16_f32 v78, v60, v61
    v_cvt_pk_bf16_f32 v79, v62, v63
    v_cndmask_b32 v78, v78, v80, s[6:7]
    v_cndmask_b32 v79, v79, 0, s[6:7]
    ds_write_b128 v84, v[76:79] offset:10112
    v_max3_f32 v136, v0, v1, v2
    v_min3_f32 v138, v0, v1, v2
    v_max3_f32 v140, v16, v17, v18
    v_min3_f32 v142, v16, v17, v18
    v_max3_f32 v136, v136, v3, v4
    v_min3_f32 v138, v138, v3, v4
    v_max3_f32 v140, v140, v19, v20
    v_min3_f32 v142, v142, v19, v20
    v_max3_f32 v136, v136, v5, v6
    v_min3_f32 v138, v138, v5, v6
    v_max3_f32 v140, v140, v21, v22
    v_min3_f32 v142, v142, v21, v22
    v_max3_f32 v136, v136, v7, v8
    v_min3_f32 v138, v138, v7, v8
    v_max3_f32 v140, v140, v23, v24
    v_min3_f32 v142, v142, v23, v24
    v_max3_f32 v136, v136, v9, v10
    v_min3_f32 v138, v138, v9, v10
    v_max3_f32 v140, v140, v25, v26
    v_min3_f32 v142, v142, v25, v26
    v_max3_f32 v136, v136, v11, v12
    v_min3_f32 v138, v138, v11, v12
    v_max3_f32 v140, v140, v27, v28
    s_waitcnt vmcnt(0)
    s_nop 0
    ds_read_b64_tr_b16 a[48:49], v117 offset:20480
    ds_read_b64_tr_b16 a[50:51], v117 offset:20992
    ds_read_b64_tr_b16 a[52:53], v118 offset:20480
    ds_read_b64_tr_b16 a[54:55], v118 offset:20992
    ds_read_b64_tr_b16 a[56:57], v117 offset:22528
    ds_read_b64_tr_b16 a[58:59], v117 offset:23040
    ds_read_b64_tr_b16 a[60:61], v118 offset:22528
    ds_read_b64_tr_b16 a[62:63], v118 offset:23040
    ds_read_b64_tr_b16 a[64:65], v117 offset:8192
    ds_read_b64_tr_b16 a[66:67], v117 offset:8704
    ds_read_b64_tr_b16 a[68:69], v118 offset:8192
    ds_read_b64_tr_b16 a[70:71], v118 offset:8704
    ds_read_b64_tr_b16 a[72:73], v117 offset:10240
    ds_read_b64_tr_b16 a[74:75], v117 offset:10752
    ds_read_b64_tr_b16 a[76:77], v118 offset:10240
    ds_read_b64_tr_b16 a[78:79], v118 offset:10752
    ds_read_b64_tr_b16 a[80:81], v117 offset:12288
    ds_read_b64_tr_b16 a[82:83], v117 offset:12800
    ds_read_b64_tr_b16 a[84:85], v118 offset:12288
    ds_read_b64_tr_b16 a[86:87], v118 offset:12800
    ds_read_b64_tr_b16 a[88:89], v117 offset:14336
    ds_read_b64_tr_b16 a[90:91], v117 offset:14848
    ds_read_b64_tr_b16 a[92:93], v118 offset:14336
    ds_read_b64_tr_b16 a[94:95], v118 offset:14848
    ds_read_b64_tr_b16 a[96:97], v117 offset:16384
    ds_read_b64_tr_b16 a[98:99], v117 offset:16896
    ds_read_b64_tr_b16 a[100:101], v118 offset:16384
    ds_read_b64_tr_b16 a[102:103], v118 offset:16896
    ds_read_b64_tr_b16 a[104:105], v117 offset:18432
    ds_read_b64_tr_b16 a[106:107], v117 offset:18944
    ds_read_b64_tr_b16 a[108:109], v118 offset:18432
    ds_read_b64_tr_b16 a[110:111], v118 offset:18944
    v_min3_f32 v142, v142, v27, v28
    v_max_f32 v137, v136, v13
    v_min_f32 v139, v138, v13
    v_max_f32 v141, v140, v29
    v_min_f32 v143, v142, v29
    v_max_f32 v136, v136, v13
    v_min_f32 v138, v138, v13
    v_max_f32 v140, v140, v29
    v_min_f32 v142, v142, v29
    s_mov_b32 vcc_lo, 0xffff0000
    s_mov_b32 vcc_hi, 0xffff0000
    v_cndmask_b32 v128, v129, v131, vcc
    v_cndmask_b32 v130, v133, v135, vcc
    v_mul_f32 v128, 0x3fb8aa3b, v128
    v_mul_f32 v130, 0x3fb8aa3b, v130
    v_permlane32_swap_b32 v136, v137
    v_permlane32_swap_b32 v138, v139
    v_permlane32_swap_b32 v140, v141
    v_permlane32_swap_b32 v142, v143
    v_max_f32 v136, v136, v137
    v_min_f32 v138, v138, v139
    v_max_f32 v140, v140, v141
    v_min_f32 v142, v142, v143
    v_mul_f32 v136, v136, v128
    v_mul_f32 v138, v138, v128
    v_mul_f32 v140, v140, v130
    v_mul_f32 v142, v142, v130
    v_pk_fma_f32 v[32:33], v[0:1], v[128:129], v[138:139] op_sel_hi:[1,0,0] neg_lo:[1,0,0] neg_hi:[1,0,0]
    v_pk_fma_f32 v[34:35], v[2:3], v[128:129], v[138:139] op_sel_hi:[1,0,0] neg_lo:[1,0,0] neg_hi:[1,0,0]
    v_pk_fma_f32 v[36:37], v[4:5], v[128:129], v[138:139] op_sel_hi:[1,0,0] neg_lo:[1,0,0] neg_hi:[1,0,0]
    s_lshl_b32 s3, s26, 2
    s_add_u32 s3, s3, 160832
    v_mov_b32_e64 v116, s3
    s_mov_b64 exec, 1
    s_waitcnt lgkmcnt(0)
    ds_write_b32 v116, v114
    s_mov_b64 exec, -1
    v_pk_fma_f32 v[38:39], v[6:7], v[128:129], v[138:139] op_sel_hi:[1,0,0] neg_lo:[1,0,0] neg_hi:[1,0,0]
    v_pk_fma_f32 v[40:41], v[8:9], v[128:129], v[138:139] op_sel_hi:[1,0,0] neg_lo:[1,0,0] neg_hi:[1,0,0]
    v_pk_fma_f32 v[42:43], v[10:11], v[128:129], v[138:139] op_sel_hi:[1,0,0] neg_lo:[1,0,0] neg_hi:[1,0,0]
    v_pk_fma_f32 v[44:45], v[12:13], v[128:129], v[138:139] op_sel_hi:[1,0,0] neg_lo:[1,0,0] neg_hi:[1,0,0]
    v_pk_fma_f32 v[0:1], v[0:1], v[128:129], v[136:137] op_sel_hi:[1,0,0] neg_lo:[0,0,1] neg_hi:[0,0,1]
    v_pk_fma_f32 v[2:3], v[2:3], v[128:129], v[136:137] op_sel_hi:[1,0,0] neg_lo:[0,0,1] neg_hi:[0,0,1]
    v_pk_fma_f32 v[4:5], v[4:5], v[128:129], v[136:137] op_sel_hi:[1,0,0] neg_lo:[0,0,1] neg_hi:[0,0,1]
    v_pk_fma_f32 v[6:7], v[6:7], v[128:129], v[136:137] op_sel_hi:[1,0,0] neg_lo:[0,0,1] neg_hi:[0,0,1]
    v_pk_fma_f32 v[8:9], v[8:9], v[128:129], v[136:137] op_sel_hi:[1,0,0] neg_lo:[0,0,1] neg_hi:[0,0,1]
    v_pk_fma_f32 v[10:11], v[10:11], v[128:129], v[136:137] op_sel_hi:[1,0,0] neg_lo:[0,0,1] neg_hi:[0,0,1]
    v_pk_fma_f32 v[12:13], v[12:13], v[128:129], v[136:137] op_sel_hi:[1,0,0] neg_lo:[0,0,1] neg_hi:[0,0,1]
    v_exp_f32 v32, v32
    v_exp_f32 v33, v33
    v_exp_f32 v34, v34
    v_exp_f32 v35, v35
    v_exp_f32 v36, v36
    v_exp_f32 v37, v37
    v_exp_f32 v38, v38
    v_exp_f32 v39, v39
    v_exp_f32 v40, v40
    v_exp_f32 v41, v41
    v_exp_f32 v42, v42
    v_exp_f32 v43, v43
    v_exp_f32 v44, v44
    v_exp_f32 v45, v45
    v_exp_f32 v0, v0
    v_exp_f32 v1, v1
    v_exp_f32 v2, v2
    v_exp_f32 v3, v3
    v_exp_f32 v4, v4
    v_exp_f32 v5, v5
    v_exp_f32 v6, v6
    v_exp_f32 v7, v7
    v_exp_f32 v8, v8
    v_exp_f32 v9, v9
    v_exp_f32 v10, v10
    v_exp_f32 v11, v11
    v_exp_f32 v12, v12
    v_exp_f32 v13, v13
    v_pk_add_f32 v[106:107], v[32:33], v[34:35]
    v_pk_add_f32 v[104:105], v[0:1], v[2:3]
    v_pk_add_f32 v[106:107], v[106:107], v[36:37]
    v_pk_add_f32 v[104:105], v[104:105], v[4:5]
    v_pk_add_f32 v[106:107], v[106:107], v[38:39]
    v_pk_add_f32 v[104:105], v[104:105], v[6:7]
    v_pk_add_f32 v[106:107], v[106:107], v[40:41]
    v_pk_add_f32 v[104:105], v[104:105], v[8:9]
    v_pk_add_f32 v[106:107], v[106:107], v[42:43]
    v_pk_add_f32 v[104:105], v[104:105], v[10:11]
    v_pk_add_f32 v[106:107], v[106:107], v[44:45]
    v_pk_add_f32 v[104:105], v[104:105], v[12:13]
    v_add_f32 v138, v106, v107
    v_add_f32 v139, v106, v107
    v_add_f32 v136, v104, v105
    v_add_f32 v137, v104, v105
    s_waitcnt lgkmcnt(0)
    v_permlane32_swap_b32 v138, v139
    v_permlane32_swap_b32 v136, v137
    v_add_f32 v138, v138, v139
    v_add_f32 v136, v136, v137
    v_rcp_f32 v138, v138
    v_rcp_f32 v136, v136
    v_mov_b32 v71, 0
    v_mov_b32_e64 v79, 0
    v_pk_mul_f32 v[0:1], v[0:1], v[136:137] op_sel_hi:[1,0]
    v_pk_mul_f32 v[2:3], v[2:3], v[136:137] op_sel_hi:[1,0]
    v_pk_mul_f32 v[4:5], v[4:5], v[136:137] op_sel_hi:[1,0]
    v_pk_mul_f32 v[6:7], v[6:7], v[136:137] op_sel_hi:[1,0]
    v_pk_mul_f32 v[8:9], v[8:9], v[136:137] op_sel_hi:[1,0]
    v_pk_mul_f32 v[10:11], v[10:11], v[136:137] op_sel_hi:[1,0]
    v_pk_mul_f32 v[12:13], v[12:13], v[136:137] op_sel_hi:[1,0]
    v_pk_mul_f32 v[32:33], v[32:33], v[138:139] op_sel_hi:[1,0]
    v_pk_mul_f32 v[34:35], v[34:35], v[138:139] op_sel_hi:[1,0]
    v_pk_mul_f32 v[36:37], v[36:37], v[138:139] op_sel_hi:[1,0]
    v_pk_mul_f32 v[38:39], v[38:39], v[138:139] op_sel_hi:[1,0]
    v_pk_mul_f32 v[40:41], v[40:41], v[138:139] op_sel_hi:[1,0]
    v_pk_mul_f32 v[42:43], v[42:43], v[138:139] op_sel_hi:[1,0]
    v_pk_mul_f32 v[44:45], v[44:45], v[138:139] op_sel_hi:[1,0]
    v_cvt_pk_bf16_f32 v64, v0, v1
    v_cvt_pk_bf16_f32 v65, v2, v3
    v_cvt_pk_bf16_f32 v66, v4, v5
    v_cvt_pk_bf16_f32 v67, v6, v7
    v_cvt_pk_bf16_f32 v68, v8, v9
    v_cvt_pk_bf16_f32 v69, v10, v11
    v_cvt_pk_bf16_f32 v70, v12, v13
    v_cvt_pk_bf16_f32 v72, v32, v33
    v_cvt_pk_bf16_f32 v73, v34, v35
    v_cvt_pk_bf16_f32 v74, v36, v37
    v_cvt_pk_bf16_f32 v75, v38, v39
    v_cvt_pk_bf16_f32 v76, v40, v41
    v_cvt_pk_bf16_f32 v77, v42, v43
    v_cvt_pk_bf16_f32 v78, v44, v45
    ds_write_b128 v100, v[64:67] offset:0
    ds_write_b128 v100, v[68:71] offset:16
    ds_write_b128 v100, v[72:75] offset:64
    ds_write_b128 v100, v[76:79] offset:80
    v_pk_fma_f32 v[48:49], v[16:17], v[130:131], v[142:143] op_sel_hi:[1,0,0] neg_lo:[1,0,0] neg_hi:[1,0,0]
    v_pk_fma_f32 v[50:51], v[18:19], v[130:131], v[142:143] op_sel_hi:[1,0,0] neg_lo:[1,0,0] neg_hi:[1,0,0]
    v_pk_fma_f32 v[52:53], v[20:21], v[130:131], v[142:143] op_sel_hi:[1,0,0] neg_lo:[1,0,0] neg_hi:[1,0,0]
    v_pk_fma_f32 v[54:55], v[22:23], v[130:131], v[142:143] op_sel_hi:[1,0,0] neg_lo:[1,0,0] neg_hi:[1,0,0]
    v_pk_fma_f32 v[56:57], v[24:25], v[130:131], v[142:143] op_sel_hi:[1,0,0] neg_lo:[1,0,0] neg_hi:[1,0,0]
    v_pk_fma_f32 v[58:59], v[26:27], v[130:131], v[142:143] op_sel_hi:[1,0,0] neg_lo:[1,0,0] neg_hi:[1,0,0]
    v_pk_fma_f32 v[60:61], v[28:29], v[130:131], v[142:143] op_sel_hi:[1,0,0] neg_lo:[1,0,0] neg_hi:[1,0,0]
    v_pk_fma_f32 v[16:17], v[16:17], v[130:131], v[140:141] op_sel_hi:[1,0,0] neg_lo:[0,0,1] neg_hi:[0,0,1]
    v_pk_fma_f32 v[18:19], v[18:19], v[130:131], v[140:141] op_sel_hi:[1,0,0] neg_lo:[0,0,1] neg_hi:[0,0,1]
    v_pk_fma_f32 v[20:21], v[20:21], v[130:131], v[140:141] op_sel_hi:[1,0,0] neg_lo:[0,0,1] neg_hi:[0,0,1]
    v_pk_fma_f32 v[22:23], v[22:23], v[130:131], v[140:141] op_sel_hi:[1,0,0] neg_lo:[0,0,1] neg_hi:[0,0,1]
    v_pk_fma_f32 v[24:25], v[24:25], v[130:131], v[140:141] op_sel_hi:[1,0,0] neg_lo:[0,0,1] neg_hi:[0,0,1]
    v_pk_fma_f32 v[26:27], v[26:27], v[130:131], v[140:141] op_sel_hi:[1,0,0] neg_lo:[0,0,1] neg_hi:[0,0,1]
    v_pk_fma_f32 v[28:29], v[28:29], v[130:131], v[140:141] op_sel_hi:[1,0,0] neg_lo:[0,0,1] neg_hi:[0,0,1]
    v_exp_f32 v48, v48
    v_exp_f32 v49, v49
    v_exp_f32 v50, v50
    v_exp_f32 v51, v51
    v_exp_f32 v52, v52
    v_exp_f32 v53, v53
    v_exp_f32 v54, v54
    v_exp_f32 v55, v55
    v_exp_f32 v56, v56
    v_exp_f32 v57, v57
    v_exp_f32 v58, v58
    v_exp_f32 v59, v59
    v_exp_f32 v60, v60
    v_exp_f32 v61, v61
    v_exp_f32 v16, v16
    v_exp_f32 v17, v17
    v_exp_f32 v18, v18
    v_exp_f32 v19, v19
    v_exp_f32 v20, v20
    v_exp_f32 v21, v21
    v_exp_f32 v22, v22
    v_exp_f32 v23, v23
    v_exp_f32 v24, v24
    v_exp_f32 v25, v25
    v_exp_f32 v26, v26
    v_exp_f32 v27, v27
    v_exp_f32 v28, v28
    v_exp_f32 v29, v29
    v_pk_add_f32 v[110:111], v[48:49], v[50:51]
    v_pk_add_f32 v[108:109], v[16:17], v[18:19]
    v_pk_add_f32 v[110:111], v[110:111], v[52:53]
    v_pk_add_f32 v[108:109], v[108:109], v[20:21]
    v_pk_add_f32 v[110:111], v[110:111], v[54:55]
    v_pk_add_f32 v[108:109], v[108:109], v[22:23]
    v_pk_add_f32 v[110:111], v[110:111], v[56:57]
    v_pk_add_f32 v[108:109], v[108:109], v[24:25]
    v_pk_add_f32 v[110:111], v[110:111], v[58:59]
    v_pk_add_f32 v[108:109], v[108:109], v[26:27]
    v_pk_add_f32 v[110:111], v[110:111], v[60:61]
    v_pk_add_f32 v[108:109], v[108:109], v[28:29]
    v_add_f32 v142, v110, v111
    v_add_f32 v143, v110, v111
    v_add_f32 v140, v108, v109
    v_add_f32 v141, v108, v109
    s_waitcnt lgkmcnt(0)
    v_permlane32_swap_b32 v142, v143
    v_permlane32_swap_b32 v140, v141
    v_add_f32 v142, v142, v143
    v_add_f32 v140, v140, v141
    v_rcp_f32 v142, v142
    v_rcp_f32 v140, v140
    v_mov_b32 v71, 0
    v_mov_b32_e64 v79, 0
    v_pk_mul_f32 v[16:17], v[16:17], v[140:141] op_sel_hi:[1,0]
    v_pk_mul_f32 v[18:19], v[18:19], v[140:141] op_sel_hi:[1,0]
    v_pk_mul_f32 v[20:21], v[20:21], v[140:141] op_sel_hi:[1,0]
    v_pk_mul_f32 v[22:23], v[22:23], v[140:141] op_sel_hi:[1,0]
    v_pk_mul_f32 v[24:25], v[24:25], v[140:141] op_sel_hi:[1,0]
    v_pk_mul_f32 v[26:27], v[26:27], v[140:141] op_sel_hi:[1,0]
    v_pk_mul_f32 v[28:29], v[28:29], v[140:141] op_sel_hi:[1,0]
    v_pk_mul_f32 v[48:49], v[48:49], v[142:143] op_sel_hi:[1,0]
    v_pk_mul_f32 v[50:51], v[50:51], v[142:143] op_sel_hi:[1,0]
    v_pk_mul_f32 v[52:53], v[52:53], v[142:143] op_sel_hi:[1,0]
    v_pk_mul_f32 v[54:55], v[54:55], v[142:143] op_sel_hi:[1,0]
    v_pk_mul_f32 v[56:57], v[56:57], v[142:143] op_sel_hi:[1,0]
    v_pk_mul_f32 v[58:59], v[58:59], v[142:143] op_sel_hi:[1,0]
    v_pk_mul_f32 v[60:61], v[60:61], v[142:143] op_sel_hi:[1,0]
    v_cvt_pk_bf16_f32 v64, v16, v17
    v_cvt_pk_bf16_f32 v65, v18, v19
    v_cvt_pk_bf16_f32 v66, v20, v21
    v_cvt_pk_bf16_f32 v67, v22, v23
    v_cvt_pk_bf16_f32 v68, v24, v25
    v_cvt_pk_bf16_f32 v69, v26, v27
    v_cvt_pk_bf16_f32 v70, v28, v29
    v_cvt_pk_bf16_f32 v72, v48, v49
    v_cvt_pk_bf16_f32 v73, v50, v51
    v_cvt_pk_bf16_f32 v74, v52, v53
    v_cvt_pk_bf16_f32 v75, v54, v55
    v_cvt_pk_bf16_f32 v76, v56, v57
    v_cvt_pk_bf16_f32 v77, v58, v59
    v_cvt_pk_bf16_f32 v78, v60, v61
    ds_write_b128 v100, v[64:67] offset:6656
    ds_write_b128 v100, v[68:71] offset:6672
    ds_write_b128 v100, v[72:75] offset:6720
    ds_write_b128 v100, v[76:79] offset:6736
    s_lshl_b32 s3, s26, 2
    s_add_u32 s3, s3, 160768
    v_mov_b32 v116, s3
    s_mov_b64 exec, 1
    s_waitcnt lgkmcnt(0)
    ds_write_b32 v116, v114
    s_mov_b64 exec, -1
    v_mov_b32 v116, 160768
L_sy_5:
    ds_read_b128 v[80:83], v116
    s_waitcnt lgkmcnt(0)
    v_min3_u32 v80, v80, v81, v82
    v_min_u32_e64 v80, v80, v83
    v_cmp_eq_u32 vcc, 0, v80
    s_cbranch_vccnz L_sy_5
    ds_read_b64_tr_b16 v[0:1], v101 offset:0
    ds_read_b64_tr_b16 v[4:5], v102 offset:128
    ds_read_b64_tr_b16 v[8:9], v102 offset:136
    ds_read_b64_tr_b16 v[2:3], v101 offset:416
    ds_read_b64_tr_b16 v[6:7], v102 offset:544
    ds_read_b64_tr_b16 v[10:11], v102 offset:552
    ds_read_b64_tr_b16 v[12:13], v101 offset:6656
    ds_read_b64_tr_b16 v[16:17], v102 offset:6784
    ds_read_b64_tr_b16 v[20:21], v102 offset:6792
    ds_read_b64_tr_b16 v[14:15], v101 offset:7072
    ds_read_b64_tr_b16 v[18:19], v102 offset:7200
    ds_read_b64_tr_b16 v[22:23], v102 offset:7208
    ds_read_b64_tr_b16 v[24:25], v101 offset:13312
    ds_read_b64_tr_b16 v[28:29], v102 offset:13440
    ds_read_b64_tr_b16 v[32:33], v102 offset:13448
    ds_read_b64_tr_b16 v[26:27], v101 offset:13728
    ds_read_b64_tr_b16 v[30:31], v102 offset:13856
    ds_read_b64_tr_b16 v[34:35], v102 offset:13864
    s_waitcnt lgkmcnt(12)
    s_nop 0
    v_mfma_f32_16x16x32_bf16 v[136:139], v[0:3], v[4:7], 0
    v_mfma_f32_16x16x32_bf16 v[140:143], v[0:3], v[8:11], 0
    ds_read_b64_tr_b16 v[36:37], v101 offset:19968
    ds_read_b64_tr_b16 v[40:41], v102 offset:20096
    ds_read_b64_tr_b16 v[44:45], v102 offset:20104
    ds_read_b64_tr_b16 v[38:39], v101 offset:20384
    ds_read_b64_tr_b16 v[42:43], v102 offset:20512
    ds_read_b64_tr_b16 v[46:47], v102 offset:20520
    s_waitcnt lgkmcnt(12)
    v_mfma_f32_16x16x32_bf16 v[136:139], v[12:15], v[16:19], v[136:139]
    v_mfma_f32_16x16x32_bf16 v[140:143], v[12:15], v[20:23], v[140:143]
    ds_read_b64_tr_b16 v[48:49], v101 offset:26624
    ds_read_b64_tr_b16 v[52:53], v102 offset:26752
    ds_read_b64_tr_b16 v[56:57], v102 offset:26760
    ds_read_b64_tr_b16 v[50:51], v101 offset:27040
    ds_read_b64_tr_b16 v[54:55], v102 offset:27168
    ds_read_b64_tr_b16 v[58:59], v102 offset:27176
    s_waitcnt lgkmcnt(12)
    v_mfma_f32_16x16x32_bf16 v[136:139], v[24:27], v[28:31], v[136:139]
    v_mfma_f32_16x16x32_bf16 v[140:143], v[24:27], v[32:35], v[140:143]
    ds_read_b64_tr_b16 v[0:1], v101 offset:33280
    ds_read_b64_tr_b16 v[4:5], v102 offset:33408
    ds_read_b64_tr_b16 v[8:9], v102 offset:33416
    ds_read_b64_tr_b16 v[2:3], v101 offset:33696
    ds_read_b64_tr_b16 v[6:7], v102 offset:33824
    ds_read_b64_tr_b16 v[10:11], v102 offset:33832
    s_waitcnt lgkmcnt(12)
    v_mfma_f32_16x16x32_bf16 v[136:139], v[36:39], v[40:43], v[136:139]
    v_mfma_f32_16x16x32_bf16 v[140:143], v[36:39], v[44:47], v[140:143]
    ds_read_b64_tr_b16 v[12:13], v101 offset:39936
    ds_read_b64_tr_b16 v[16:17], v102 offset:40064
    ds_read_b64_tr_b16 v[20:21], v102 offset:40072
    ds_read_b64_tr_b16 v[14:15], v101 offset:40352
    ds_read_b64_tr_b16 v[18:19], v102 offset:40480
    ds_read_b64_tr_b16 v[22:23], v102 offset:40488
    s_waitcnt lgkmcnt(12)
    v_mfma_f32_16x16x32_bf16 v[136:139], v[48:51], v[52:55], v[136:139]
    v_mfma_f32_16x16x32_bf16 v[140:143], v[48:51], v[56:59], v[140:143]
    ds_read_b64_tr_b16 v[24:25], v101 offset:46592
    ds_read_b64_tr_b16 v[28:29], v102 offset:46720
    ds_read_b64_tr_b16 v[32:33], v102 offset:46728
    ds_read_b64_tr_b16 v[26:27], v101 offset:47008
    ds_read_b64_tr_b16 v[30:31], v102 offset:47136
    ds_read_b64_tr_b16 v[34:35], v102 offset:47144
    s_waitcnt lgkmcnt(12)
    v_mfma_f32_16x16x32_bf16 v[136:139], v[0:3], v[4:7], v[136:139]
    v_mfma_f32_16x16x32_bf16 v[140:143], v[0:3], v[8:11], v[140:143]
    s_waitcnt lgkmcnt(6)
    v_mfma_f32_16x16x32_bf16 v[136:139], v[12:15], v[16:19], v[136:139]
    v_mfma_f32_16x16x32_bf16 v[140:143], v[12:15], v[20:23], v[140:143]
    s_waitcnt lgkmcnt(0)
    v_mfma_f32_16x16x32_bf16 v[136:139], v[24:27], v[28:31], v[136:139]
    v_mfma_f32_16x16x32_bf16 v[140:143], v[24:27], v[32:35], v[140:143]
    s_lshl_b32 s3, s26, 2
    s_add_u32 s3, s3, 160784
    v_mov_b32 v116, s3
    s_mov_b64 exec, 1
    s_waitcnt lgkmcnt(0)
    ds_write_b32 v116, v114
    s_mov_b64 exec, -1
    s_add_u32 s3, s34, 0
    s_load_dword s69, s[52:53], s3 glc
    v_cvt_pk_bf16_f32 v136, v136, v137
    v_cvt_pk_bf16_f32 v137, v138, v139
    v_cvt_pk_bf16_f32 v138, v140, v141
    v_cvt_pk_bf16_f32 v139, v142, v143
    s_nop 0
    v_permlane32_swap_b32 v136, v138
    v_permlane32_swap_b32 v137, v139
    buffer_store_dwordx4 v[136:139], v103, s[52:55], s1 offen sc1
    s_setprio 0
    s_waitcnt lgkmcnt(0)
    s_cmp_lt_u32 s69, 8
    s_cbranch_scc1 L_os_6
    s_bfe_u32 s36, s43, 0x40000
    s_lshl_b32 s36, s36, 12
    s_add_u32 s36, s36, s33
    buffer_load_dwordx4 v[64:67], v112, s[52:55], s36 offen offset:0 sc1
    buffer_load_dwordx4 v[68:71], v112, s[52:55], s36 offen offset:1024 sc1
    buffer_load_dwordx4 v[72:75], v112, s[52:55], s36 offen offset:2048 sc1
    buffer_load_dwordx4 v[76:79], v112, s[52:55], s36 offen offset:3072 sc1
    s_bfe_u32 s36, s43, 0x40004
    s_lshl_b32 s36, s36, 12
    s_add_u32 s36, s36, s33
    buffer_load_dwordx4 v[80:83], v112, s[52:55], s36 offen offset:0 sc1
    buffer_load_dwordx4 v[84:87], v112, s[52:55], s36 offen offset:1024 sc1
    buffer_load_dwordx4 v[88:91], v112, s[52:55], s36 offen offset:2048 sc1
    buffer_load_dwordx4 v[92:95], v112, s[52:55], s36 offen offset:3072 sc1
    s_waitcnt vmcnt(8)
    s_mov_b32 s42, 1
    s_atomic_add s42, s[52:53], s17
    s_branch L_tailP
L_os_6:
    s_waitcnt vmcnt(0)
    s_mov_b32 s42, 1
    s_atomic_add s42, s[52:53], s17
    s_branch L_waitP
L_QF:
    v_lshlrev_b32_e64 v19, 7, v16
    v_lshl_add_u32 v19, v14, 3, v19
    v_add_u32 v19, 102400, v19
    v_lshrrev_b32_e64 v20, 1, v13
    v_lshl_add_u32 v20, v15, 1, v20
    v_xor_b32_e64 v12, 0, v20
    v_lshl_add_u32 v98, v12, 5, v19
    v_xor_b32_e64 v12, 1, v20
    v_lshl_add_u32 v99, v12, 5, v19
    v_xor_b32_e64 v12, 2, v20
    v_lshl_add_u32 v100, v12, 5, v19
    s_add_u32 s76, s76, 1
    s_cmp_eq_u32 s76, 7
    s_cselect_b32 s76, 0, s76
    s_mul_i32 s6, s76, 172032
    s_add_u32 s6, s6, s78
    s_add_u32 m0, s11, 20736
    s_mul_i32 s8, s76, 229376
    buffer_load_dwordx4 v101, s[32:35], s6 offen lds
    s_add_u32 m0, s12, 20736
    s_add_u32 s8, s8, s79
    buffer_load_dwordx4 v102, s[36:39], s8 offen lds
    s_add_u32 s9, s8, 27648
    buffer_load_dwordx4 v103, s[36:39], s9 offen offset:1024 lds
    s_add_u32 m0, s12, 28928
    s_nop 0
    buffer_load_dwordx4 v102, s[40:43], s8 offen lds
    buffer_load_dwordx4 v103, s[40:43], s9 offen offset:1024 lds
    s_waitcnt vmcnt(5) lgkmcnt(0)
    s_barrier
    ds_read_b64_tr_b16 a[56:57], v98 offset:0
    ds_read_b64_tr_b16 a[58:59], v98 offset:512
    ds_read_b128 a[80:83], v96 offset:0
    ds_read_b128 a[84:87], v96 offset:2048
    ds_read_b128 a[88:91], v96 offset:4096
    ds_read_b128 a[92:95], v96 offset:6144
    ds_read_b64_tr_b16 a[60:61], v99 offset:0
    ds_read_b64_tr_b16 a[62:63], v99 offset:512
    ds_read_b64_tr_b16 a[64:65], v100 offset:0
    ds_read_b64_tr_b16 a[66:67], v100 offset:512
    s_setprio 1
    s_waitcnt lgkmcnt(0)
    v_mfma_f32_16x16x32_bf16 v[0:3], a[56:59], a[80:83], 0
    v_mfma_f32_16x16x32_bf16 v[4:7], a[56:59], a[84:87], 0
    ds_read_b64_tr_b16 a[68:69], v98 offset:8192
    ds_read_b64_tr_b16 a[70:71], v98 offset:8704
    ds_read_b64_tr_b16 a[72:73], v99 offset:8192
    ds_read_b64_tr_b16 a[74:75], v99 offset:8704
    v_mfma_f32_16x16x32_bf16 v[16:19], a[56:59], a[88:91], 0
    v_mfma_f32_16x16x32_bf16 v[20:23], a[56:59], a[92:95], 0
    ds_read_b64_tr_b16 a[76:77], v100 offset:8192
    ds_read_b64_tr_b16 a[78:79], v100 offset:8704
    ds_read_b128 a[96:99], v97 offset:0
    ds_read_b128 a[100:103], v97 offset:2048
    s_add_u32 s76, s76, 1
    s_cmp_eq_u32 s76, 7
    s_cselect_b32 s76, 0, s76
    s_mul_i32 s6, s76, 172032
    s_add_u32 s6, s6, s78
    s_add_u32 m0, s11, 41472
    s_mul_i32 s8, s76, 229376
    buffer_load_dwordx4 v101, s[32:35], s6 offen lds
    s_mov_b32 s54, 268435456
    s_mov_b32 s55, 0x20000
    s_lshl_b32 s16, s23, 2
    s_add_u32 s16, s16, s72
    v_mfma_f32_16x16x32_bf16 v[32:35], a[60:63], a[80:83], 0
    v_mfma_f32_16x16x32_bf16 v[36:39], a[60:63], a[84:87], 0
    s_mul_i32 s16, s16, 512
    s_add_u32 s16, s16, 13631488
    s_mul_i32 s23, s23, 294912
    v_mov_b32_e64 v115, 1073741824
    v_mfma_f32_16x16x32_bf16 v[48:51], a[60:63], a[88:91], 0
    v_mfma_f32_16x16x32_bf16 v[52:55], a[60:63], a[92:95], 0
    s_add_u32 m0, s12, 41472
    s_add_u32 s8, s8, s79
    buffer_load_dwordx4 v102, s[36:39], s8 offen lds
    v_mov_b32 v114, 1
    s_mov_b32 s46, 1605632
    s_mov_b32 s47, 0x20000
    v_mfma_f32_16x16x32_bf16 v[64:67], a[64:67], a[80:83], 0
    v_mfma_f32_16x16x32_bf16 v[68:71], a[64:67], a[84:87], 0
    s_mov_b32 s50, 401408
    s_mov_b32 s51, 0x20000
    s_mov_b32 s58, 1835008
    s_mov_b32 s59, 0x20000
    v_mfma_f32_16x16x32_bf16 v[80:83], a[64:67], a[88:91], 0
    v_mfma_f32_16x16x32_bf16 v[84:87], a[64:67], a[92:95], 0
    s_and_b32 s20, s2, 7
    s_lshl_b32 s20, s20, 2
    s_bfe_u32 s21, s2, 0x20003
    s_waitcnt lgkmcnt(0)
    s_nop 0
    v_mfma_f32_16x16x32_bf16 v[8:11], a[68:71], a[80:83], 0
    v_mfma_f32_16x16x32_bf16 v[12:15], a[68:71], a[84:87], 0
    ds_read_b64_tr_b16 a[56:57], v98 offset:4096
    ds_read_b64_tr_b16 a[58:59], v98 offset:4608
    ds_read_b64_tr_b16 a[60:61], v99 offset:4096
    ds_read_b64_tr_b16 a[62:63], v99 offset:4608
    v_mfma_f32_16x16x32_bf16 v[24:27], a[68:71], a[88:91], 0
    v_mfma_f32_16x16x32_bf16 v[28:31], a[68:71], a[92:95], 0
    ds_read_b64_tr_b16 a[64:65], v100 offset:4096
    ds_read_b64_tr_b16 a[66:67], v100 offset:4608
    ds_read_b128 a[104:107], v97 offset:4096
    ds_read_b128 a[108:111], v97 offset:6144
    s_add_u32 s9, s8, 27648
    buffer_load_dwordx4 v103, s[36:39], s9 offen offset:1024 lds
    s_or_b32 s20, s20, s21
    s_lshr_b32 s21, s2, 5
    s_lshl_b32 s22, s21, 7
    s_mul_i32 s3, s26, 401408
    s_add_u32 s22, s22, s3
    v_mfma_f32_16x16x32_bf16 v[40:43], a[72:75], a[80:83], 0
    v_mfma_f32_16x16x32_bf16 v[44:47], a[72:75], a[84:87], 0
    v_lshrrev_b32 v124, 4, v112
    v_lshrrev_b32 v125, 3, v124
    v_mul_u32_u24 v126, 896, v125
    v_mfma_f32_16x16x32_bf16 v[56:59], a[72:75], a[88:91], 0
    v_mfma_f32_16x16x32_bf16 v[60:63], a[72:75], a[92:95], 0
    v_and_b32 v125, 2, v125
    v_lshlrev_b32 v125, 1, v125
    v_and_b32_e64 v127, 7, v124
    v_mfma_f32_16x16x32_bf16 v[72:75], a[76:79], a[80:83], 0
    v_mfma_f32_16x16x32_bf16 v[76:79], a[76:79], a[84:87], 0
    v_xor_b32_e64 v125, v125, v127
    v_lshl_add_u32 v119, v125, 4, v126
    s_cmp_eq_u32 s21, 7
    s_cselect_b32 s3, 1073741824, 0
    v_add_u32 v119, s3, v119
    v_mfma_f32_16x16x32_bf16 v[88:91], a[76:79], a[88:91], 0
    v_mfma_f32_16x16x32_bf16 v[92:95], a[76:79], a[92:95], 0
    v_add_u32 v120, 6144, v119
    v_add_u32 v121, 12288, v119
    s_waitcnt lgkmcnt(0)
    v_mfma_f32_16x16x32_bf16 v[0:3], a[56:59], a[96:99], v[0:3]
    v_mfma_f32_16x16x32_bf16 v[4:7], a[56:59], a[100:103], v[4:7]
    ds_read_b64_tr_b16 a[68:69], v98 offset:12288
    ds_read_b64_tr_b16 a[70:71], v98 offset:12800
    ds_read_b64_tr_b16 a[72:73], v99 offset:12288
    ds_read_b64_tr_b16 a[74:75], v99 offset:12800
    v_mfma_f32_16x16x32_bf16 v[16:19], a[56:59], a[104:107], v[16:19]
    v_mfma_f32_16x16x32_bf16 v[20:23], a[56:59], a[108:111], v[20:23]
    ds_read_b64_tr_b16 a[76:77], v100 offset:12288
    ds_read_b64_tr_b16 a[78:79], v100 offset:12800
    s_add_u32 m0, s12, 49664
    s_nop 0
    buffer_load_dwordx4 v102, s[40:43], s8 offen lds
    v_add_u32 v122, 18432, v119
    v_bfe_u32 v125, v124, 2, 2
    v_lshrrev_b32 v126, 5, v124
    v_mfma_f32_16x16x32_bf16 v[32:35], a[60:63], a[96:99], v[32:35]
    v_mfma_f32_16x16x32_bf16 v[36:39], a[60:63], a[100:103], v[36:39]
    v_lshl_add_u32 v126, v126, 3, v125
    v_bfe_u32 v127, v124, 4, 1
    v_and_b32_e64 v128, 3, v124
    v_mfma_f32_16x16x32_bf16 v[48:51], a[60:63], a[104:107], v[48:51]
    v_mfma_f32_16x16x32_bf16 v[52:55], a[60:63], a[108:111], v[52:55]
    v_lshl_add_u32 v127, v127, 2, v128
    v_lshlrev_b32_e64 v128, 7, v126
    v_lshl_add_u32 v128, v127, 3, v128
    v_mfma_f32_16x16x32_bf16 v[64:67], a[64:67], a[96:99], v[64:67]
    v_mfma_f32_16x16x32_bf16 v[68:71], a[64:67], a[100:103], v[68:71]
    v_add_u32 v128, s10, v128
    v_lshrrev_b32 v125, 1, v125
    v_lshl_add_u32 v117, v125, 6, v128
    v_mfma_f32_16x16x32_bf16 v[80:83], a[64:67], a[104:107], v[80:83]
    v_mfma_f32_16x16x32_bf16 v[84:87], a[64:67], a[108:111], v[84:87]
    v_xor_b32 v125, 1, v125
    v_lshl_add_u32 v118, v125, 6, v128
    s_waitcnt lgkmcnt(0)
    v_mfma_f32_16x16x32_bf16 v[8:11], a[68:71], a[96:99], v[8:11]
    v_mfma_f32_16x16x32_bf16 v[12:15], a[68:71], a[100:103], v[12:15]
    s_waitcnt vmcnt(4)
    s_barrier
    ds_read_b64_tr_b16 a[56:57], v98 offset:20736
    ds_read_b64_tr_b16 a[58:59], v98 offset:21248
    ds_read_b128 a[80:83], v96 offset:8192
    ds_read_b128 a[84:87], v96 offset:10240
    v_mfma_f32_16x16x32_bf16 v[24:27], a[68:71], a[104:107], v[24:27]
    v_mfma_f32_16x16x32_bf16 v[28:31], a[68:71], a[108:111], v[28:31]
    ds_read_b128 a[88:91], v96 offset:12288
    ds_read_b128 a[92:95], v96 offset:14336
    ds_read_b64_tr_b16 a[60:61], v99 offset:20736
    ds_read_b64_tr_b16 a[62:63], v99 offset:21248
    buffer_load_dwordx4 v103, s[40:43], s9 offen offset:1024 lds
    v_mfma_f32_16x16x32_bf16 v[40:43], a[72:75], a[96:99], v[40:43]
    v_mfma_f32_16x16x32_bf16 v[44:47], a[72:75], a[100:103], v[44:47]
    ds_read_b64_tr_b16 a[64:65], v100 offset:20736
    ds_read_b64_tr_b16 a[66:67], v100 offset:21248
    v_mfma_f32_16x16x32_bf16 v[56:59], a[72:75], a[104:107], v[56:59]
    v_mfma_f32_16x16x32_bf16 v[60:63], a[72:75], a[108:111], v[60:63]
    v_mfma_f32_16x16x32_bf16 v[72:75], a[76:79], a[96:99], v[72:75]
    v_mfma_f32_16x16x32_bf16 v[76:79], a[76:79], a[100:103], v[76:79]
    v_mfma_f32_16x16x32_bf16 v[88:91], a[76:79], a[104:107], v[88:91]
    v_mfma_f32_16x16x32_bf16 v[92:95], a[76:79], a[108:111], v[92:95]
    s_waitcnt lgkmcnt(0)
    s_nop 0
    v_mfma_f32_16x16x32_bf16 v[0:3], a[56:59], a[80:83], v[0:3]
    v_mfma_f32_16x16x32_bf16 v[4:7], a[56:59], a[84:87], v[4:7]
    ds_read_b64_tr_b16 a[68:69], v98 offset:28928
    ds_read_b64_tr_b16 a[70:71], v98 offset:29440
    ds_read_b64_tr_b16 a[72:73], v99 offset:28928
    ds_read_b64_tr_b16 a[74:75], v99 offset:29440
    v_mfma_f32_16x16x32_bf16 v[16:19], a[56:59], a[88:91], v[16:19]
    v_mfma_f32_16x16x32_bf16 v[20:23], a[56:59], a[92:95], v[20:23]
    ds_read_b64_tr_b16 a[76:77], v100 offset:28928
    ds_read_b64_tr_b16 a[78:79], v100 offset:29440
    ds_read_b128 a[96:99], v97 offset:8192
    ds_read_b128 a[100:103], v97 offset:10240
    s_add_u32 s76, s76, 1
    s_cmp_eq_u32 s76, 7
    s_cselect_b32 s76, 0, s76
    s_mul_i32 s6, s76, 172032
    s_add_u32 s6, s6, s78
    s_add_u32 m0, s11, 0
    s_mul_i32 s8, s76, 229376
    buffer_load_dwordx4 v101, s[32:35], s6 offen lds
    v_mfma_f32_16x16x32_bf16 v[32:35], a[60:63], a[80:83], v[32:35]
    v_mfma_f32_16x16x32_bf16 v[36:39], a[60:63], a[84:87], v[36:39]
    v_mfma_f32_16x16x32_bf16 v[48:51], a[60:63], a[88:91], v[48:51]
    v_mfma_f32_16x16x32_bf16 v[52:55], a[60:63], a[92:95], v[52:55]
    s_add_u32 m0, s12, 0
    s_add_u32 s8, s8, s79
    buffer_load_dwordx4 v102, s[36:39], s8 offen lds
    v_mfma_f32_16x16x32_bf16 v[64:67], a[64:67], a[80:83], v[64:67]
    v_mfma_f32_16x16x32_bf16 v[68:71], a[64:67], a[84:87], v[68:71]
    v_mfma_f32_16x16x32_bf16 v[80:83], a[64:67], a[88:91], v[80:83]
    v_mfma_f32_16x16x32_bf16 v[84:87], a[64:67], a[92:95], v[84:87]
    s_waitcnt lgkmcnt(0)
    v_mfma_f32_16x16x32_bf16 v[8:11], a[68:71], a[80:83], v[8:11]
    v_mfma_f32_16x16x32_bf16 v[12:15], a[68:71], a[84:87], v[12:15]
    ds_read_b64_tr_b16 a[56:57], v98 offset:24832
    ds_read_b64_tr_b16 a[58:59], v98 offset:25344
    ds_read_b64_tr_b16 a[60:61], v99 offset:24832
    ds_read_b64_tr_b16 a[62:63], v99 offset:25344
    v_mfma_f32_16x16x32_bf16 v[24:27], a[68:71], a[88:91], v[24:27]
    v_mfma_f32_16x16x32_bf16 v[28:31], a[68:71], a[92:95], v[28:31]
    ds_read_b64_tr_b16 a[64:65], v100 offset:24832
    ds_read_b64_tr_b16 a[66:67], v100 offset:25344
    ds_read_b128 a[104:107], v97 offset:12288
    ds_read_b128 a[108:111], v97 offset:14336
    s_add_u32 s9, s8, 27648
    buffer_load_dwordx4 v103, s[36:39], s9 offen offset:1024 lds
    v_mfma_f32_16x16x32_bf16 v[40:43], a[72:75], a[80:83], v[40:43]
    v_mfma_f32_16x16x32_bf16 v[44:47], a[72:75], a[84:87], v[44:47]
    v_mfma_f32_16x16x32_bf16 v[56:59], a[72:75], a[88:91], v[56:59]
    v_mfma_f32_16x16x32_bf16 v[60:63], a[72:75], a[92:95], v[60:63]
    v_mfma_f32_16x16x32_bf16 v[72:75], a[76:79], a[80:83], v[72:75]
    v_mfma_f32_16x16x32_bf16 v[76:79], a[76:79], a[84:87], v[76:79]
    v_mfma_f32_16x16x32_bf16 v[88:91], a[76:79], a[88:91], v[88:91]
    v_mfma_f32_16x16x32_bf16 v[92:95], a[76:79], a[92:95], v[92:95]
    s_waitcnt lgkmcnt(0)
    s_nop 0
    v_mfma_f32_16x16x32_bf16 v[0:3], a[56:59], a[96:99], v[0:3]
    v_mfma_f32_16x16x32_bf16 v[4:7], a[56:59], a[100:103], v[4:7]
    ds_read_b64_tr_b16 a[68:69], v98 offset:33024
    ds_read_b64_tr_b16 a[70:71], v98 offset:33536
    ds_read_b64_tr_b16 a[72:73], v99 offset:33024
    ds_read_b64_tr_b16 a[74:75], v99 offset:33536
    v_mfma_f32_16x16x32_bf16 v[16:19], a[56:59], a[104:107], v[16:19]
    v_mfma_f32_16x16x32_bf16 v[20:23], a[56:59], a[108:111], v[20:23]
    ds_read_b64_tr_b16 a[76:77], v100 offset:33024
    ds_read_b64_tr_b16 a[78:79], v100 offset:33536
    s_add_u32 m0, s12, 8192
    s_nop 0
    buffer_load_dwordx4 v102, s[40:43], s8 offen lds
    v_mfma_f32_16x16x32_bf16 v[32:35], a[60:63], a[96:99], v[32:35]
    v_mfma_f32_16x16x32_bf16 v[36:39], a[60:63], a[100:103], v[36:39]
    v_mfma_f32_16x16x32_bf16 v[48:51], a[60:63], a[104:107], v[48:51]
    v_mfma_f32_16x16x32_bf16 v[52:55], a[60:63], a[108:111], v[52:55]
    v_mfma_f32_16x16x32_bf16 v[64:67], a[64:67], a[96:99], v[64:67]
    v_mfma_f32_16x16x32_bf16 v[68:71], a[64:67], a[100:103], v[68:71]
    v_mfma_f32_16x16x32_bf16 v[80:83], a[64:67], a[104:107], v[80:83]
    v_mfma_f32_16x16x32_bf16 v[84:87], a[64:67], a[108:111], v[84:87]
    s_waitcnt lgkmcnt(0)
    v_mfma_f32_16x16x32_bf16 v[8:11], a[68:71], a[96:99], v[8:11]
    v_mfma_f32_16x16x32_bf16 v[12:15], a[68:71], a[100:103], v[12:15]
    s_waitcnt vmcnt(4)
    s_barrier
    ds_read_b64_tr_b16 a[56:57], v98 offset:41472
    ds_read_b64_tr_b16 a[58:59], v98 offset:41984
    ds_read_b128 a[80:83], v96 offset:16384
    ds_read_b128 a[84:87], v96 offset:18432
    v_mfma_f32_16x16x32_bf16 v[24:27], a[68:71], a[104:107], v[24:27]
    v_mfma_f32_16x16x32_bf16 v[28:31], a[68:71], a[108:111], v[28:31]
    ds_read_b128 a[88:91], v96 offset:20480
    ds_read_b128 a[92:95], v96 offset:22528
    ds_read_b64_tr_b16 a[60:61], v99 offset:41472
    ds_read_b64_tr_b16 a[62:63], v99 offset:41984
    buffer_load_dwordx4 v103, s[40:43], s9 offen offset:1024 lds
    v_mfma_f32_16x16x32_bf16 v[40:43], a[72:75], a[96:99], v[40:43]
    v_mfma_f32_16x16x32_bf16 v[44:47], a[72:75], a[100:103], v[44:47]
    ds_read_b64_tr_b16 a[64:65], v100 offset:41472
    ds_read_b64_tr_b16 a[66:67], v100 offset:41984
    v_mfma_f32_16x16x32_bf16 v[56:59], a[72:75], a[104:107], v[56:59]
    v_mfma_f32_16x16x32_bf16 v[60:63], a[72:75], a[108:111], v[60:63]
    v_mfma_f32_16x16x32_bf16 v[72:75], a[76:79], a[96:99], v[72:75]
    v_mfma_f32_16x16x32_bf16 v[76:79], a[76:79], a[100:103], v[76:79]
    v_mfma_f32_16x16x32_bf16 v[88:91], a[76:79], a[104:107], v[88:91]
    v_mfma_f32_16x16x32_bf16 v[92:95], a[76:79], a[108:111], v[92:95]
    s_waitcnt lgkmcnt(0)
    s_nop 0
    v_mfma_f32_16x16x32_bf16 v[0:3], a[56:59], a[80:83], v[0:3]
    v_mfma_f32_16x16x32_bf16 v[4:7], a[56:59], a[84:87], v[4:7]
    ds_read_b64_tr_b16 a[68:69], v98 offset:49664
    ds_read_b64_tr_b16 a[70:71], v98 offset:50176
    ds_read_b64_tr_b16 a[72:73], v99 offset:49664
    ds_read_b64_tr_b16 a[74:75], v99 offset:50176
    v_mfma_f32_16x16x32_bf16 v[16:19], a[56:59], a[88:91], v[16:19]
    v_mfma_f32_16x16x32_bf16 v[20:23], a[56:59], a[92:95], v[20:23]
    ds_read_b64_tr_b16 a[76:77], v100 offset:49664
    ds_read_b64_tr_b16 a[78:79], v100 offset:50176
    ds_read_b128 a[96:99], v97 offset:16384
    ds_read_b128 a[100:103], v97 offset:18432
    s_add_u32 s76, s76, 1
    s_cmp_eq_u32 s76, 7
    s_cselect_b32 s76, 0, s76
    s_mul_i32 s6, s76, 172032
    s_add_u32 s6, s6, s78
    s_add_u32 m0, s11, 20736
    s_mul_i32 s8, s76, 229376
    buffer_load_dwordx4 v101, s[32:35], s6 offen lds
    v_mfma_f32_16x16x32_bf16 v[32:35], a[60:63], a[80:83], v[32:35]
    v_mfma_f32_16x16x32_bf16 v[36:39], a[60:63], a[84:87], v[36:39]
    v_mfma_f32_16x16x32_bf16 v[48:51], a[60:63], a[88:91], v[48:51]
    v_mfma_f32_16x16x32_bf16 v[52:55], a[60:63], a[92:95], v[52:55]
    s_add_u32 m0, s12, 20736
    s_add_u32 s8, s8, s79
    buffer_load_dwordx4 v102, s[36:39], s8 offen lds
    v_mfma_f32_16x16x32_bf16 v[64:67], a[64:67], a[80:83], v[64:67]
    v_mfma_f32_16x16x32_bf16 v[68:71], a[64:67], a[84:87], v[68:71]
    v_mfma_f32_16x16x32_bf16 v[80:83], a[64:67], a[88:91], v[80:83]
    v_mfma_f32_16x16x32_bf16 v[84:87], a[64:67], a[92:95], v[84:87]
    s_waitcnt lgkmcnt(0)
    v_mfma_f32_16x16x32_bf16 v[8:11], a[68:71], a[80:83], v[8:11]
    v_mfma_f32_16x16x32_bf16 v[12:15], a[68:71], a[84:87], v[12:15]
    ds_read_b64_tr_b16 a[56:57], v98 offset:45568
    ds_read_b64_tr_b16 a[58:59], v98 offset:46080
    ds_read_b64_tr_b16 a[60:61], v99 offset:45568
    ds_read_b64_tr_b16 a[62:63], v99 offset:46080
    v_mfma_f32_16x16x32_bf16 v[24:27], a[68:71], a[88:91], v[24:27]
    v_mfma_f32_16x16x32_bf16 v[28:31], a[68:71], a[92:95], v[28:31]
    ds_read_b64_tr_b16 a[64:65], v100 offset:45568
    ds_read_b64_tr_b16 a[66:67], v100 offset:46080
    ds_read_b128 a[104:107], v97 offset:20480
    ds_read_b128 a[108:111], v97 offset:22528
    s_add_u32 s9, s8, 27648
    buffer_load_dwordx4 v103, s[36:39], s9 offen offset:1024 lds
    v_mfma_f32_16x16x32_bf16 v[40:43], a[72:75], a[80:83], v[40:43]
    v_mfma_f32_16x16x32_bf16 v[44:47], a[72:75], a[84:87], v[44:47]
    v_mfma_f32_16x16x32_bf16 v[56:59], a[72:75], a[88:91], v[56:59]
    v_mfma_f32_16x16x32_bf16 v[60:63], a[72:75], a[92:95], v[60:63]
    v_mfma_f32_16x16x32_bf16 v[72:75], a[76:79], a[80:83], v[72:75]
    v_mfma_f32_16x16x32_bf16 v[76:79], a[76:79], a[84:87], v[76:79]
    v_mfma_f32_16x16x32_bf16 v[88:91], a[76:79], a[88:91], v[88:91]
    v_mfma_f32_16x16x32_bf16 v[92:95], a[76:79], a[92:95], v[92:95]
    s_waitcnt lgkmcnt(0)
    s_nop 0
    v_mfma_f32_16x16x32_bf16 v[0:3], a[56:59], a[96:99], v[0:3]
    v_mfma_f32_16x16x32_bf16 v[4:7], a[56:59], a[100:103], v[4:7]
    ds_read_b64_tr_b16 a[68:69], v98 offset:53760
    ds_read_b64_tr_b16 a[70:71], v98 offset:54272
    ds_read_b64_tr_b16 a[72:73], v99 offset:53760
    ds_read_b64_tr_b16 a[74:75], v99 offset:54272
    v_mfma_f32_16x16x32_bf16 v[16:19], a[56:59], a[104:107], v[16:19]
    v_mfma_f32_16x16x32_bf16 v[20:23], a[56:59], a[108:111], v[20:23]
    ds_read_b64_tr_b16 a[76:77], v100 offset:53760
    ds_read_b64_tr_b16 a[78:79], v100 offset:54272
    s_add_u32 m0, s12, 28928
    s_nop 0
    buffer_load_dwordx4 v102, s[40:43], s8 offen lds
    v_mfma_f32_16x16x32_bf16 v[32:35], a[60:63], a[96:99], v[32:35]
    v_mfma_f32_16x16x32_bf16 v[36:39], a[60:63], a[100:103], v[36:39]
    v_mfma_f32_16x16x32_bf16 v[48:51], a[60:63], a[104:107], v[48:51]
    v_mfma_f32_16x16x32_bf16 v[52:55], a[60:63], a[108:111], v[52:55]
    v_mfma_f32_16x16x32_bf16 v[64:67], a[64:67], a[96:99], v[64:67]
    v_mfma_f32_16x16x32_bf16 v[68:71], a[64:67], a[100:103], v[68:71]
    v_mfma_f32_16x16x32_bf16 v[80:83], a[64:67], a[104:107], v[80:83]
    v_mfma_f32_16x16x32_bf16 v[84:87], a[64:67], a[108:111], v[84:87]
    s_waitcnt lgkmcnt(0)
    v_mfma_f32_16x16x32_bf16 v[8:11], a[68:71], a[96:99], v[8:11]
    v_mfma_f32_16x16x32_bf16 v[12:15], a[68:71], a[100:103], v[12:15]
    s_waitcnt vmcnt(4)
    s_barrier
    ds_read_b64_tr_b16 a[56:57], v98 offset:0
    ds_read_b64_tr_b16 a[58:59], v98 offset:512
    ds_read_b128 a[80:83], v96 offset:0
    ds_read_b128 a[84:87], v96 offset:2048
    v_mfma_f32_16x16x32_bf16 v[24:27], a[68:71], a[104:107], v[24:27]
    v_mfma_f32_16x16x32_bf16 v[28:31], a[68:71], a[108:111], v[28:31]
    ds_read_b128 a[88:91], v96 offset:4096
    ds_read_b128 a[92:95], v96 offset:6144
    ds_read_b64_tr_b16 a[60:61], v99 offset:0
    ds_read_b64_tr_b16 a[62:63], v99 offset:512
    buffer_load_dwordx4 v103, s[40:43], s9 offen offset:1024 lds
    v_mfma_f32_16x16x32_bf16 v[40:43], a[72:75], a[96:99], v[40:43]
    v_mfma_f32_16x16x32_bf16 v[44:47], a[72:75], a[100:103], v[44:47]
    ds_read_b64_tr_b16 a[64:65], v100 offset:0
    ds_read_b64_tr_b16 a[66:67], v100 offset:512
    v_mfma_f32_16x16x32_bf16 v[56:59], a[72:75], a[104:107], v[56:59]
    v_mfma_f32_16x16x32_bf16 v[60:63], a[72:75], a[108:111], v[60:63]
    v_mfma_f32_16x16x32_bf16 v[72:75], a[76:79], a[96:99], v[72:75]
    v_mfma_f32_16x16x32_bf16 v[76:79], a[76:79], a[100:103], v[76:79]
    v_mfma_f32_16x16x32_bf16 v[88:91], a[76:79], a[104:107], v[88:91]
    v_mfma_f32_16x16x32_bf16 v[92:95], a[76:79], a[108:111], v[92:95]
    s_waitcnt lgkmcnt(0)
    s_nop 0
    v_mfma_f32_16x16x32_bf16 v[0:3], a[56:59], a[80:83], v[0:3]
    v_mfma_f32_16x16x32_bf16 v[4:7], a[56:59], a[84:87], v[4:7]
    ds_read_b64_tr_b16 a[68:69], v98 offset:8192
    ds_read_b64_tr_b16 a[70:71], v98 offset:8704
    ds_read_b64_tr_b16 a[72:73], v99 offset:8192
    ds_read_b64_tr_b16 a[74:75], v99 offset:8704
    v_mfma_f32_16x16x32_bf16 v[16:19], a[56:59], a[88:91], v[16:19]
    v_mfma_f32_16x16x32_bf16 v[20:23], a[56:59], a[92:95], v[20:23]
    ds_read_b64_tr_b16 a[76:77], v100 offset:8192
    ds_read_b64_tr_b16 a[78:79], v100 offset:8704
    ds_read_b128 a[96:99], v97 offset:0
    ds_read_b128 a[100:103], v97 offset:2048
    s_add_u32 s76, s76, 1
    s_cmp_eq_u32 s76, 7
    s_cselect_b32 s76, 0, s76
    s_mul_i32 s6, s76, 172032
    s_add_u32 s6, s6, s78
    s_add_u32 m0, s11, 41472
    s_mul_i32 s8, s76, 229376
    buffer_load_dwordx4 v101, s[32:35], s6 offen lds
    v_mfma_f32_16x16x32_bf16 v[32:35], a[60:63], a[80:83], v[32:35]
    v_mfma_f32_16x16x32_bf16 v[36:39], a[60:63], a[84:87], v[36:39]
    v_mfma_f32_16x16x32_bf16 v[48:51], a[60:63], a[88:91], v[48:51]
    v_mfma_f32_16x16x32_bf16 v[52:55], a[60:63], a[92:95], v[52:55]
    s_add_u32 m0, s12, 41472
    s_add_u32 s8, s8, s79
    buffer_load_dwordx4 v102, s[36:39], s8 offen lds
    v_mfma_f32_16x16x32_bf16 v[64:67], a[64:67], a[80:83], v[64:67]
    v_mfma_f32_16x16x32_bf16 v[68:71], a[64:67], a[84:87], v[68:71]
    v_mfma_f32_16x16x32_bf16 v[80:83], a[64:67], a[88:91], v[80:83]
    v_mfma_f32_16x16x32_bf16 v[84:87], a[64:67], a[92:95], v[84:87]
    s_waitcnt lgkmcnt(0)
    v_mfma_f32_16x16x32_bf16 v[8:11], a[68:71], a[80:83], v[8:11]
    v_mfma_f32_16x16x32_bf16 v[12:15], a[68:71], a[84:87], v[12:15]
    ds_read_b64_tr_b16 a[56:57], v98 offset:4096
    ds_read_b64_tr_b16 a[58:59], v98 offset:4608
    ds_read_b64_tr_b16 a[60:61], v99 offset:4096
    ds_read_b64_tr_b16 a[62:63], v99 offset:4608
    v_mfma_f32_16x16x32_bf16 v[24:27], a[68:71], a[88:91], v[24:27]
    v_mfma_f32_16x16x32_bf16 v[28:31], a[68:71], a[92:95], v[28:31]
    ds_read_b64_tr_b16 a[64:65], v100 offset:4096
    ds_read_b64_tr_b16 a[66:67], v100 offset:4608
    ds_read_b128 a[104:107], v97 offset:4096
    ds_read_b128 a[108:111], v97 offset:6144
    s_add_u32 s9, s8, 27648
    buffer_load_dwordx4 v103, s[36:39], s9 offen offset:1024 lds
    v_mfma_f32_16x16x32_bf16 v[40:43], a[72:75], a[80:83], v[40:43]
    v_mfma_f32_16x16x32_bf16 v[44:47], a[72:75], a[84:87], v[44:47]
    v_mfma_f32_16x16x32_bf16 v[56:59], a[72:75], a[88:91], v[56:59]
    v_mfma_f32_16x16x32_bf16 v[60:63], a[72:75], a[92:95], v[60:63]
    v_mfma_f32_16x16x32_bf16 v[72:75], a[76:79], a[80:83], v[72:75]
    v_mfma_f32_16x16x32_bf16 v[76:79], a[76:79], a[84:87], v[76:79]
    v_mfma_f32_16x16x32_bf16 v[88:91], a[76:79], a[88:91], v[88:91]
    v_mfma_f32_16x16x32_bf16 v[92:95], a[76:79], a[92:95], v[92:95]
    s_waitcnt lgkmcnt(0)
    s_nop 0
    v_mfma_f32_16x16x32_bf16 v[0:3], a[56:59], a[96:99], v[0:3]
    v_mfma_f32_16x16x32_bf16 v[4:7], a[56:59], a[100:103], v[4:7]
    ds_read_b64_tr_b16 a[68:69], v98 offset:12288
    ds_read_b64_tr_b16 a[70:71], v98 offset:12800
    ds_read_b64_tr_b16 a[72:73], v99 offset:12288
    ds_read_b64_tr_b16 a[74:75], v99 offset:12800
    v_mfma_f32_16x16x32_bf16 v[16:19], a[56:59], a[104:107], v[16:19]
    v_mfma_f32_16x16x32_bf16 v[20:23], a[56:59], a[108:111], v[20:23]
    ds_read_b64_tr_b16 a[76:77], v100 offset:12288
    ds_read_b64_tr_b16 a[78:79], v100 offset:12800
    s_add_u32 m0, s12, 49664
    s_nop 0
    buffer_load_dwordx4 v102, s[40:43], s8 offen lds
    v_lshl_add_u32 v105, v112, 4, s2
    v_min_u32 v105, 1567, v105
    v_lshlrev_b32 v105, 7, v105
    v_mfma_f32_16x16x32_bf16 v[32:35], a[60:63], a[96:99], v[32:35]
    v_mfma_f32_16x16x32_bf16 v[36:39], a[60:63], a[100:103], v[36:39]
    s_mul_i32 s3, s26, 401408
    s_add_u32 s3, s3, 200704
    v_add_u32 v105, s3, v105
    v_mfma_f32_16x16x32_bf16 v[48:51], a[60:63], a[104:107], v[48:51]
    v_mfma_f32_16x16x32_bf16 v[52:55], a[60:63], a[108:111], v[52:55]
    buffer_load_dwordx4 v103, s[40:43], s9 offen offset:1024 lds
    s_mov_b64 exec, 127
    buffer_load_dword v106, v105, s[44:47], 0 offen
    s_mov_b64 exec, -1
    s_lshl_b32 s3, s26, 8
    s_add_u32 s3, s3, s2
    v_lshl_add_u32 v105, v112, 6, s3
    v_mfma_f32_16x16x32_bf16 v[64:67], a[64:67], a[96:99], v[64:67]
    v_mfma_f32_16x16x32_bf16 v[68:71], a[64:67], a[100:103], v[68:71]
    v_mfma_f32_16x16x32_bf16 v[80:83], a[64:67], a[104:107], v[80:83]
    v_mfma_f32_16x16x32_bf16 v[84:87], a[64:67], a[108:111], v[84:87]
    v_lshlrev_b32 v105, 7, v105
    s_mov_b64 exec, 15
    buffer_load_dword v106, v105, s[48:51], 0 offen
    s_mov_b64 exec, -1
    s_waitcnt lgkmcnt(0)
    v_mfma_f32_16x16x32_bf16 v[8:11], a[68:71], a[96:99], v[8:11]
    v_mfma_f32_16x16x32_bf16 v[12:15], a[68:71], a[100:103], v[12:15]
    s_waitcnt vmcnt(7)
    s_barrier
    ds_read_b64_tr_b16 a[56:57], v98 offset:20736
    ds_read_b64_tr_b16 a[58:59], v98 offset:21248
    ds_read_b128 a[80:83], v96 offset:8192
    ds_read_b128 a[84:87], v96 offset:10240
    v_mfma_f32_16x16x32_bf16 v[24:27], a[68:71], a[104:107], v[24:27]
    v_mfma_f32_16x16x32_bf16 v[28:31], a[68:71], a[108:111], v[28:31]
    ds_read_b128 a[88:91], v96 offset:12288
    ds_read_b128 a[92:95], v96 offset:14336
    ds_read_b64_tr_b16 a[60:61], v99 offset:20736
    ds_read_b64_tr_b16 a[62:63], v99 offset:21248
    s_mov_b32 s66, 25088
    s_mov_b32 s67, 0x20000
    s_and_b32 s9, s26, 1
    s_lshl_b32 s9, s9, 10
    s_add_u32 m0, s9, 161792
    s_mul_i32 s6, s74, 1568
    s_add_u32 s6, s6, s9
    s_nop 0
    buffer_load_dwordx4 v112, s[64:67], s6 offen lds
    v_mfma_f32_16x16x32_bf16 v[40:43], a[72:75], a[96:99], v[40:43]
    v_mfma_f32_16x16x32_bf16 v[44:47], a[72:75], a[100:103], v[44:47]
    ds_read_b64_tr_b16 a[64:65], v100 offset:20736
    ds_read_b64_tr_b16 a[66:67], v100 offset:21248
    v_mfma_f32_16x16x32_bf16 v[56:59], a[72:75], a[104:107], v[56:59]
    v_mfma_f32_16x16x32_bf16 v[60:63], a[72:75], a[108:111], v[60:63]
    v_mfma_f32_16x16x32_bf16 v[72:75], a[76:79], a[96:99], v[72:75]
    v_mfma_f32_16x16x32_bf16 v[76:79], a[76:79], a[100:103], v[76:79]
    v_mfma_f32_16x16x32_bf16 v[88:91], a[76:79], a[104:107], v[88:91]
    v_mfma_f32_16x16x32_bf16 v[92:95], a[76:79], a[108:111], v[92:95]
    s_waitcnt lgkmcnt(0)
    s_nop 0
    v_mfma_f32_16x16x32_bf16 v[0:3], a[56:59], a[80:83], v[0:3]
    v_mfma_f32_16x16x32_bf16 v[4:7], a[56:59], a[84:87], v[4:7]
    ds_read_b64_tr_b16 a[68:69], v98 offset:28928
    ds_read_b64_tr_b16 a[70:71], v98 offset:29440
    ds_read_b64_tr_b16 a[72:73], v99 offset:28928
    ds_read_b64_tr_b16 a[74:75], v99 offset:29440
    v_mfma_f32_16x16x32_bf16 v[16:19], a[56:59], a[88:91], v[16:19]
    v_mfma_f32_16x16x32_bf16 v[20:23], a[56:59], a[92:95], v[20:23]
    ds_read_b64_tr_b16 a[76:77], v100 offset:28928
    ds_read_b64_tr_b16 a[78:79], v100 offset:29440
    ds_read_b128 a[96:99], v97 offset:8192
    ds_read_b128 a[100:103], v97 offset:10240
    s_add_u32 s76, s76, 1
    s_cmp_eq_u32 s76, 7
    s_cselect_b32 s76, 0, s76
    s_mul_i32 s6, s76, 172032
    s_add_u32 s6, s6, s78
    s_add_u32 m0, s11, 0
    s_mul_i32 s8, s76, 229376
    buffer_load_dwordx4 v101, s[32:35], s6 offen lds
    v_mfma_f32_16x16x32_bf16 v[32:35], a[60:63], a[80:83], v[32:35]
    v_mfma_f32_16x16x32_bf16 v[36:39], a[60:63], a[84:87], v[36:39]
    v_mfma_f32_16x16x32_bf16 v[48:51], a[60:63], a[88:91], v[48:51]
    v_mfma_f32_16x16x32_bf16 v[52:55], a[60:63], a[92:95], v[52:55]
    s_add_u32 m0, s12, 0
    s_add_u32 s8, s8, s79
    buffer_load_dwordx4 v102, s[36:39], s8 offen lds
    v_mfma_f32_16x16x32_bf16 v[64:67], a[64:67], a[80:83], v[64:67]
    v_mfma_f32_16x16x32_bf16 v[68:71], a[64:67], a[84:87], v[68:71]
    v_mfma_f32_16x16x32_bf16 v[80:83], a[64:67], a[88:91], v[80:83]
    v_mfma_f32_16x16x32_bf16 v[84:87], a[64:67], a[92:95], v[84:87]
    s_waitcnt lgkmcnt(0)
    v_mfma_f32_16x16x32_bf16 v[8:11], a[68:71], a[80:83], v[8:11]
    v_mfma_f32_16x16x32_bf16 v[12:15], a[68:71], a[84:87], v[12:15]
    ds_read_b64_tr_b16 a[56:57], v98 offset:24832
    ds_read_b64_tr_b16 a[58:59], v98 offset:25344
    ds_read_b64_tr_b16 a[60:61], v99 offset:24832
    ds_read_b64_tr_b16 a[62:63], v99 offset:25344
    v_mfma_f32_16x16x32_bf16 v[24:27], a[68:71], a[88:91], v[24:27]
    v_mfma_f32_16x16x32_bf16 v[28:31], a[68:71], a[92:95], v[28:31]
    ds_read_b64_tr_b16 a[64:65], v100 offset:24832
    ds_read_b64_tr_b16 a[66:67], v100 offset:25344
    ds_read_b128 a[104:107], v97 offset:12288
    ds_read_b128 a[108:111], v97 offset:14336
    s_add_u32 s9, s8, 27648
    buffer_load_dwordx4 v103, s[36:39], s9 offen offset:1024 lds
    v_mfma_f32_16x16x32_bf16 v[40:43], a[72:75], a[80:83], v[40:43]
    v_mfma_f32_16x16x32_bf16 v[44:47], a[72:75], a[84:87], v[44:47]
    v_mfma_f32_16x16x32_bf16 v[56:59], a[72:75], a[88:91], v[56:59]
    v_mfma_f32_16x16x32_bf16 v[60:63], a[72:75], a[92:95], v[60:63]
    v_mfma_f32_16x16x32_bf16 v[72:75], a[76:79], a[80:83], v[72:75]
    v_mfma_f32_16x16x32_bf16 v[76:79], a[76:79], a[84:87], v[76:79]
    v_mfma_f32_16x16x32_bf16 v[88:91], a[76:79], a[88:91], v[88:91]
    v_mfma_f32_16x16x32_bf16 v[92:95], a[76:79], a[92:95], v[92:95]
    s_waitcnt lgkmcnt(0)
    s_nop 0
    v_mfma_f32_16x16x32_bf16 v[0:3], a[56:59], a[96:99], v[0:3]
    v_mfma_f32_16x16x32_bf16 v[4:7], a[56:59], a[100:103], v[4:7]
    ds_read_b64_tr_b16 a[68:69], v98 offset:33024
    ds_read_b64_tr_b16 a[70:71], v98 offset:33536
    ds_read_b64_tr_b16 a[72:73], v99 offset:33024
    ds_read_b64_tr_b16 a[74:75], v99 offset:33536
    v_mfma_f32_16x16x32_bf16 v[16:19], a[56:59], a[104:107], v[16:19]
    v_mfma_f32_16x16x32_bf16 v[20:23], a[56:59], a[108:111], v[20:23]
    ds_read_b64_tr_b16 a[76:77], v100 offset:33024
    ds_read_b64_tr_b16 a[78:79], v100 offset:33536
    s_add_u32 m0, s12, 8192
    s_nop 0
    buffer_load_dwordx4 v102, s[40:43], s8 offen lds
    v_mfma_f32_16x16x32_bf16 v[32:35], a[60:63], a[96:99], v[32:35]
    v_mfma_f32_16x16x32_bf16 v[36:39], a[60:63], a[100:103], v[36:39]
    v_mfma_f32_16x16x32_bf16 v[48:51], a[60:63], a[104:107], v[48:51]
    v_mfma_f32_16x16x32_bf16 v[52:55], a[60:63], a[108:111], v[52:55]
    v_mfma_f32_16x16x32_bf16 v[64:67], a[64:67], a[96:99], v[64:67]
    v_mfma_f32_16x16x32_bf16 v[68:71], a[64:67], a[100:103], v[68:71]
    v_mfma_f32_16x16x32_bf16 v[80:83], a[64:67], a[104:107], v[80:83]
    v_mfma_f32_16x16x32_bf16 v[84:87], a[64:67], a[108:111], v[84:87]
    s_waitcnt lgkmcnt(0)
    v_mfma_f32_16x16x32_bf16 v[8:11], a[68:71], a[96:99], v[8:11]
    v_mfma_f32_16x16x32_bf16 v[12:15], a[68:71], a[100:103], v[12:15]
    s_waitcnt vmcnt(4)
    s_barrier
    ds_read_b64_tr_b16 a[56:57], v98 offset:41472
    ds_read_b64_tr_b16 a[58:59], v98 offset:41984
    ds_read_b128 a[80:83], v96 offset:16384
    ds_read_b128 a[84:87], v96 offset:18432
    v_mfma_f32_16x16x32_bf16 v[24:27], a[68:71], a[104:107], v[24:27]
    v_mfma_f32_16x16x32_bf16 v[28:31], a[68:71], a[108:111], v[28:31]
    ds_read_b128 a[88:91], v96 offset:20480
    ds_read_b128 a[92:95], v96 offset:22528
    ds_read_b64_tr_b16 a[60:61], v99 offset:41472
    ds_read_b64_tr_b16 a[62:63], v99 offset:41984
    buffer_load_dwordx4 v103, s[40:43], s9 offen offset:1024 lds
    v_mfma_f32_16x16x32_bf16 v[40:43], a[72:75], a[96:99], v[40:43]
    v_mfma_f32_16x16x32_bf16 v[44:47], a[72:75], a[100:103], v[44:47]
    ds_read_b64_tr_b16 a[64:65], v100 offset:41472
    ds_read_b64_tr_b16 a[66:67], v100 offset:41984
    v_mfma_f32_16x16x32_bf16 v[56:59], a[72:75], a[104:107], v[56:59]
    v_mfma_f32_16x16x32_bf16 v[60:63], a[72:75], a[108:111], v[60:63]
    v_mfma_f32_16x16x32_bf16 v[72:75], a[76:79], a[96:99], v[72:75]
    v_mfma_f32_16x16x32_bf16 v[76:79], a[76:79], a[100:103], v[76:79]
    v_mfma_f32_16x16x32_bf16 v[88:91], a[76:79], a[104:107], v[88:91]
    v_mfma_f32_16x16x32_bf16 v[92:95], a[76:79], a[108:111], v[92:95]
    s_waitcnt lgkmcnt(0)
    s_nop 0
    v_mfma_f32_16x16x32_bf16 v[0:3], a[56:59], a[80:83], v[0:3]
    v_mfma_f32_16x16x32_bf16 v[4:7], a[56:59], a[84:87], v[4:7]
    s_and_b32 s3, s2, 7
    s_lshl_b32 s3, s3, 2
    s_lshr_b32 s43, 0x6543210, s3
    s_sub_u32 s3, 28, s3
    s_lshl_b32 s3, 0x6543210, s3
    s_or_b32 s43, s43, s3
    s_lshl_b32 s35, s20, 2
    s_add_u32 s34, s35, s26
    s_mul_i32 s34, s34, 512
    s_add_u32 s34, s34, 13631488
    s_lshl_b32 s35, s35, 1
    s_add_u32 s35, s35, s26
    s_mul_i32 s35, s35, 7168
    s_lshl_b32 s36, s21, 7
    s_add_u32 s35, s35, s36
    s_mul_i32 s37, s20, 294912
    s_mul_i32 s33, s26, 57344
    s_add_u32 s33, s33, s37
    s_mul_i32 s40, s26, 14336
    s_add_u32 s40, s40, 98304
    s_mul_i32 s41, s26, -301056
    s_add_u32 s41, s41, s22
    s_add_u32 s32, s35, 28672
    ds_read_b64_tr_b16 a[68:69], v98 offset:49664
    ds_read_b64_tr_b16 a[70:71], v98 offset:50176
    ds_read_b64_tr_b16 a[72:73], v99 offset:49664
    ds_read_b64_tr_b16 a[74:75], v99 offset:50176
    v_mfma_f32_16x16x32_bf16 v[16:19], a[56:59], a[88:91], v[16:19]
    v_mfma_f32_16x16x32_bf16 v[20:23], a[56:59], a[92:95], v[20:23]
    ds_read_b64_tr_b16 a[76:77], v100 offset:49664
    ds_read_b64_tr_b16 a[78:79], v100 offset:50176
    ds_read_b128 a[96:99], v97 offset:16384
    ds_read_b128 a[100:103], v97 offset:18432
    s_bfe_u32 s4, s43, 0x40000
    s_mul_i32 s4, s4, 28672
    s_add_u32 m0, s10, 8192
    s_add_u32 s4, s4, s22
    s_nop 0
    buffer_load_dwordx4 v119, s[44:47], s4 offen offset:0 lds
    v_mfma_f32_16x16x32_bf16 v[32:35], a[60:63], a[80:83], v[32:35]
    v_mfma_f32_16x16x32_bf16 v[36:39], a[60:63], a[84:87], v[36:39]
    buffer_load_dwordx4 v120, s[44:47], s4 offen offset:1024 lds
    v_mfma_f32_16x16x32_bf16 v[48:51], a[60:63], a[88:91], v[48:51]
    v_mfma_f32_16x16x32_bf16 v[52:55], a[60:63], a[92:95], v[52:55]
    buffer_load_dwordx4 v121, s[44:47], s4 offen offset:2048 lds
    v_mfma_f32_16x16x32_bf16 v[64:67], a[64:67], a[80:83], v[64:67]
    v_mfma_f32_16x16x32_bf16 v[68:71], a[64:67], a[84:87], v[68:71]
    buffer_load_dwordx4 v122, s[44:47], s4 offen offset:3072 lds
    v_mfma_f32_16x16x32_bf16 v[80:83], a[64:67], a[88:91], v[80:83]
    v_mfma_f32_16x16x32_bf16 v[84:87], a[64:67], a[92:95], v[84:87]
    s_waitcnt lgkmcnt(0)
    s_nop 0
    v_mfma_f32_16x16x32_bf16 v[8:11], a[68:71], a[80:83], v[8:11]
    v_mfma_f32_16x16x32_bf16 v[12:15], a[68:71], a[84:87], v[12:15]
    ds_read_b64_tr_b16 a[56:57], v98 offset:45568
    ds_read_b64_tr_b16 a[58:59], v98 offset:46080
    ds_read_b64_tr_b16 a[60:61], v99 offset:45568
    ds_read_b64_tr_b16 a[62:63], v99 offset:46080
    v_mfma_f32_16x16x32_bf16 v[24:27], a[68:71], a[88:91], v[24:27]
    v_mfma_f32_16x16x32_bf16 v[28:31], a[68:71], a[92:95], v[28:31]
    ds_read_b64_tr_b16 a[64:65], v100 offset:45568
    ds_read_b64_tr_b16 a[66:67], v100 offset:46080
    ds_read_b128 a[104:107], v97 offset:20480
    ds_read_b128 a[108:111], v97 offset:22528
    s_bfe_u32 s4, s43, 0x40004
    s_mul_i32 s4, s4, 28672
    s_add_u32 m0, s10, 12288
    s_add_u32 s4, s4, s22
    s_nop 0
    buffer_load_dwordx4 v119, s[44:47], s4 offen offset:0 lds
    v_mfma_f32_16x16x32_bf16 v[40:43], a[72:75], a[80:83], v[40:43]
    v_mfma_f32_16x16x32_bf16 v[44:47], a[72:75], a[84:87], v[44:47]
    buffer_load_dwordx4 v120, s[44:47], s4 offen offset:1024 lds
    v_mfma_f32_16x16x32_bf16 v[56:59], a[72:75], a[88:91], v[56:59]
    v_mfma_f32_16x16x32_bf16 v[60:63], a[72:75], a[92:95], v[60:63]
    buffer_load_dwordx4 v121, s[44:47], s4 offen offset:2048 lds
    v_mfma_f32_16x16x32_bf16 v[72:75], a[76:79], a[80:83], v[72:75]
    v_mfma_f32_16x16x32_bf16 v[76:79], a[76:79], a[84:87], v[76:79]
    buffer_load_dwordx4 v122, s[44:47], s4 offen offset:3072 lds
    v_mfma_f32_16x16x32_bf16 v[88:91], a[76:79], a[88:91], v[88:91]
    v_mfma_f32_16x16x32_bf16 v[92:95], a[76:79], a[92:95], v[92:95]
    s_waitcnt lgkmcnt(0)
    s_nop 0
    v_mfma_f32_16x16x32_bf16 v[0:3], a[56:59], a[96:99], v[0:3]
    v_mfma_f32_16x16x32_bf16 v[4:7], a[56:59], a[100:103], v[4:7]
    ds_read_b64_tr_b16 a[68:69], v98 offset:53760
    ds_read_b64_tr_b16 a[70:71], v98 offset:54272
    ds_read_b64_tr_b16 a[72:73], v99 offset:53760
    ds_read_b64_tr_b16 a[74:75], v99 offset:54272
    v_mfma_f32_16x16x32_bf16 v[16:19], a[56:59], a[104:107], v[16:19]
    v_mfma_f32_16x16x32_bf16 v[20:23], a[56:59], a[108:111], v[20:23]
    ds_read_b64_tr_b16 a[76:77], v100 offset:53760
    ds_read_b64_tr_b16 a[78:79], v100 offset:54272
    v_mfma_f32_16x16x32_bf16 v[32:35], a[60:63], a[96:99], v[32:35]
    v_mfma_f32_16x16x32_bf16 v[36:39], a[60:63], a[100:103], v[36:39]
    v_mfma_f32_16x16x32_bf16 v[48:51], a[60:63], a[104:107], v[48:51]
    v_mfma_f32_16x16x32_bf16 v[52:55], a[60:63], a[108:111], v[52:55]
    v_mfma_f32_16x16x32_bf16 v[64:67], a[64:67], a[96:99], v[64:67]
    v_mfma_f32_16x16x32_bf16 v[68:71], a[64:67], a[100:103], v[68:71]
    v_mfma_f32_16x16x32_bf16 v[80:83], a[64:67], a[104:107], v[80:83]
    v_mfma_f32_16x16x32_bf16 v[84:87], a[64:67], a[108:111], v[84:87]
    s_waitcnt lgkmcnt(0)
    s_nop 0
    v_mfma_f32_16x16x32_bf16 v[8:11], a[68:71], a[96:99], v[8:11]
    v_mfma_f32_16x16x32_bf16 v[12:15], a[68:71], a[100:103], v[12:15]
    s_waitcnt vmcnt(8)
    s_barrier
    ds_read_b64_tr_b16 a[56:57], v98 offset:0
    ds_read_b64_tr_b16 a[58:59], v98 offset:512
    ds_read_b128 a[80:83], v96 offset:0
    ds_read_b128 a[84:87], v96 offset:2048
    v_mfma_f32_16x16x32_bf16 v[24:27], a[68:71], a[104:107], v[24:27]
    v_mfma_f32_16x16x32_bf16 v[28:31], a[68:71], a[108:111], v[28:31]
    ds_read_b128 a[88:91], v96 offset:4096
    ds_read_b128 a[92:95], v96 offset:6144
    ds_read_b64_tr_b16 a[60:61], v99 offset:0
    ds_read_b64_tr_b16 a[62:63], v99 offset:512
    s_bfe_u32 s4, s43, 0x40008
    s_mul_i32 s4, s4, 28672
    s_add_u32 m0, s10, 16384
    s_add_u32 s4, s4, s22
    buffer_load_dwordx4 v119, s[44:47], s4 offen offset:0 lds
    v_and_b32 v116, 0xf0, v112
    v_lshlrev_b32_e64 v116, 1, v116
    s_lshl_b32 s15, s27, 2
    v_mfma_f32_16x16x32_bf16 v[40:43], a[72:75], a[96:99], v[40:43]
    v_mfma_f32_16x16x32_bf16 v[44:47], a[72:75], a[100:103], v[44:47]
    ds_read_b64_tr_b16 a[64:65], v100 offset:0
    ds_read_b64_tr_b16 a[66:67], v100 offset:512
    buffer_load_dwordx4 v120, s[44:47], s4 offen offset:1024 lds
    s_add_u32 s15, s15, s26
    s_lshl_b32 s15, s15, 9
    v_mfma_f32_16x16x32_bf16 v[56:59], a[72:75], a[104:107], v[56:59]
    v_mfma_f32_16x16x32_bf16 v[60:63], a[72:75], a[108:111], v[60:63]
    buffer_load_dwordx4 v121, s[44:47], s4 offen offset:2048 lds
    s_add_u32 s15, s15, 12582912
    buffer_load_dwordx4 v[124:127], v116, s[52:55], s15 offen offset:0 sc1
    v_mfma_f32_16x16x32_bf16 v[72:75], a[76:79], a[96:99], v[72:75]
    v_mfma_f32_16x16x32_bf16 v[76:79], a[76:79], a[100:103], v[76:79]
    buffer_load_dwordx4 v122, s[44:47], s4 offen offset:3072 lds
    buffer_load_dwordx4 v[108:111], v116, s[52:55], s15 offen offset:16 sc1
    v_mfma_f32_16x16x32_bf16 v[88:91], a[76:79], a[104:107], v[88:91]
    v_mfma_f32_16x16x32_bf16 v[92:95], a[76:79], a[108:111], v[92:95]
    s_waitcnt lgkmcnt(0)
    s_nop 0
    v_mfma_f32_16x16x32_bf16 v[0:3], a[56:59], a[80:83], v[0:3]
    v_mfma_f32_16x16x32_bf16 v[4:7], a[56:59], a[84:87], v[4:7]
    ds_read_b64_tr_b16 a[68:69], v98 offset:8192
    ds_read_b64_tr_b16 a[70:71], v98 offset:8704
    ds_read_b64_tr_b16 a[72:73], v99 offset:8192
    ds_read_b64_tr_b16 a[74:75], v99 offset:8704
    v_mfma_f32_16x16x32_bf16 v[16:19], a[56:59], a[88:91], v[16:19]
    v_mfma_f32_16x16x32_bf16 v[20:23], a[56:59], a[92:95], v[20:23]
    ds_read_b64_tr_b16 a[76:77], v100 offset:8192
    ds_read_b64_tr_b16 a[78:79], v100 offset:8704
    ds_read_b128 a[96:99], v97 offset:0
    ds_read_b128 a[100:103], v97 offset:2048
    s_bfe_u32 s4, s43, 0x4000c
    s_mul_i32 s4, s4, 28672
    s_add_u32 m0, s10, 20480
    s_add_u32 s4, s4, s22
    buffer_load_dwordx4 v119, s[44:47], s4 offen offset:0 lds
    s_waitcnt vmcnt(7)
    ds_read_b64_tr_b16 a[0:1], v117 offset:8192
    ds_read_b64_tr_b16 a[2:3], v117 offset:8704
    ds_read_b64_tr_b16 a[4:5], v118 offset:8192
    v_mfma_f32_16x16x32_bf16 v[32:35], a[60:63], a[80:83], v[32:35]
    v_mfma_f32_16x16x32_bf16 v[36:39], a[60:63], a[84:87], v[36:39]
    buffer_load_dwordx4 v120, s[44:47], s4 offen offset:1024 lds
    ds_read_b64_tr_b16 a[6:7], v118 offset:8704
    ds_read_b64_tr_b16 a[8:9], v117 offset:10240
    ds_read_b64_tr_b16 a[10:11], v117 offset:10752
    v_mfma_f32_16x16x32_bf16 v[48:51], a[60:63], a[88:91], v[48:51]
    v_mfma_f32_16x16x32_bf16 v[52:55], a[60:63], a[92:95], v[52:55]
    buffer_load_dwordx4 v121, s[44:47], s4 offen offset:2048 lds
    ds_read_b64_tr_b16 a[12:13], v118 offset:10240
    ds_read_b64_tr_b16 a[14:15], v118 offset:10752
    ds_read_b64_tr_b16 a[16:17], v117 offset:12288
    ds_read_b64_tr_b16 a[18:19], v117 offset:12800
    v_mfma_f32_16x16x32_bf16 v[64:67], a[64:67], a[80:83], v[64:67]
    v_mfma_f32_16x16x32_bf16 v[68:71], a[64:67], a[84:87], v[68:71]
    buffer_load_dwordx4 v122, s[44:47], s4 offen offset:3072 lds
    ds_read_b64_tr_b16 a[20:21], v118 offset:12288
    ds_read_b64_tr_b16 a[22:23], v118 offset:12800
    ds_read_b64_tr_b16 a[24:25], v117 offset:14336
    v_mfma_f32_16x16x32_bf16 v[80:83], a[64:67], a[88:91], v[80:83]
    v_mfma_f32_16x16x32_bf16 v[84:87], a[64:67], a[92:95], v[84:87]
    ds_read_b64_tr_b16 a[26:27], v117 offset:14848
    ds_read_b64_tr_b16 a[28:29], v118 offset:14336
    ds_read_b64_tr_b16 a[30:31], v118 offset:14848
    s_waitcnt lgkmcnt(0)
    s_nop 0
    v_mfma_f32_16x16x32_bf16 v[8:11], a[68:71], a[80:83], v[8:11]
    v_mfma_f32_16x16x32_bf16 v[12:15], a[68:71], a[84:87], v[12:15]
    ds_read_b64_tr_b16 a[56:57], v98 offset:4096
    ds_read_b64_tr_b16 a[58:59], v98 offset:4608
    ds_read_b64_tr_b16 a[60:61], v99 offset:4096
    ds_read_b64_tr_b16 a[62:63], v99 offset:4608
    v_mfma_f32_16x16x32_bf16 v[24:27], a[68:71], a[88:91], v[24:27]
    v_mfma_f32_16x16x32_bf16 v[28:31], a[68:71], a[92:95], v[28:31]
    ds_read_b64_tr_b16 a[64:65], v100 offset:4096
    ds_read_b64_tr_b16 a[66:67], v100 offset:4608
    ds_read_b128 a[104:107], v97 offset:4096
    ds_read_b128 a[108:111], v97 offset:6144
    s_bfe_u32 s4, s43, 0x40010
    s_mul_i32 s4, s4, 28672
    s_add_u32 m0, s10, 8192
    s_add_u32 s4, s4, s22
    buffer_load_dwordx4 v119, s[44:47], s4 offen offset:0 lds
    s_waitcnt vmcnt(5)
    v_and_b32 v123, 0x130, v112
    v_lshrrev_b32 v123, 1, v123
    v_and_b32 v116, 0x40, v112
    v_add_u32 v123, v123, v116
    s_mov_b32 vcc_lo, 0xff00ff00
    s_mov_b32 vcc_hi, 0x00ff00ff
    v_mov_b32 v116, 1280
    v_cndmask_b32 v123, v123, v116, vcc
    v_mfma_f32_16x16x32_bf16 v[40:43], a[72:75], a[80:83], v[40:43]
    v_mfma_f32_16x16x32_bf16 v[44:47], a[72:75], a[84:87], v[44:47]
    buffer_load_dwordx4 v120, s[44:47], s4 offen offset:1024 lds
    v_add_u32 v123, 155648, v123
    s_mov_b32 vcc_lo, 0
    s_mov_b32 vcc_hi, -1
    v_cndmask_b32 v136, v125, v127, vcc
    v_cndmask_b32 v140, v109, v111, vcc
    v_cvt_pk_bf16_f32 v136, v136, v136
    v_cvt_pk_bf16_f32 v140, v140, v140
    v_mfma_f32_16x16x32_bf16 v[56:59], a[72:75], a[88:91], v[56:59]
    v_mfma_f32_16x16x32_bf16 v[60:63], a[72:75], a[92:95], v[60:63]
    buffer_load_dwordx4 v121, s[44:47], s4 offen offset:2048 lds
    s_mov_b32 vcc_lo, 0xffff0000
    s_mov_b32 vcc_hi, 0xffff0000
    v_cndmask_b32 v138, 0, v136, vcc
    v_cndmask_b32 v139, 0, v136, vcc
    v_cndmask_b32 v137, v136, 0, vcc
    v_cndmask_b32 v136, v136, 0, vcc
    v_cndmask_b32 v142, 0, v140, vcc
    v_cndmask_b32 v143, 0, v140, vcc
    v_cndmask_b32 v141, v140, 0, vcc
    v_cndmask_b32 v140, v140, 0, vcc
    v_mfma_f32_16x16x32_bf16 v[72:75], a[76:79], a[80:83], v[72:75]
    v_mfma_f32_16x16x32_bf16 v[76:79], a[76:79], a[84:87], v[76:79]
    buffer_load_dwordx4 v122, s[44:47], s4 offen offset:3072 lds
    v_rsq_f32 v129, v124
    v_rsq_f32 v131, v126
    v_rsq_f32 v133, v108
    v_rsq_f32 v135, v110
    v_mul_f32_e64 v132, v129, v129
    v_mfma_f32_16x16x32_bf16 v[88:91], a[76:79], a[88:91], v[88:91]
    v_mfma_f32_16x16x32_bf16 v[92:95], a[76:79], a[92:95], v[92:95]
    v_mul_f32 v128, 0xc0135761, v129
    v_mul_f32_e64 v134, v131, v131
    v_mul_f32 v130, 0xc0135761, v131
    v_mul_f32 v132, 0x3d372713, v132
    v_mul_f32 v134, 0x3d372713, v134
    v_mul_f32_e64 v132, v128, v132
    v_mul_f32 v134, v130, v134
    s_waitcnt lgkmcnt(0)
    v_mfma_f32_16x16x32_bf16 v[0:3], a[56:59], a[96:99], v[0:3]
    v_mfma_f32_16x16x32_bf16 v[4:7], a[56:59], a[100:103], v[4:7]
    ds_read_b64_tr_b16 a[68:69], v98 offset:12288
    ds_read_b64_tr_b16 a[70:71], v98 offset:12800
    ds_read_b64_tr_b16 a[72:73], v99 offset:12288
    ds_read_b64_tr_b16 a[74:75], v99 offset:12800
    v_mfma_f32_16x16x32_bf16 v[16:19], a[56:59], a[104:107], v[16:19]
    v_mfma_f32_16x16x32_bf16 v[20:23], a[56:59], a[108:111], v[20:23]
    ds_read_b64_tr_b16 a[76:77], v100 offset:12288
    ds_read_b64_tr_b16 a[78:79], v100 offset:12800
    s_bfe_u32 s4, s43, 0x40014
    s_mul_i32 s4, s4, 28672
    s_add_u32 m0, s10, 12288
    s_add_u32 s4, s4, s22
    s_nop 0
    buffer_load_dwordx4 v119, s[44:47], s4 offen offset:0 lds
    v_mfma_f32_16x16x32_bf16 v[32:35], a[60:63], a[96:99], v[32:35]
    v_mfma_f32_16x16x32_bf16 v[36:39], a[60:63], a[100:103], v[36:39]
    buffer_load_dwordx4 v120, s[44:47], s4 offen offset:1024 lds
    v_mfma_f32_16x16x32_bf16 v[48:51], a[60:63], a[104:107], v[48:51]
    v_mfma_f32_16x16x32_bf16 v[52:55], a[60:63], a[108:111], v[52:55]
    buffer_load_dwordx4 v121, s[44:47], s4 offen offset:2048 lds
    v_mfma_f32_16x16x32_bf16 v[64:67], a[64:67], a[96:99], v[64:67]
    v_mfma_f32_16x16x32_bf16 v[68:71], a[64:67], a[100:103], v[68:71]
    buffer_load_dwordx4 v122, s[44:47], s4 offen offset:3072 lds
    v_mfma_f32_16x16x32_bf16 v[80:83], a[64:67], a[104:107], v[80:83]
    v_mfma_f32_16x16x32_bf16 v[84:87], a[64:67], a[108:111], v[84:87]
    s_waitcnt lgkmcnt(0)
    s_nop 0
    v_mfma_f32_16x16x32_bf16 v[8:11], a[68:71], a[96:99], v[8:11]
    v_mfma_f32_16x16x32_bf16 v[12:15], a[68:71], a[100:103], v[12:15]
    s_setprio 3
    s_barrier
    ds_read2_b64 a[56:59], v123 offset0:32 offset1:36
    ds_read2_b64 a[60:63], v123 offset0:64 offset1:68
    ds_read2_b64 a[64:67], v123 offset0:96 offset1:100
    v_mfma_f32_16x16x32_bf16 v[24:27], a[68:71], a[104:107], v[24:27]
    v_mfma_f32_16x16x32_bf16 v[28:31], a[68:71], a[108:111], v[28:31]
    ds_read_b64_tr_b16 a[32:33], v117 offset:16384
    v_mfma_f32_16x16x32_bf16 v[40:43], a[72:75], a[96:99], v[40:43]
    v_mfma_f32_16x16x32_bf16 v[44:47], a[72:75], a[100:103], v[44:47]
    ds_read_b64_tr_b16 a[34:35], v117 offset:16896
    ds_read_b64_tr_b16 a[36:37], v118 offset:16384
    v_mfma_f32_16x16x32_bf16 v[56:59], a[72:75], a[104:107], v[56:59]
    v_mfma_f32_16x16x32_bf16 v[60:63], a[72:75], a[108:111], v[60:63]
    ds_read_b64_tr_b16 a[38:39], v118 offset:16896
    ds_read_b64_tr_b16 a[40:41], v117 offset:18432
    v_mfma_f32_16x16x32_bf16 v[72:75], a[76:79], a[96:99], v[72:75]
    v_mfma_f32_16x16x32_bf16 v[76:79], a[76:79], a[100:103], v[76:79]
    ds_read_b64_tr_b16 a[42:43], v117 offset:18944
    ds_read_b64_tr_b16 a[44:45], v118 offset:18432
    v_mfma_f32_16x16x32_bf16 v[88:91], a[76:79], a[104:107], v[88:91]
    v_mfma_f32_16x16x32_bf16 v[92:95], a[76:79], a[108:111], v[92:95]
    ds_read_b64_tr_b16 a[46:47], v118 offset:18944
    s_waitcnt lgkmcnt(0)
    v_mfma_f32_32x32x16_bf16 v[0:15], a[56:59], v[136:139], v[0:15]
    s_barrier
    v_mfma_f32_32x32x16_bf16 v[16:31], a[56:59], v[140:143], v[16:31]
    s_bfe_u32 s4, s43, 0x40018
    s_mul_i32 s4, s4, 28672
    s_add_u32 m0, s10, 16384
    s_add_u32 s4, s4, s22
    s_nop 0
    buffer_load_dwordx4 v119, s[44:47], s4 offen offset:0 lds
    v_mfma_f32_32x32x16_bf16 v[32:47], a[60:63], v[136:139], v[32:47]
    buffer_load_dwordx4 v120, s[44:47], s4 offen offset:1024 lds
    v_mfma_f32_32x32x16_bf16 v[48:63], a[60:63], v[140:143], v[48:63]
    buffer_load_dwordx4 v121, s[44:47], s4 offen offset:2048 lds
    v_mfma_f32_32x32x16_bf16 v[64:79], a[64:67], v[136:139], v[64:79]
    buffer_load_dwordx4 v122, s[44:47], s4 offen offset:3072 lds
    v_mfma_f32_32x32x16_bf16 v[80:95], a[64:67], v[140:143], v[80:95]
    s_setprio 1
    s_nop 4
    s_lshl_b32 s8, s25, 11
    s_add_u32 s8, s8, s23
    s_add_u32 s9, s8, 4096
    v_pk_mul_f32 v[136:137], v[0:1], v[0:1]
    v_pk_mul_f32 v[138:139], v[2:3], v[2:3]
    v_pk_mul_f32 v[140:141], v[4:5], v[4:5]
    v_pk_mul_f32 v[142:143], v[6:7], v[6:7]
    v_pk_fma_f32 v[136:137], v[136:137], v[132:133], v[128:129] op_sel_hi:[1,0,0]
    v_pk_fma_f32 v[138:139], v[138:139], v[132:133], v[128:129] op_sel_hi:[1,0,0]
    v_pk_fma_f32 v[140:141], v[140:141], v[134:135], v[130:131] op_sel_hi:[1,0,0]
    v_pk_fma_f32 v[142:143], v[142:143], v[134:135], v[130:131] op_sel_hi:[1,0,0]
    v_pk_mul_f32 v[136:137], v[0:1], v[136:137]
    v_pk_mul_f32 v[138:139], v[2:3], v[138:139]
    v_pk_mul_f32 v[140:141], v[4:5], v[140:141]
    v_pk_mul_f32 v[142:143], v[6:7], v[142:143]
    v_exp_f32 v136, v136
    v_exp_f32 v137, v137
    v_exp_f32 v138, v138
    v_exp_f32 v139, v139
    v_exp_f32 v140, v140
    s_waitcnt vmcnt(0)
    ds_read_b64_tr_b16 a[48:49], v117 offset:20480
    ds_read_b64_tr_b16 a[50:51], v117 offset:20992
    ds_read_b64_tr_b16 a[52:53], v118 offset:20480
    ds_read_b64_tr_b16 a[54:55], v118 offset:20992
    ds_read_b64_tr_b16 a[56:57], v117 offset:22528
    ds_read_b64_tr_b16 a[58:59], v117 offset:23040
    ds_read_b64_tr_b16 a[60:61], v118 offset:22528
    ds_read_b64_tr_b16 a[62:63], v118 offset:23040
    ds_read_b64_tr_b16 a[64:65], v117 offset:8192
    ds_read_b64_tr_b16 a[66:67], v117 offset:8704
    ds_read_b64_tr_b16 a[68:69], v118 offset:8192
    ds_read_b64_tr_b16 a[70:71], v118 offset:8704
    ds_read_b64_tr_b16 a[72:73], v117 offset:10240
    ds_read_b64_tr_b16 a[74:75], v117 offset:10752
    ds_read_b64_tr_b16 a[76:77], v118 offset:10240
    ds_read_b64_tr_b16 a[78:79], v118 offset:10752
    ds_read_b64_tr_b16 a[80:81], v117 offset:12288
    ds_read_b64_tr_b16 a[82:83], v117 offset:12800
    ds_read_b64_tr_b16 a[84:85], v118 offset:12288
    ds_read_b64_tr_b16 a[86:87], v118 offset:12800
    ds_read_b64_tr_b16 a[88:89], v117 offset:14336
    ds_read_b64_tr_b16 a[90:91], v117 offset:14848
    ds_read_b64_tr_b16 a[92:93], v118 offset:14336
    ds_read_b64_tr_b16 a[94:95], v118 offset:14848
    ds_read_b64_tr_b16 a[96:97], v117 offset:16384
    ds_read_b64_tr_b16 a[98:99], v117 offset:16896
    ds_read_b64_tr_b16 a[100:101], v118 offset:16384
    ds_read_b64_tr_b16 a[102:103], v118 offset:16896
    ds_read_b64_tr_b16 a[104:105], v117 offset:18432
    ds_read_b64_tr_b16 a[106:107], v117 offset:18944
    ds_read_b64_tr_b16 a[108:109], v118 offset:18432
    ds_read_b64_tr_b16 a[110:111], v118 offset:18944
    v_exp_f32 v141, v141
    v_exp_f32 v142, v142
    v_exp_f32_e64 v143, v143
    v_pk_mul_f32 v[0:1], v[0:1], v[8:9]
    v_pk_mul_f32 v[2:3], v[2:3], v[10:11]
    v_pk_mul_f32 v[4:5], v[4:5], v[12:13]
    v_pk_mul_f32 v[6:7], v[6:7], v[14:15]
    v_pk_fma_f32 v[136:137], v[136:137], v[124:125], v[124:125] op_sel_hi:[1,0,0]
    v_pk_fma_f32 v[138:139], v[138:139], v[124:125], v[124:125] op_sel_hi:[1,0,0]
    v_pk_fma_f32 v[140:141], v[140:141], v[126:127], v[126:127] op_sel_hi:[1,0,0]
    v_pk_fma_f32 v[142:143], v[142:143], v[126:127], v[126:127] op_sel_hi:[1,0,0]
    v_rcp_f32 v136, v136
    v_rcp_f32 v137, v137
    v_rcp_f32 v138, v138
    v_rcp_f32 v139, v139
    v_rcp_f32 v140, v140
    v_rcp_f32 v141, v141
    v_rcp_f32_e64 v142, v142
    v_rcp_f32 v143, v143
    s_lshl_b32 s3, s26, 2
    s_add_u32 s3, s3, 160832
    v_mov_b32 v116, s3
    s_mov_b64 exec, 1
    s_waitcnt lgkmcnt(0)
    ds_write_b32 v116, v114
    s_mov_b64 exec, -1
    v_pk_mul_f32 v[0:1], v[0:1], v[136:137]
    v_pk_mul_f32 v[2:3], v[2:3], v[138:139]
    v_pk_mul_f32 v[4:5], v[4:5], v[140:141]
    v_pk_mul_f32 v[6:7], v[6:7], v[142:143]
    v_cvt_pk_bf16_f32 v8, v0, v1
    v_cvt_pk_bf16_f32 v10, v4, v5
    v_cvt_pk_bf16_f32 v9, v2, v3
    v_cvt_pk_bf16_f32 v11, v6, v7
    s_nop 0
    v_permlane16_swap_b32 v8, v10
    v_permlane16_swap_b32 v9, v11
    s_nop 0
    buffer_store_dwordx4 v[8:11], v112, s[52:55], s8 offen offset:0 sc1
    v_pk_mul_f32 v[136:137], v[32:33], v[32:33]
    v_pk_mul_f32 v[138:139], v[34:35], v[34:35]
    v_pk_mul_f32 v[140:141], v[36:37], v[36:37]
    v_pk_mul_f32 v[142:143], v[38:39], v[38:39]
    v_pk_fma_f32 v[136:137], v[136:137], v[132:133], v[128:129] op_sel_hi:[1,0,0]
    v_pk_fma_f32 v[138:139], v[138:139], v[132:133], v[128:129] op_sel_hi:[1,0,0]
    v_pk_fma_f32 v[140:141], v[140:141], v[134:135], v[130:131] op_sel_hi:[1,0,0]
    v_pk_fma_f32 v[142:143], v[142:143], v[134:135], v[130:131] op_sel_hi:[1,0,0]
    v_pk_mul_f32 v[136:137], v[32:33], v[136:137]
    v_pk_mul_f32 v[138:139], v[34:35], v[138:139]
    v_pk_mul_f32 v[140:141], v[36:37], v[140:141]
    v_pk_mul_f32 v[142:143], v[38:39], v[142:143]
    v_exp_f32 v136, v136
    v_exp_f32 v137, v137
    v_exp_f32 v138, v138
    v_exp_f32 v139, v139
    v_exp_f32 v140, v140
    v_exp_f32 v141, v141
    v_exp_f32 v142, v142
    v_exp_f32 v143, v143
    v_pk_mul_f32 v[32:33], v[32:33], v[40:41]
    v_pk_mul_f32 v[34:35], v[34:35], v[42:43]
    v_pk_mul_f32 v[36:37], v[36:37], v[44:45]
    v_pk_mul_f32 v[38:39], v[38:39], v[46:47]
    v_pk_fma_f32 v[136:137], v[136:137], v[124:125], v[124:125] op_sel_hi:[1,0,0]
    v_pk_fma_f32 v[138:139], v[138:139], v[124:125], v[124:125] op_sel_hi:[1,0,0]
    v_pk_fma_f32 v[140:141], v[140:141], v[126:127], v[126:127] op_sel_hi:[1,0,0]
    v_pk_fma_f32 v[142:143], v[142:143], v[126:127], v[126:127] op_sel_hi:[1,0,0]
    v_rcp_f32 v136, v136
    v_rcp_f32 v137, v137
    v_rcp_f32 v138, v138
    v_rcp_f32 v139, v139
    v_rcp_f32 v140, v140
    v_rcp_f32 v141, v141
    v_rcp_f32 v142, v142
    v_rcp_f32 v143, v143
    v_pk_mul_f32 v[32:33], v[32:33], v[136:137]
    v_pk_mul_f32 v[34:35], v[34:35], v[138:139]
    v_pk_mul_f32 v[36:37], v[36:37], v[140:141]
    v_pk_mul_f32 v[38:39], v[38:39], v[142:143]
    v_cvt_pk_bf16_f32 v40, v32, v33
    v_cvt_pk_bf16_f32 v42, v36, v37
    v_cvt_pk_bf16_f32 v41, v34, v35
    v_cvt_pk_bf16_f32 v43, v38, v39
    s_nop 0
    v_permlane16_swap_b32 v40, v42
    v_permlane16_swap_b32 v41, v43
    s_nop 0
    buffer_store_dwordx4 v[40:43], v112, s[52:55], s8 offen offset:2048 sc1
    v_pk_mul_f32 v[136:137], v[64:65], v[64:65]
    v_pk_mul_f32 v[138:139], v[66:67], v[66:67]
    v_pk_mul_f32 v[140:141], v[68:69], v[68:69]
    v_pk_mul_f32 v[142:143], v[70:71], v[70:71]
    v_pk_fma_f32 v[136:137], v[136:137], v[132:133], v[128:129] op_sel_hi:[1,0,0]
    v_pk_fma_f32 v[138:139], v[138:139], v[132:133], v[128:129] op_sel_hi:[1,0,0]
    v_pk_fma_f32 v[140:141], v[140:141], v[134:135], v[130:131] op_sel_hi:[1,0,0]
    v_pk_fma_f32 v[142:143], v[142:143], v[134:135], v[130:131] op_sel_hi:[1,0,0]
    v_pk_mul_f32 v[136:137], v[64:65], v[136:137]
    v_pk_mul_f32 v[138:139], v[66:67], v[138:139]
    v_pk_mul_f32 v[140:141], v[68:69], v[140:141]
    v_pk_mul_f32 v[142:143], v[70:71], v[142:143]
    v_exp_f32 v136, v136
    v_exp_f32 v137, v137
    v_exp_f32 v138, v138
    v_exp_f32 v139, v139
    v_exp_f32 v140, v140
    v_exp_f32 v141, v141
    v_exp_f32 v142, v142
    v_exp_f32 v143, v143
    v_pk_mul_f32 v[64:65], v[64:65], v[72:73]
    v_pk_mul_f32 v[66:67], v[66:67], v[74:75]
    v_pk_mul_f32 v[68:69], v[68:69], v[76:77]
    v_pk_mul_f32 v[70:71], v[70:71], v[78:79]
    v_pk_fma_f32 v[136:137], v[136:137], v[124:125], v[124:125] op_sel_hi:[1,0,0]
    v_pk_fma_f32 v[138:139], v[138:139], v[124:125], v[124:125] op_sel_hi:[1,0,0]
    v_pk_fma_f32 v[140:141], v[140:141], v[126:127], v[126:127] op_sel_hi:[1,0,0]
    v_pk_fma_f32 v[142:143], v[142:143], v[126:127], v[126:127] op_sel_hi:[1,0,0]
    v_rcp_f32 v136, v136
    v_rcp_f32 v137, v137
    v_rcp_f32 v138, v138
    v_rcp_f32 v139, v139
    v_rcp_f32 v140, v140
    v_rcp_f32 v141, v141
    v_rcp_f32 v142, v142
    v_rcp_f32 v143, v143
    v_pk_mul_f32 v[64:65], v[64:65], v[136:137]
    v_pk_mul_f32 v[66:67], v[66:67], v[138:139]
    v_pk_mul_f32 v[68:69], v[68:69], v[140:141]
    v_pk_mul_f32 v[70:71], v[70:71], v[142:143]
    v_cvt_pk_bf16_f32 v72, v64, v65
    v_cvt_pk_bf16_f32 v74, v68, v69
    v_cvt_pk_bf16_f32 v73, v66, v67
    v_cvt_pk_bf16_f32 v75, v70, v71
    s_nop 0
    v_permlane16_swap_b32 v72, v74
    v_permlane16_swap_b32 v73, v75
    buffer_store_dwordx4 v[72:75], v112, s[52:55], s9 offen offset:0 sc1
    v_mul_f32 v132, v133, v133
    v_mul_f32 v128, 0xc0135761, v133
    v_mul_f32_e64 v134, v135, v135
    v_mul_f32 v130, 0xc0135761, v135
    v_mul_f32 v132, 0x3d372713, v132
    v_mul_f32 v134, 0x3d372713, v134
    v_mul_f32 v132, v128, v132
    v_mul_f32 v134, v130, v134
    v_pk_mul_f32 v[136:137], v[16:17], v[16:17]
    v_pk_mul_f32 v[138:139], v[18:19], v[18:19]
    v_pk_mul_f32 v[140:141], v[20:21], v[20:21]
    v_pk_mul_f32 v[142:143], v[22:23], v[22:23]
    v_pk_fma_f32 v[136:137], v[136:137], v[132:133], v[128:129] op_sel_hi:[1,0,0]
    v_pk_fma_f32 v[138:139], v[138:139], v[132:133], v[128:129] op_sel_hi:[1,0,0]
    v_pk_fma_f32 v[140:141], v[140:141], v[134:135], v[130:131] op_sel_hi:[1,0,0]
    v_pk_fma_f32 v[142:143], v[142:143], v[134:135], v[130:131] op_sel_hi:[1,0,0]
    v_pk_mul_f32 v[136:137], v[16:17], v[136:137]
    v_pk_mul_f32 v[138:139], v[18:19], v[138:139]
    v_pk_mul_f32 v[140:141], v[20:21], v[140:141]
    v_pk_mul_f32 v[142:143], v[22:23], v[142:143]
    v_exp_f32 v136, v136
    v_exp_f32 v137, v137
    v_exp_f32 v138, v138
    v_exp_f32 v139, v139
    v_exp_f32 v140, v140
    v_exp_f32 v141, v141
    v_exp_f32 v142, v142
    v_exp_f32 v143, v143
    v_pk_mul_f32 v[16:17], v[16:17], v[24:25]
    v_pk_mul_f32 v[18:19], v[18:19], v[26:27]
    v_pk_mul_f32 v[20:21], v[20:21], v[28:29]
    v_pk_mul_f32 v[22:23], v[22:23], v[30:31]
    v_pk_fma_f32 v[136:137], v[136:137], v[108:109], v[108:109] op_sel_hi:[1,0,0]
    v_pk_fma_f32 v[138:139], v[138:139], v[108:109], v[108:109] op_sel_hi:[1,0,0]
    v_pk_fma_f32 v[140:141], v[140:141], v[110:111], v[110:111] op_sel_hi:[1,0,0]
    v_pk_fma_f32 v[142:143], v[142:143], v[110:111], v[110:111] op_sel_hi:[1,0,0]
    v_rcp_f32 v136, v136
    v_rcp_f32 v137, v137
    v_rcp_f32 v138, v138
    v_rcp_f32 v139, v139
    v_rcp_f32 v140, v140
    v_rcp_f32 v141, v141
    v_rcp_f32 v142, v142
    v_rcp_f32 v143, v143
    v_pk_mul_f32 v[16:17], v[16:17], v[136:137]
    v_pk_mul_f32 v[18:19], v[18:19], v[138:139]
    v_pk_mul_f32 v[20:21], v[20:21], v[140:141]
    v_pk_mul_f32 v[22:23], v[22:23], v[142:143]
    v_cvt_pk_bf16_f32 v24, v16, v17
    v_cvt_pk_bf16_f32 v26, v20, v21
    v_cvt_pk_bf16_f32 v25, v18, v19
    v_cvt_pk_bf16_f32 v27, v22, v23
    s_nop 0
    v_permlane16_swap_b32 v24, v26
    v_permlane16_swap_b32 v25, v27
    s_nop 0
    buffer_store_dwordx4 v[24:27], v112, s[52:55], s8 offen offset:1024 sc1
    v_pk_mul_f32 v[136:137], v[48:49], v[48:49]
    v_pk_mul_f32 v[138:139], v[50:51], v[50:51]
    v_pk_mul_f32 v[140:141], v[52:53], v[52:53]
    v_pk_mul_f32 v[142:143], v[54:55], v[54:55]
    v_pk_fma_f32 v[136:137], v[136:137], v[132:133], v[128:129] op_sel_hi:[1,0,0]
    v_pk_fma_f32 v[138:139], v[138:139], v[132:133], v[128:129] op_sel_hi:[1,0,0]
    v_pk_fma_f32 v[140:141], v[140:141], v[134:135], v[130:131] op_sel_hi:[1,0,0]
    v_pk_fma_f32 v[142:143], v[142:143], v[134:135], v[130:131] op_sel_hi:[1,0,0]
    v_pk_mul_f32 v[136:137], v[48:49], v[136:137]
    v_pk_mul_f32 v[138:139], v[50:51], v[138:139]
    v_pk_mul_f32 v[140:141], v[52:53], v[140:141]
    v_pk_mul_f32 v[142:143], v[54:55], v[142:143]
    v_exp_f32 v136, v136
    v_exp_f32 v137, v137
    v_exp_f32 v138, v138
    v_exp_f32 v139, v139
    v_exp_f32 v140, v140
    v_exp_f32 v141, v141
    v_exp_f32 v142, v142
    v_exp_f32 v143, v143
    v_pk_mul_f32 v[48:49], v[48:49], v[56:57]
    v_pk_mul_f32 v[50:51], v[50:51], v[58:59]
    v_pk_mul_f32 v[52:53], v[52:53], v[60:61]
    v_pk_mul_f32 v[54:55], v[54:55], v[62:63]
    v_pk_fma_f32 v[136:137], v[136:137], v[108:109], v[108:109] op_sel_hi:[1,0,0]
    v_pk_fma_f32 v[138:139], v[138:139], v[108:109], v[108:109] op_sel_hi:[1,0,0]
    v_pk_fma_f32 v[140:141], v[140:141], v[110:111], v[110:111] op_sel_hi:[1,0,0]
    v_pk_fma_f32 v[142:143], v[142:143], v[110:111], v[110:111] op_sel_hi:[1,0,0]
    v_rcp_f32 v136, v136
    v_rcp_f32 v137, v137
    v_rcp_f32 v138, v138
    v_rcp_f32 v139, v139
    v_rcp_f32 v140, v140
    v_rcp_f32 v141, v141
    v_rcp_f32 v142, v142
    v_rcp_f32 v143, v143
    v_pk_mul_f32 v[48:49], v[48:49], v[136:137]
    v_pk_mul_f32 v[50:51], v[50:51], v[138:139]
    v_pk_mul_f32 v[52:53], v[52:53], v[140:141]
    v_pk_mul_f32 v[54:55], v[54:55], v[142:143]
    v_cvt_pk_bf16_f32 v56, v48, v49
    v_cvt_pk_bf16_f32 v58, v52, v53
    v_cvt_pk_bf16_f32 v57, v50, v51
    v_cvt_pk_bf16_f32 v59, v54, v55
    s_nop 0
    v_permlane16_swap_b32 v56, v58
    v_permlane16_swap_b32 v57, v59
    s_nop 0
    buffer_store_dwordx4 v[56:59], v112, s[52:55], s8 offen offset:3072 sc1
    v_pk_mul_f32 v[136:137], v[80:81], v[80:81]
    v_pk_mul_f32 v[138:139], v[82:83], v[82:83]
    v_pk_mul_f32 v[140:141], v[84:85], v[84:85]
    v_pk_mul_f32 v[142:143], v[86:87], v[86:87]
    v_pk_fma_f32 v[136:137], v[136:137], v[132:133], v[128:129] op_sel_hi:[1,0,0]
    v_pk_fma_f32 v[138:139], v[138:139], v[132:133], v[128:129] op_sel_hi:[1,0,0]
    v_pk_fma_f32 v[140:141], v[140:141], v[134:135], v[130:131] op_sel_hi:[1,0,0]
    v_pk_fma_f32 v[142:143], v[142:143], v[134:135], v[130:131] op_sel_hi:[1,0,0]
    v_pk_mul_f32 v[136:137], v[80:81], v[136:137]
    v_pk_mul_f32 v[138:139], v[82:83], v[138:139]
    v_pk_mul_f32 v[140:141], v[84:85], v[140:141]
    v_pk_mul_f32 v[142:143], v[86:87], v[142:143]
    v_exp_f32 v136, v136
    v_exp_f32 v137, v137
    v_exp_f32 v138, v138
    v_exp_f32 v139, v139
    v_exp_f32 v140, v140
    v_exp_f32 v141, v141
    v_exp_f32 v142, v142
    v_exp_f32 v143, v143
    v_pk_mul_f32 v[80:81], v[80:81], v[88:89]
    v_pk_mul_f32 v[82:83], v[82:83], v[90:91]
    v_pk_mul_f32 v[84:85], v[84:85], v[92:93]
    v_pk_mul_f32 v[86:87], v[86:87], v[94:95]
    v_pk_fma_f32 v[136:137], v[136:137], v[108:109], v[108:109] op_sel_hi:[1,0,0]
    v_pk_fma_f32 v[138:139], v[138:139], v[108:109], v[108:109] op_sel_hi:[1,0,0]
    v_pk_fma_f32 v[140:141], v[140:141], v[110:111], v[110:111] op_sel_hi:[1,0,0]
    v_pk_fma_f32 v[142:143], v[142:143], v[110:111], v[110:111] op_sel_hi:[1,0,0]
    v_rcp_f32 v136, v136
    v_rcp_f32 v137, v137
    v_rcp_f32 v138, v138
    v_rcp_f32 v139, v139
    v_rcp_f32 v140, v140
    v_rcp_f32 v141, v141
    v_rcp_f32 v142, v142
    v_rcp_f32 v143, v143
    v_pk_mul_f32 v[80:81], v[80:81], v[136:137]
    v_pk_mul_f32 v[82:83], v[82:83], v[138:139]
    v_pk_mul_f32 v[84:85], v[84:85], v[140:141]
    v_pk_mul_f32 v[86:87], v[86:87], v[142:143]
    v_cvt_pk_bf16_f32 v88, v80, v81
    v_cvt_pk_bf16_f32 v90, v84, v85
    v_cvt_pk_bf16_f32 v89, v82, v83
    v_cvt_pk_bf16_f32 v91, v86, v87
    s_nop 0
    v_permlane16_swap_b32 v88, v90
    v_permlane16_swap_b32 v89, v91
    buffer_store_dwordx4 v[88:91], v112, s[52:55], s9 offen offset:1024 sc1
    s_setprio 0
    s_waitcnt vmcnt(0)
    s_mov_b32 s42, 1
    s_atomic_add s42, s[52:53], s16
    s_cmp_eq_u32 s21, 7
    s_cbranch_scc1 L_endP
L_waitP:
    s_mov_b32 s24, 0
L_hP_7:
    s_add_u32 s24, s24, 1
    s_cmp_gt_u32 s24, 200000
    s_cbranch_scc1 L_hP_7x
    s_add_u32 s3, s34, 0
    s_load_dword s68, s[52:53], s3 glc
L_hP_7c:
    s_waitcnt lgkmcnt(0)
    s_cmp_lt_u32 s68, 8
    s_cbranch_scc1 L_hP_7
L_hP_7x:
    s_bfe_u32 s36, s43, 0x40000
    s_lshl_b32 s36, s36, 12
    s_add_u32 s36, s36, s33
    s_nop 0
    buffer_load_dwordx4 v[64:67], v112, s[52:55], s36 offen offset:0 sc1
    buffer_load_dwordx4 v[68:71], v112, s[52:55], s36 offen offset:1024 sc1
    buffer_load_dwordx4 v[72:75], v112, s[52:55], s36 offen offset:2048 sc1
    buffer_load_dwordx4 v[76:79], v112, s[52:55], s36 offen offset:3072 sc1
    s_bfe_u32 s36, s43, 0x40004
    s_lshl_b32 s36, s36, 12
    s_add_u32 s36, s36, s33
    buffer_load_dwordx4 v[80:83], v112, s[52:55], s36 offen offset:0 sc1
    buffer_load_dwordx4 v[84:87], v112, s[52:55], s36 offen offset:1024 sc1
    buffer_load_dwordx4 v[88:91], v112, s[52:55], s36 offen offset:2048 sc1
    buffer_load_dwordx4 v[92:95], v112, s[52:55], s36 offen offset:3072 sc1
L_tailP:
    v_lshrrev_b32_e64 v119, 7, v112
    v_mul_u32_u24 v123, 896, v119
    v_and_b32 v120, 0x70, v112
    v_add_u32 v123, v123, v120
    v_lshrrev_b32 v120, 3, v120
    v_xor_b32 v120, v120, v119
    v_lshlrev_b32 v119, 8, v119
    s_lshl_b32 s3, s26, 11
    v_add_u32 v119, s3, v119
    v_lshl_add_u32 v132, v120, 4, v119
    v_xor_b32_e64 v133, 16, v132
    v_add_u32 v134, 49152, v132
    v_add_u32 v135, 49152, v133
    v_add_u32 v124, 98304, v132
    v_add_u32 v125, 98304, v133
    v_bfe_u32 v119, v112, 4, 5
    v_lshrrev_b32 v120, 9, v112
    v_and_b32 v121, 7, v119
    v_xor_b32 v120, v120, v121
    v_lshlrev_b32 v119, 8, v119
    v_lshl_add_u32 v119, v120, 4, v119
    v_add_u32 v128, s10, v119
    v_xor_b32 v129, 32, v128
    v_xor_b32_e64 v130, 64, v128
    v_xor_b32 v131, 96, v128
    s_waitcnt vmcnt(7) lgkmcnt(0)
    v_mfma_f32_32x32x16_bf16 v[0:15], a[0:3], v[64:67], 0
    s_bfe_u32 s36, s43, 0x40008
    s_lshl_b32 s36, s36, 12
    s_add_u32 s36, s36, s33
    buffer_load_dwordx4 v[96:99], v112, s[52:55], s36 offen offset:0 sc1
    v_mfma_f32_32x32x16_bf16 v[32:47], a[4:7], v[64:67], 0
    s_waitcnt vmcnt(7)
    v_mfma_f32_32x32x16_bf16 v[16:31], a[0:3], v[68:71], 0
    buffer_load_dwordx4 v[100:103], v112, s[52:55], s36 offen offset:1024 sc1
    v_mfma_f32_32x32x16_bf16 v[48:63], a[4:7], v[68:71], 0
    s_waitcnt vmcnt(7)
    v_mfma_f32_32x32x16_bf16 v[0:15], a[8:11], v[72:75], v[0:15]
    buffer_load_dwordx4 v[104:107], v112, s[52:55], s36 offen offset:2048 sc1
    v_mfma_f32_32x32x16_bf16 v[32:47], a[12:15], v[72:75], v[32:47]
    s_waitcnt vmcnt(7)
    v_mfma_f32_32x32x16_bf16 v[16:31], a[8:11], v[76:79], v[16:31]
    buffer_load_dwordx4 v[108:111], v112, s[52:55], s36 offen offset:3072 sc1
    v_mfma_f32_32x32x16_bf16 v[48:63], a[12:15], v[76:79], v[48:63]
    s_waitcnt vmcnt(7)
    v_mfma_f32_32x32x16_bf16 v[0:15], a[16:19], v[80:83], v[0:15]
    s_bfe_u32 s36, s43, 0x4000c
    s_lshl_b32 s36, s36, 12
    s_add_u32 s36, s36, s33
    buffer_load_dwordx4 v[64:67], v112, s[52:55], s36 offen offset:0 sc1
    v_mfma_f32_32x32x16_bf16 v[32:47], a[20:23], v[80:83], v[32:47]
    s_waitcnt vmcnt(7)
    v_mfma_f32_32x32x16_bf16 v[16:31], a[16:19], v[84:87], v[16:31]
    buffer_load_dwordx4 v[68:71], v112, s[52:55], s36 offen offset:1024 sc1
    v_mfma_f32_32x32x16_bf16 v[48:63], a[20:23], v[84:87], v[48:63]
    s_waitcnt vmcnt(7)
    v_mfma_f32_32x32x16_bf16 v[0:15], a[24:27], v[88:91], v[0:15]
    buffer_load_dwordx4 v[72:75], v112, s[52:55], s36 offen offset:2048 sc1
    v_mfma_f32_32x32x16_bf16 v[32:47], a[28:31], v[88:91], v[32:47]
    s_waitcnt vmcnt(7)
    v_mfma_f32_32x32x16_bf16 v[16:31], a[24:27], v[92:95], v[16:31]
    buffer_load_dwordx4 v[76:79], v112, s[52:55], s36 offen offset:3072 sc1
    v_mfma_f32_32x32x16_bf16 v[48:63], a[28:31], v[92:95], v[48:63]
    s_waitcnt vmcnt(7)
    v_mfma_f32_32x32x16_bf16 v[0:15], a[32:35], v[96:99], v[0:15]
    s_bfe_u32 s36, s43, 0x40010
    s_lshl_b32 s36, s36, 12
    s_add_u32 s36, s36, s33
    buffer_load_dwordx4 v[80:83], v112, s[52:55], s36 offen offset:0 sc1
    v_mfma_f32_32x32x16_bf16 v[32:47], a[36:39], v[96:99], v[32:47]
    s_waitcnt vmcnt(7)
    v_mfma_f32_32x32x16_bf16 v[16:31], a[32:35], v[100:103], v[16:31]
    buffer_load_dwordx4 v[84:87], v112, s[52:55], s36 offen offset:1024 sc1
    v_mfma_f32_32x32x16_bf16 v[48:63], a[36:39], v[100:103], v[48:63]
    s_waitcnt vmcnt(7)
    v_mfma_f32_32x32x16_bf16 v[0:15], a[40:43], v[104:107], v[0:15]
    buffer_load_dwordx4 v[88:91], v112, s[52:55], s36 offen offset:2048 sc1
    v_mfma_f32_32x32x16_bf16 v[32:47], a[44:47], v[104:107], v[32:47]
    s_waitcnt vmcnt(7)
    v_mfma_f32_32x32x16_bf16 v[16:31], a[40:43], v[108:111], v[16:31]
    buffer_load_dwordx4 v[92:95], v112, s[52:55], s36 offen offset:3072 sc1
    v_mfma_f32_32x32x16_bf16 v[48:63], a[44:47], v[108:111], v[48:63]
    s_waitcnt vmcnt(7)
    v_mfma_f32_32x32x16_bf16 v[0:15], a[48:51], v[64:67], v[0:15]
    s_bfe_u32 s36, s43, 0x40014
    s_lshl_b32 s36, s36, 12
    s_add_u32 s36, s36, s33
    buffer_load_dwordx4 v[96:99], v112, s[52:55], s36 offen offset:0 sc1
    v_mfma_f32_32x32x16_bf16 v[32:47], a[52:55], v[64:67], v[32:47]
    s_waitcnt vmcnt(7)
    v_mfma_f32_32x32x16_bf16 v[16:31], a[48:51], v[68:71], v[16:31]
    buffer_load_dwordx4 v[100:103], v112, s[52:55], s36 offen offset:1024 sc1
    v_mfma_f32_32x32x16_bf16 v[48:63], a[52:55], v[68:71], v[48:63]
    s_waitcnt vmcnt(7)
    v_mfma_f32_32x32x16_bf16 v[0:15], a[56:59], v[72:75], v[0:15]
    buffer_load_dwordx4 v[104:107], v112, s[52:55], s36 offen offset:2048 sc1
    v_mfma_f32_32x32x16_bf16 v[32:47], a[60:63], v[72:75], v[32:47]
    s_waitcnt vmcnt(7)
    v_mfma_f32_32x32x16_bf16 v[16:31], a[56:59], v[76:79], v[16:31]
    buffer_load_dwordx4 v[108:111], v112, s[52:55], s36 offen offset:3072 sc1
    v_mfma_f32_32x32x16_bf16 v[48:63], a[60:63], v[76:79], v[48:63]
    s_waitcnt vmcnt(7)
    v_mfma_f32_32x32x16_bf16 v[0:15], a[64:67], v[80:83], v[0:15]
    s_bfe_u32 s36, s43, 0x40018
    s_lshl_b32 s36, s36, 12
    s_add_u32 s36, s36, s33
    buffer_load_dwordx4 v[64:67], v112, s[52:55], s36 offen offset:0 sc1
    v_mfma_f32_32x32x16_bf16 v[32:47], a[68:71], v[80:83], v[32:47]
    s_waitcnt vmcnt(7)
    v_mfma_f32_32x32x16_bf16 v[16:31], a[64:67], v[84:87], v[16:31]
    buffer_load_dwordx4 v[68:71], v112, s[52:55], s36 offen offset:1024 sc1
    v_mfma_f32_32x32x16_bf16 v[48:63], a[68:71], v[84:87], v[48:63]
    s_waitcnt vmcnt(7)
    v_mfma_f32_32x32x16_bf16 v[0:15], a[72:75], v[88:91], v[0:15]
    buffer_load_dwordx4 v[72:75], v112, s[52:55], s36 offen offset:2048 sc1
    v_mfma_f32_32x32x16_bf16 v[32:47], a[76:79], v[88:91], v[32:47]
    s_waitcnt vmcnt(7)
    v_mfma_f32_32x32x16_bf16 v[16:31], a[72:75], v[92:95], v[16:31]
    buffer_load_dwordx4 v[76:79], v112, s[52:55], s36 offen offset:3072 sc1
    v_mfma_f32_32x32x16_bf16 v[48:63], a[76:79], v[92:95], v[48:63]
    s_waitcnt vmcnt(7)
    buffer_load_dwordx4 v[136:139], v123, s[28:31], s35 offen
    buffer_load_dwordx4 v[140:143], v123, s[28:31], s32 offen
    v_mfma_f32_32x32x16_bf16 v[0:15], a[80:83], v[96:99], v[0:15]
    v_mfma_f32_32x32x16_bf16 v[32:47], a[84:87], v[96:99], v[32:47]
    s_waitcnt vmcnt(8)
    v_mfma_f32_32x32x16_bf16 v[16:31], a[80:83], v[100:103], v[16:31]
    v_mfma_f32_32x32x16_bf16 v[48:63], a[84:87], v[100:103], v[48:63]
    s_waitcnt vmcnt(7)
    v_mfma_f32_32x32x16_bf16 v[0:15], a[88:91], v[104:107], v[0:15]
    v_mfma_f32_32x32x16_bf16 v[32:47], a[92:95], v[104:107], v[32:47]
    s_waitcnt vmcnt(6)
    v_mfma_f32_32x32x16_bf16 v[16:31], a[88:91], v[108:111], v[16:31]
    v_mfma_f32_32x32x16_bf16 v[48:63], a[92:95], v[108:111], v[48:63]
    s_waitcnt vmcnt(5)
    v_mfma_f32_32x32x16_bf16 v[0:15], a[96:99], v[64:67], v[0:15]
    v_mfma_f32_32x32x16_bf16 v[32:47], a[100:103], v[64:67], v[32:47]
    s_waitcnt vmcnt(4)
    v_mfma_f32_32x32x16_bf16 v[16:31], a[96:99], v[68:71], v[16:31]
    v_mfma_f32_32x32x16_bf16 v[48:63], a[100:103], v[68:71], v[48:63]
    s_waitcnt vmcnt(3)
    v_mfma_f32_32x32x16_bf16 v[0:15], a[104:107], v[72:75], v[0:15]
    v_mfma_f32_32x32x16_bf16 v[32:47], a[108:111], v[72:75], v[32:47]
    s_waitcnt vmcnt(2)
    v_mfma_f32_32x32x16_bf16 v[16:31], a[104:107], v[76:79], v[16:31]
    v_mfma_f32_32x32x16_bf16 v[48:63], a[108:111], v[76:79], v[48:63]
    s_waitcnt vmcnt(0)
    v_lshlrev_b32 v64, 16, v136
    v_and_b32 v65, 0xffff0000, v136
    v_lshlrev_b32_e64 v66, 16, v137
    v_and_b32 v67, 0xffff0000, v137
    v_lshlrev_b32_e64 v68, 16, v138
    v_and_b32 v69, 0xffff0000, v138
    v_lshlrev_b32_e64 v70, 16, v139
    v_and_b32 v71, 0xffff0000, v139
    v_lshlrev_b32_e64 v72, 16, v140
    v_and_b32 v73, 0xffff0000, v140
    v_lshlrev_b32_e64 v74, 16, v141
    v_and_b32 v75, 0xffff0000, v141
    v_lshlrev_b32_e64 v76, 16, v142
    v_and_b32 v77, 0xffff0000, v142
    v_lshlrev_b32_e64 v78, 16, v143
    v_and_b32 v79, 0xffff0000, v143
    v_mov_b32 v116, 160848
L_sy_8:
    ds_read_b128 v[136:139], v116
    s_waitcnt lgkmcnt(0)
    v_min3_u32 v136, v136, v137, v138
    v_min_u32 v136, v136, v139
    v_cmp_eq_u32 vcc, 0, v136
    s_cbranch_vccnz L_sy_8
    ds_write_b128 v128, v[0:3] offset:8192
    ds_write_b128 v129, v[4:7] offset:8192
    ds_write_b128 v130, v[8:11] offset:8192
    ds_write_b128 v131, v[12:15] offset:8192
    ds_write_b128 v128, v[32:35] offset:8320
    ds_write_b128 v129, v[36:39] offset:8320
    ds_write_b128 v130, v[40:43] offset:8320
    ds_write_b128 v131, v[44:47] offset:8320
    ds_write_b128 v128, v[16:19] offset:16384
    ds_write_b128 v129, v[20:23] offset:16384
    ds_write_b128 v130, v[24:27] offset:16384
    ds_write_b128 v131, v[28:31] offset:16384
    ds_write_b128 v128, v[48:51] offset:16512
    ds_write_b128 v129, v[52:55] offset:16512
    ds_write_b128 v130, v[56:59] offset:16512
    ds_write_b128 v131, v[60:63] offset:16512
    s_lshl_b32 s3, s26, 2
    s_add_u32 s3, s3, 160816
    v_mov_b32 v116, s3
    s_mov_b64 exec, 1
    s_waitcnt lgkmcnt(0)
    ds_write_b32 v116, v114
    s_mov_b64 exec, -1
    v_mov_b32 v116, 160816
L_sy_9:
    ds_read_b128 v[136:139], v116
    s_waitcnt lgkmcnt(0)
    v_min3_u32 v136, v136, v137, v138
    v_min_u32_e64 v136, v136, v139
    v_cmp_eq_u32 vcc, 0, v136
    s_cbranch_vccnz L_sy_9
    ds_read_b128 v[0:3], v132 offset:8192
    ds_read_b128 v[4:7], v133 offset:8192
    ds_read_b128 v[8:11], v132 offset:32768
    ds_read_b128 v[12:15], v133 offset:32768
    ds_read_b128 v[16:19], v134 offset:8192
    ds_read_b128 v[20:23], v135 offset:8192
    ds_read_b128 v[24:27], v134 offset:32768
    ds_read_b128 v[28:31], v135 offset:32768
    s_waitcnt lgkmcnt(6)
    v_add_f32 v64, v64, v0
    v_add_f32 v65, v65, v1
    v_add_f32 v66, v66, v2
    v_add_f32 v67, v67, v3
    v_add_f32 v68, v68, v4
    v_add_f32 v69, v69, v5
    v_add_f32 v70, v70, v6
    v_add_f32 v71, v71, v7
    s_waitcnt lgkmcnt(4)
    v_add_f32 v64, v64, v8
    v_add_f32 v65, v65, v9
    v_add_f32 v66, v66, v10
    v_add_f32 v67, v67, v11
    v_add_f32 v68, v68, v12
    v_add_f32 v69, v69, v13
    v_add_f32 v70, v70, v14
    v_add_f32 v71, v71, v15
    s_waitcnt lgkmcnt(2)
    v_add_f32 v64, v64, v16
    v_add_f32 v65, v65, v17
    v_add_f32 v66, v66, v18
    v_add_f32 v67, v67, v19
    v_add_f32 v68, v68, v20
    v_add_f32 v69, v69, v21
    v_add_f32 v70, v70, v22
    v_add_f32 v71, v71, v23
    s_waitcnt lgkmcnt(0)
    v_add_f32 v64, v64, v24
    v_add_f32 v65, v65, v25
    v_add_f32 v66, v66, v26
    v_add_f32 v67, v67, v27
    v_add_f32 v68, v68, v28
    v_add_f32 v69, v69, v29
    v_add_f32 v70, v70, v30
    v_add_f32 v71, v71, v31
    ds_read_b128 v[0:3], v132 offset:16384
    ds_read_b128 v[4:7], v133 offset:16384
    ds_read_b128 v[8:11], v132 offset:40960
    ds_read_b128 v[12:15], v133 offset:40960
    ds_read_b128 v[16:19], v134 offset:16384
    ds_read_b128 v[20:23], v135 offset:16384
    ds_read_b128 v[24:27], v134 offset:40960
    ds_read_b128 v[28:31], v135 offset:40960
    s_waitcnt lgkmcnt(6)
    v_add_f32 v72, v72, v0
    v_add_f32 v73, v73, v1
    v_add_f32 v74, v74, v2
    v_add_f32 v75, v75, v3
    v_add_f32 v76, v76, v4
    v_add_f32 v77, v77, v5
    v_add_f32 v78, v78, v6
    v_add_f32 v79, v79, v7
    s_waitcnt lgkmcnt(4)
    v_add_f32 v72, v72, v8
    v_add_f32 v73, v73, v9
    v_add_f32 v74, v74, v10
    v_add_f32 v75, v75, v11
    v_add_f32 v76, v76, v12
    v_add_f32 v77, v77, v13
    v_add_f32 v78, v78, v14
    v_add_f32 v79, v79, v15
    s_waitcnt lgkmcnt(2)
    v_add_f32 v72, v72, v16
    v_add_f32 v73, v73, v17
    v_add_f32 v74, v74, v18
    v_add_f32 v75, v75, v19
    v_add_f32 v76, v76, v20
    v_add_f32 v77, v77, v21
    v_add_f32 v78, v78, v22
    v_add_f32 v79, v79, v23
    s_waitcnt lgkmcnt(0)
    v_add_f32 v72, v72, v24
    v_add_f32 v73, v73, v25
    v_add_f32 v74, v74, v26
    v_add_f32 v75, v75, v27
    v_add_f32 v76, v76, v28
    v_add_f32 v77, v77, v29
    v_add_f32_e64 v78, v78, v30
    v_add_f32 v79, v79, v31
    s_barrier
    ds_read_b128 v[0:3], v132 offset:0
    ds_read_b128 v[4:7], v133 offset:0
    ds_read_b128 v[8:11], v132 offset:24576
    ds_read_b128 v[12:15], v133 offset:24576
    ds_read_b128 v[16:19], v134 offset:0
    ds_read_b128 v[20:23], v135 offset:0
    ds_read_b128 v[24:27], v134 offset:24576
    ds_read_b128 v[28:31], v135 offset:24576
    s_waitcnt lgkmcnt(6)
    v_add_f32 v64, v64, v0
    v_add_f32 v65, v65, v1
    v_add_f32 v66, v66, v2
    v_add_f32 v67, v67, v3
    v_add_f32 v68, v68, v4
    v_add_f32 v69, v69, v5
    v_add_f32 v70, v70, v6
    v_add_f32 v71, v71, v7
    s_waitcnt lgkmcnt(4)
    v_add_f32 v64, v64, v8
    v_add_f32 v65, v65, v9
    v_add_f32 v66, v66, v10
    v_add_f32 v67, v67, v11
    v_add_f32 v68, v68, v12
    v_add_f32 v69, v69, v13
    v_add_f32 v70, v70, v14
    v_add_f32 v71, v71, v15
    s_waitcnt lgkmcnt(2)
    v_add_f32 v64, v64, v16
    v_add_f32 v65, v65, v17
    v_add_f32 v66, v66, v18
    v_add_f32 v67, v67, v19
    v_add_f32 v68, v68, v20
    v_add_f32 v69, v69, v21
    v_add_f32 v70, v70, v22
    v_add_f32 v71, v71, v23
    s_waitcnt lgkmcnt(0)
    v_add_f32 v64, v64, v24
    v_add_f32 v65, v65, v25
    v_add_f32 v66, v66, v26
    v_add_f32 v67, v67, v27
    v_add_f32 v68, v68, v28
    v_add_f32 v69, v69, v29
    v_add_f32_e64 v70, v70, v30
    v_add_f32 v71, v71, v31
    v_cvt_pk_bf16_f32 v80, v64, v65
    v_cvt_pk_bf16_f32 v81, v66, v67
    v_cvt_pk_bf16_f32 v82, v68, v69
    v_cvt_pk_bf16_f32 v83, v70, v71
    buffer_store_dwordx4 v[80:83], v123, s[56:59], s35 offen sc1
    s_barrier
    ds_read_b128 v[0:3], v124 offset:0
    ds_read_b128 v[4:7], v125 offset:0
    ds_read_b128 v[8:11], v124 offset:14336
    ds_read_b128 v[12:15], v125 offset:14336
    ds_read_b128 v[16:19], v124 offset:28672
    ds_read_b128 v[20:23], v125 offset:28672
    ds_read_b128 v[24:27], v124 offset:43008
    ds_read_b128 v[28:31], v125 offset:43008
    s_waitcnt lgkmcnt(6)
    v_add_f32 v72, v72, v0
    v_add_f32 v73, v73, v1
    v_add_f32 v74, v74, v2
    v_add_f32 v75, v75, v3
    v_add_f32 v76, v76, v4
    v_add_f32 v77, v77, v5
    v_add_f32 v78, v78, v6
    v_add_f32 v79, v79, v7
    s_waitcnt lgkmcnt(4)
    v_add_f32 v72, v72, v8
    v_add_f32 v73, v73, v9
    v_add_f32 v74, v74, v10
    v_add_f32 v75, v75, v11
    v_add_f32 v76, v76, v12
    v_add_f32 v77, v77, v13
    v_add_f32 v78, v78, v14
    v_add_f32 v79, v79, v15
    s_waitcnt lgkmcnt(2)
    v_add_f32 v72, v72, v16
    v_add_f32 v73, v73, v17
    v_add_f32 v74, v74, v18
    v_add_f32 v75, v75, v19
    v_add_f32 v76, v76, v20
    v_add_f32 v77, v77, v21
    v_add_f32 v78, v78, v22
    v_add_f32 v79, v79, v23
    s_waitcnt lgkmcnt(0)
    v_add_f32 v72, v72, v24
    v_add_f32 v73, v73, v25
    v_add_f32 v74, v74, v26
    v_add_f32 v75, v75, v27
    v_add_f32 v76, v76, v28
    v_add_f32 v77, v77, v29
    v_add_f32 v78, v78, v30
    v_add_f32 v79, v79, v31
    v_cvt_pk_bf16_f32 v84, v72, v73
    v_cvt_pk_bf16_f32 v85, v74, v75
    v_cvt_pk_bf16_f32 v86, v76, v77
    v_cvt_pk_bf16_f32 v87, v78, v79
    buffer_store_dwordx4 v[84:87], v123, s[56:59], s32 offen sc1
L_endP:
    s_endpgm
L_in_2f:
    s_mov_b32 s24, 0
L_in_2l:
    buffer_load_dword v115, v116, s[60:63], 0 offen sc1
    s_add_u32 s24, s24, 1
    s_waitcnt vmcnt(0)
    v_cmp_gt_u32 vcc, 16, v115
    s_and_b32 s3, vcc_lo, 3
    s_cbranch_scc0 L_in_2b
    s_cmp_lt_u32 s24, 200000
    s_cbranch_scc1 L_in_2l
    s_branch L_in_2b
L_sc_4f:
    s_mov_b32 s24, 0
    v_mov_b32_e64 v116, s6
    v_writelane_b32 v116, s14, 1
L_sc_4l:
    s_sleep 4
    s_mov_b64 exec, 3
    buffer_load_dword v115, v116, s[52:55], 0 offen sc1
    s_add_u32 s24, s24, 1
    s_waitcnt vmcnt(0)
    v_cmp_gt_u32 vcc, 8, v115
    s_mov_b64 exec, -1
    s_cbranch_vccz L_sc_4b
    s_cmp_lt_u32 s24, 200000
    s_cbranch_scc1 L_sc_4l
    s_branch L_sc_4b
L_KVF:
    v_lshlrev_b32 v19, 2, v15
    v_sub_u32_e64 v19, v16, v19
    v_mul_u32_u24 v19, 96, v19
    v_lshl_add_u32 v19, v14, 3, v19
    v_add_u32 v98, 106496, v19
    s_add_u32 s76, s76, 1
    s_cmp_eq_u32 s76, 7
    s_cselect_b32 s76, 0, s76
    s_mul_i32 s6, s76, 172032
    s_add_u32 s6, s6, s78
    s_add_u32 m0, s11, 20736
    s_mul_i32 s8, s76, 229376
    buffer_load_dwordx4 v101, s[32:35], s6 offen lds
    s_add_u32 m0, s11, 24832
    s_add_u32 s7, s6, 896
    buffer_load_dwordx4 v101, s[32:35], s7 offen lds
    s_add_u32 m0, s12, 20736
    s_add_u32 s8, s8, s79
    s_nop 0
    buffer_load_dwordx4 v102, s[68:71], s8 offen lds
    buffer_load_dwordx4 v103, s[68:71], s8 offen offset:1024 lds
    buffer_load_dwordx4 v104, s[68:71], s8 offen offset:2048 lds
    s_waitcnt vmcnt(5) lgkmcnt(0)
    s_barrier
    ds_read_b64_tr_b16 a[56:57], v98 offset:0
    ds_read_b64_tr_b16 a[58:59], v98 offset:768
    ds_read_b128 a[80:83], v96 offset:0
    ds_read_b128 a[84:87], v96 offset:2048
    ds_read_b128 a[88:91], v96 offset:4096
    ds_read_b128 a[92:95], v96 offset:6144
    ds_read_b64_tr_b16 a[60:61], v98 offset:32
    ds_read_b64_tr_b16 a[62:63], v98 offset:800
    ds_read_b64_tr_b16 a[64:65], v98 offset:64
    ds_read_b64_tr_b16 a[66:67], v98 offset:832
    s_setprio 1
    s_waitcnt lgkmcnt(0)
    v_mfma_f32_16x16x32_bf16 v[0:3], a[56:59], a[80:83], 0
    v_mfma_f32_16x16x32_bf16 v[4:7], a[56:59], a[84:87], 0
    ds_read_b64_tr_b16 a[68:69], v98 offset:6272
    ds_read_b64_tr_b16 a[70:71], v98 offset:7040
    ds_read_b64_tr_b16 a[72:73], v98 offset:6304
    ds_read_b64_tr_b16 a[74:75], v98 offset:7072
    v_mfma_f32_16x16x32_bf16 v[16:19], a[56:59], a[88:91], 0
    v_mfma_f32_16x16x32_bf16 v[20:23], a[56:59], a[92:95], 0
    ds_read_b64_tr_b16 a[76:77], v98 offset:6336
    ds_read_b64_tr_b16 a[78:79], v98 offset:7104
    ds_read_b128 a[96:99], v97 offset:0
    ds_read_b128 a[100:103], v97 offset:2048
    s_add_u32 s76, s76, 1
    s_cmp_eq_u32 s76, 7
    s_cselect_b32 s76, 0, s76
    s_mul_i32 s6, s76, 172032
    s_add_u32 s6, s6, s78
    s_add_u32 m0, s11, 41472
    s_mul_i32 s8, s76, 229376
    buffer_load_dwordx4 v101, s[32:35], s6 offen lds
    s_mov_b32 s54, 268435456
    s_mov_b32 s55, 0x20000
    s_lshl_b32 s16, s23, 2
    s_add_u32 s16, s16, s72
    v_mfma_f32_16x16x32_bf16 v[32:35], a[60:63], a[80:83], 0
    v_mfma_f32_16x16x32_bf16 v[36:39], a[60:63], a[84:87], 0
    s_mul_i32 s16, s16, 512
    s_add_u32 s16, s16, 13631616
    s_mul_i32 s23, s23, 294912
    v_mov_b32_e64 v115, 1073741824
    v_mfma_f32_16x16x32_bf16 v[48:51], a[60:63], a[88:91], 0
    v_mfma_f32_16x16x32_bf16 v[52:55], a[60:63], a[92:95], 0
    s_add_u32 m0, s11, 45568
    s_add_u32 s7, s6, 896
    buffer_load_dwordx4 v101, s[32:35], s7 offen lds
    v_mov_b32_e64 v114, 1
    s_mov_b32 s46, 1605632
    s_mov_b32 s47, 0x20000
    v_mfma_f32_16x16x32_bf16 v[64:67], a[64:67], a[80:83], 0
    v_mfma_f32_16x16x32_bf16 v[68:71], a[64:67], a[84:87], 0
    s_mov_b32 s50, 401408
    s_mov_b32 s51, 0x20000
    s_mov_b32 s58, 1835008
    s_mov_b32 s59, 0x20000
    v_mfma_f32_16x16x32_bf16 v[80:83], a[64:67], a[88:91], 0
    v_mfma_f32_16x16x32_bf16 v[84:87], a[64:67], a[92:95], 0
    s_and_b32 s20, s2, 7
    s_lshl_b32 s20, s20, 2
    s_bfe_u32 s21, s2, 0x20003
    s_waitcnt lgkmcnt(0)
    s_nop 0
    v_mfma_f32_16x16x32_bf16 v[8:11], a[68:71], a[80:83], 0
    v_mfma_f32_16x16x32_bf16 v[12:15], a[68:71], a[84:87], 0
    ds_read_b64_tr_b16 a[56:57], v98 offset:3072
    ds_read_b64_tr_b16 a[58:59], v98 offset:3840
    ds_read_b64_tr_b16 a[60:61], v98 offset:3104
    ds_read_b64_tr_b16 a[62:63], v98 offset:3872
    v_mfma_f32_16x16x32_bf16 v[24:27], a[68:71], a[88:91], 0
    v_mfma_f32_16x16x32_bf16 v[28:31], a[68:71], a[92:95], 0
    ds_read_b64_tr_b16 a[64:65], v98 offset:3136
    ds_read_b64_tr_b16 a[66:67], v98 offset:3904
    ds_read_b128 a[104:107], v97 offset:4096
    ds_read_b128 a[108:111], v97 offset:6144
    s_add_u32 m0, s12, 41472
    s_add_u32 s8, s8, s79
    buffer_load_dwordx4 v102, s[68:71], s8 offen lds
    s_or_b32 s20, s20, s21
    s_lshr_b32 s21, s2, 5
    s_lshl_b32 s22, s21, 7
    s_mul_i32 s3, s26, 401408
    s_add_u32 s22, s22, s3
    v_mfma_f32_16x16x32_bf16 v[40:43], a[72:75], a[80:83], 0
    v_mfma_f32_16x16x32_bf16 v[44:47], a[72:75], a[84:87], 0
    v_lshrrev_b32 v124, 4, v112
    v_lshrrev_b32_e64 v125, 3, v124
    v_mul_u32_u24 v126, 896, v125
    v_mfma_f32_16x16x32_bf16 v[56:59], a[72:75], a[88:91], 0
    v_mfma_f32_16x16x32_bf16 v[60:63], a[72:75], a[92:95], 0
    v_and_b32 v125, 2, v125
    v_lshlrev_b32 v125, 1, v125
    v_and_b32_e64 v127, 7, v124
    v_mfma_f32_16x16x32_bf16 v[72:75], a[76:79], a[80:83], 0
    v_mfma_f32_16x16x32_bf16 v[76:79], a[76:79], a[84:87], 0
    v_xor_b32_e64 v125, v125, v127
    v_lshl_add_u32 v119, v125, 4, v126
    s_cmp_eq_u32 s21, 7
    s_cselect_b32 s3, 1073741824, 0
    v_add_u32 v119, s3, v119
    v_mfma_f32_16x16x32_bf16 v[88:91], a[76:79], a[88:91], 0
    v_mfma_f32_16x16x32_bf16 v[92:95], a[76:79], a[92:95], 0
    v_add_u32 v120, 6144, v119
    v_add_u32 v121, 12288, v119
    s_waitcnt lgkmcnt(0)
    v_mfma_f32_16x16x32_bf16 v[0:3], a[56:59], a[96:99], v[0:3]
    v_mfma_f32_16x16x32_bf16 v[4:7], a[56:59], a[100:103], v[4:7]
    ds_read_b64_tr_b16 a[68:69], v98 offset:9344
    ds_read_b64_tr_b16 a[70:71], v98 offset:10112
    ds_read_b64_tr_b16 a[72:73], v98 offset:9376
    ds_read_b64_tr_b16 a[74:75], v98 offset:10144
    v_mfma_f32_16x16x32_bf16 v[16:19], a[56:59], a[104:107], v[16:19]
    v_mfma_f32_16x16x32_bf16 v[20:23], a[56:59], a[108:111], v[20:23]
    ds_read_b64_tr_b16 a[76:77], v98 offset:9408
    ds_read_b64_tr_b16 a[78:79], v98 offset:10176
    buffer_load_dwordx4 v103, s[68:71], s8 offen offset:1024 lds
    v_add_u32 v122, 18432, v119
    v_bfe_u32 v125, v124, 2, 2
    v_lshrrev_b32_e64 v126, 5, v124
    v_mfma_f32_16x16x32_bf16 v[32:35], a[60:63], a[96:99], v[32:35]
    v_mfma_f32_16x16x32_bf16 v[36:39], a[60:63], a[100:103], v[36:39]
    v_lshl_add_u32 v126, v126, 3, v125
    v_bfe_u32 v127, v124, 4, 1
    v_and_b32_e64 v128, 3, v124
    v_mfma_f32_16x16x32_bf16 v[48:51], a[60:63], a[104:107], v[48:51]
    v_mfma_f32_16x16x32_bf16 v[52:55], a[60:63], a[108:111], v[52:55]
    v_lshl_add_u32 v127, v127, 2, v128
    v_lshlrev_b32_e64 v128, 7, v126
    v_lshl_add_u32 v128, v127, 3, v128
    v_mfma_f32_16x16x32_bf16 v[64:67], a[64:67], a[96:99], v[64:67]
    v_mfma_f32_16x16x32_bf16 v[68:71], a[64:67], a[100:103], v[68:71]
    v_add_u32 v128, s10, v128
    v_lshrrev_b32 v125, 1, v125
    v_lshl_add_u32 v117, v125, 6, v128
    v_mfma_f32_16x16x32_bf16 v[80:83], a[64:67], a[104:107], v[80:83]
    v_mfma_f32_16x16x32_bf16 v[84:87], a[64:67], a[108:111], v[84:87]
    v_xor_b32 v125, 1, v125
    v_lshl_add_u32 v118, v125, 6, v128
    s_waitcnt lgkmcnt(0)
    v_mfma_f32_16x16x32_bf16 v[8:11], a[68:71], a[96:99], v[8:11]
    v_mfma_f32_16x16x32_bf16 v[12:15], a[68:71], a[100:103], v[12:15]
    s_waitcnt vmcnt(4)
    s_barrier
    ds_read_b64_tr_b16 a[56:57], v98 offset:20736
    ds_read_b64_tr_b16 a[58:59], v98 offset:21504
    ds_read_b128 a[80:83], v96 offset:8192
    ds_read_b128 a[84:87], v96 offset:10240
    v_mfma_f32_16x16x32_bf16 v[24:27], a[68:71], a[104:107], v[24:27]
    v_mfma_f32_16x16x32_bf16 v[28:31], a[68:71], a[108:111], v[28:31]
    ds_read_b128 a[88:91], v96 offset:12288
    ds_read_b128 a[92:95], v96 offset:14336
    ds_read_b64_tr_b16 a[60:61], v98 offset:20768
    ds_read_b64_tr_b16 a[62:63], v98 offset:21536
    buffer_load_dwordx4 v104, s[68:71], s8 offen offset:2048 lds
    v_mfma_f32_16x16x32_bf16 v[40:43], a[72:75], a[96:99], v[40:43]
    v_mfma_f32_16x16x32_bf16 v[44:47], a[72:75], a[100:103], v[44:47]
    ds_read_b64_tr_b16 a[64:65], v98 offset:20800
    ds_read_b64_tr_b16 a[66:67], v98 offset:21568
    v_mfma_f32_16x16x32_bf16 v[56:59], a[72:75], a[104:107], v[56:59]
    v_mfma_f32_16x16x32_bf16 v[60:63], a[72:75], a[108:111], v[60:63]
    v_mfma_f32_16x16x32_bf16 v[72:75], a[76:79], a[96:99], v[72:75]
    v_mfma_f32_16x16x32_bf16 v[76:79], a[76:79], a[100:103], v[76:79]
    v_mfma_f32_16x16x32_bf16 v[88:91], a[76:79], a[104:107], v[88:91]
    v_mfma_f32_16x16x32_bf16 v[92:95], a[76:79], a[108:111], v[92:95]
    s_waitcnt lgkmcnt(0)
    s_nop 0
    v_mfma_f32_16x16x32_bf16 v[0:3], a[56:59], a[80:83], v[0:3]
    v_mfma_f32_16x16x32_bf16 v[4:7], a[56:59], a[84:87], v[4:7]
    ds_read_b64_tr_b16 a[68:69], v98 offset:27008
    ds_read_b64_tr_b16 a[70:71], v98 offset:27776
    ds_read_b64_tr_b16 a[72:73], v98 offset:27040
    ds_read_b64_tr_b16 a[74:75], v98 offset:27808
    v_mfma_f32_16x16x32_bf16 v[16:19], a[56:59], a[88:91], v[16:19]
    v_mfma_f32_16x16x32_bf16 v[20:23], a[56:59], a[92:95], v[20:23]
    ds_read_b64_tr_b16 a[76:77], v98 offset:27072
    ds_read_b64_tr_b16 a[78:79], v98 offset:27840
    ds_read_b128 a[96:99], v97 offset:8192
    ds_read_b128 a[100:103], v97 offset:10240
    s_add_u32 s76, s76, 1
    s_cmp_eq_u32 s76, 7
    s_cselect_b32 s76, 0, s76
    s_mul_i32 s6, s76, 172032
    s_add_u32 s6, s6, s78
    s_add_u32 m0, s11, 0
    s_mul_i32 s8, s76, 229376
    s_nop 0
    buffer_load_dwordx4 v101, s[32:35], s6 offen lds
    v_mfma_f32_16x16x32_bf16 v[32:35], a[60:63], a[80:83], v[32:35]
    v_mfma_f32_16x16x32_bf16 v[36:39], a[60:63], a[84:87], v[36:39]
    v_mfma_f32_16x16x32_bf16 v[48:51], a[60:63], a[88:91], v[48:51]
    v_mfma_f32_16x16x32_bf16 v[52:55], a[60:63], a[92:95], v[52:55]
    s_add_u32 m0, s11, 4096
    s_add_u32 s7, s6, 896
    buffer_load_dwordx4 v101, s[32:35], s7 offen lds
    v_mfma_f32_16x16x32_bf16 v[64:67], a[64:67], a[80:83], v[64:67]
    v_mfma_f32_16x16x32_bf16 v[68:71], a[64:67], a[84:87], v[68:71]
    v_mfma_f32_16x16x32_bf16 v[80:83], a[64:67], a[88:91], v[80:83]
    v_mfma_f32_16x16x32_bf16 v[84:87], a[64:67], a[92:95], v[84:87]
    s_waitcnt lgkmcnt(0)
    s_nop 0
    v_mfma_f32_16x16x32_bf16 v[8:11], a[68:71], a[80:83], v[8:11]
    v_mfma_f32_16x16x32_bf16 v[12:15], a[68:71], a[84:87], v[12:15]
    ds_read_b64_tr_b16 a[56:57], v98 offset:23808
    ds_read_b64_tr_b16 a[58:59], v98 offset:24576
    ds_read_b64_tr_b16 a[60:61], v98 offset:23840
    ds_read_b64_tr_b16 a[62:63], v98 offset:24608
    v_mfma_f32_16x16x32_bf16 v[24:27], a[68:71], a[88:91], v[24:27]
    v_mfma_f32_16x16x32_bf16 v[28:31], a[68:71], a[92:95], v[28:31]
    ds_read_b64_tr_b16 a[64:65], v98 offset:23872
    ds_read_b64_tr_b16 a[66:67], v98 offset:24640
    ds_read_b128 a[104:107], v97 offset:12288
    ds_read_b128 a[108:111], v97 offset:14336
    s_add_u32 m0, s12, 0
    s_add_u32 s8, s8, s79
    buffer_load_dwordx4 v102, s[68:71], s8 offen lds
    v_mfma_f32_16x16x32_bf16 v[40:43], a[72:75], a[80:83], v[40:43]
    v_mfma_f32_16x16x32_bf16 v[44:47], a[72:75], a[84:87], v[44:47]
    v_mfma_f32_16x16x32_bf16 v[56:59], a[72:75], a[88:91], v[56:59]
    v_mfma_f32_16x16x32_bf16 v[60:63], a[72:75], a[92:95], v[60:63]
    v_mfma_f32_16x16x32_bf16 v[72:75], a[76:79], a[80:83], v[72:75]
    v_mfma_f32_16x16x32_bf16 v[76:79], a[76:79], a[84:87], v[76:79]
    v_mfma_f32_16x16x32_bf16 v[88:91], a[76:79], a[88:91], v[88:91]
    v_mfma_f32_16x16x32_bf16 v[92:95], a[76:79], a[92:95], v[92:95]
    s_waitcnt lgkmcnt(0)
    s_nop 0
    v_mfma_f32_16x16x32_bf16 v[0:3], a[56:59], a[96:99], v[0:3]
    v_mfma_f32_16x16x32_bf16 v[4:7], a[56:59], a[100:103], v[4:7]
    ds_read_b64_tr_b16 a[68:69], v98 offset:30080
    ds_read_b64_tr_b16 a[70:71], v98 offset:30848
    ds_read_b64_tr_b16 a[72:73], v98 offset:30112
    ds_read_b64_tr_b16 a[74:75], v98 offset:30880
    v_mfma_f32_16x16x32_bf16 v[16:19], a[56:59], a[104:107], v[16:19]
    v_mfma_f32_16x16x32_bf16 v[20:23], a[56:59], a[108:111], v[20:23]
    ds_read_b64_tr_b16 a[76:77], v98 offset:30144
    ds_read_b64_tr_b16 a[78:79], v98 offset:30912
    buffer_load_dwordx4 v103, s[68:71], s8 offen offset:1024 lds
    v_mfma_f32_16x16x32_bf16 v[32:35], a[60:63], a[96:99], v[32:35]
    v_mfma_f32_16x16x32_bf16 v[36:39], a[60:63], a[100:103], v[36:39]
    v_mfma_f32_16x16x32_bf16 v[48:51], a[60:63], a[104:107], v[48:51]
    v_mfma_f32_16x16x32_bf16 v[52:55], a[60:63], a[108:111], v[52:55]
    v_mfma_f32_16x16x32_bf16 v[64:67], a[64:67], a[96:99], v[64:67]
    v_mfma_f32_16x16x32_bf16 v[68:71], a[64:67], a[100:103], v[68:71]
    v_mfma_f32_16x16x32_bf16 v[80:83], a[64:67], a[104:107], v[80:83]
    v_mfma_f32_16x16x32_bf16 v[84:87], a[64:67], a[108:111], v[84:87]
    s_waitcnt lgkmcnt(0)
    s_nop 0
    v_mfma_f32_16x16x32_bf16 v[8:11], a[68:71], a[96:99], v[8:11]
    v_mfma_f32_16x16x32_bf16 v[12:15], a[68:71], a[100:103], v[12:15]
    s_waitcnt vmcnt(4)
    s_barrier
    ds_read_b64_tr_b16 a[56:57], v98 offset:41472
    ds_read_b64_tr_b16 a[58:59], v98 offset:42240
    ds_read_b128 a[80:83], v96 offset:16384
    ds_read_b128 a[84:87], v96 offset:18432
    v_mfma_f32_16x16x32_bf16 v[24:27], a[68:71], a[104:107], v[24:27]
    v_mfma_f32_16x16x32_bf16 v[28:31], a[68:71], a[108:111], v[28:31]
    ds_read_b128 a[88:91], v96 offset:20480
    ds_read_b128 a[92:95], v96 offset:22528
    ds_read_b64_tr_b16 a[60:61], v98 offset:41504
    ds_read_b64_tr_b16 a[62:63], v98 offset:42272
    buffer_load_dwordx4 v104, s[68:71], s8 offen offset:2048 lds
    v_mfma_f32_16x16x32_bf16 v[40:43], a[72:75], a[96:99], v[40:43]
    v_mfma_f32_16x16x32_bf16 v[44:47], a[72:75], a[100:103], v[44:47]
    ds_read_b64_tr_b16 a[64:65], v98 offset:41536
    ds_read_b64_tr_b16 a[66:67], v98 offset:42304
    v_mfma_f32_16x16x32_bf16 v[56:59], a[72:75], a[104:107], v[56:59]
    v_mfma_f32_16x16x32_bf16 v[60:63], a[72:75], a[108:111], v[60:63]
    v_mfma_f32_16x16x32_bf16 v[72:75], a[76:79], a[96:99], v[72:75]
    v_mfma_f32_16x16x32_bf16 v[76:79], a[76:79], a[100:103], v[76:79]
    v_mfma_f32_16x16x32_bf16 v[88:91], a[76:79], a[104:107], v[88:91]
    v_mfma_f32_16x16x32_bf16 v[92:95], a[76:79], a[108:111], v[92:95]
    s_waitcnt lgkmcnt(0)
    s_nop 0
    v_mfma_f32_16x16x32_bf16 v[0:3], a[56:59], a[80:83], v[0:3]
    v_mfma_f32_16x16x32_bf16 v[4:7], a[56:59], a[84:87], v[4:7]
    ds_read_b64_tr_b16 a[68:69], v98 offset:47744
    ds_read_b64_tr_b16 a[70:71], v98 offset:48512
    ds_read_b64_tr_b16 a[72:73], v98 offset:47776
    ds_read_b64_tr_b16 a[74:75], v98 offset:48544
    v_mfma_f32_16x16x32_bf16 v[16:19], a[56:59], a[88:91], v[16:19]
    v_mfma_f32_16x16x32_bf16 v[20:23], a[56:59], a[92:95], v[20:23]
    ds_read_b64_tr_b16 a[76:77], v98 offset:47808
    ds_read_b64_tr_b16 a[78:79], v98 offset:48576
    ds_read_b128 a[96:99], v97 offset:16384
    ds_read_b128 a[100:103], v97 offset:18432
    s_add_u32 s76, s76, 1
    s_cmp_eq_u32 s76, 7
    s_cselect_b32 s76, 0, s76
    s_mul_i32 s6, s76, 172032
    s_add_u32 s6, s6, s78
    s_add_u32 m0, s11, 20736
    s_mul_i32 s8, s76, 229376
    buffer_load_dwordx4 v101, s[32:35], s6 offen lds
    v_mfma_f32_16x16x32_bf16 v[32:35], a[60:63], a[80:83], v[32:35]
    v_mfma_f32_16x16x32_bf16 v[36:39], a[60:63], a[84:87], v[36:39]
    v_mfma_f32_16x16x32_bf16 v[48:51], a[60:63], a[88:91], v[48:51]
    v_mfma_f32_16x16x32_bf16 v[52:55], a[60:63], a[92:95], v[52:55]
    s_add_u32 m0, s11, 24832
    s_add_u32 s7, s6, 896
    buffer_load_dwordx4 v101, s[32:35], s7 offen lds
    v_mfma_f32_16x16x32_bf16 v[64:67], a[64:67], a[80:83], v[64:67]
    v_mfma_f32_16x16x32_bf16 v[68:71], a[64:67], a[84:87], v[68:71]
    v_mfma_f32_16x16x32_bf16 v[80:83], a[64:67], a[88:91], v[80:83]
    v_mfma_f32_16x16x32_bf16 v[84:87], a[64:67], a[92:95], v[84:87]
    s_waitcnt lgkmcnt(0)
    s_nop 0
    v_mfma_f32_16x16x32_bf16 v[8:11], a[68:71], a[80:83], v[8:11]
    v_mfma_f32_16x16x32_bf16 v[12:15], a[68:71], a[84:87], v[12:15]
    ds_read_b64_tr_b16 a[56:57], v98 offset:44544
    ds_read_b64_tr_b16 a[58:59], v98 offset:45312
    ds_read_b64_tr_b16 a[60:61], v98 offset:44576
    ds_read_b64_tr_b16 a[62:63], v98 offset:45344
    v_mfma_f32_16x16x32_bf16 v[24:27], a[68:71], a[88:91], v[24:27]
    v_mfma_f32_16x16x32_bf16 v[28:31], a[68:71], a[92:95], v[28:31]
    ds_read_b64_tr_b16 a[64:65], v98 offset:44608
    ds_read_b64_tr_b16 a[66:67], v98 offset:45376
    ds_read_b128 a[104:107], v97 offset:20480
    ds_read_b128 a[108:111], v97 offset:22528
    s_add_u32 m0, s12, 20736
    s_add_u32 s8, s8, s79
    buffer_load_dwordx4 v102, s[68:71], s8 offen lds
    v_mfma_f32_16x16x32_bf16 v[40:43], a[72:75], a[80:83], v[40:43]
    v_mfma_f32_16x16x32_bf16 v[44:47], a[72:75], a[84:87], v[44:47]
    v_mfma_f32_16x16x32_bf16 v[56:59], a[72:75], a[88:91], v[56:59]
    v_mfma_f32_16x16x32_bf16 v[60:63], a[72:75], a[92:95], v[60:63]
    v_mfma_f32_16x16x32_bf16 v[72:75], a[76:79], a[80:83], v[72:75]
    v_mfma_f32_16x16x32_bf16 v[76:79], a[76:79], a[84:87], v[76:79]
    v_mfma_f32_16x16x32_bf16 v[88:91], a[76:79], a[88:91], v[88:91]
    v_mfma_f32_16x16x32_bf16 v[92:95], a[76:79], a[92:95], v[92:95]
    s_waitcnt lgkmcnt(0)
    v_mfma_f32_16x16x32_bf16 v[0:3], a[56:59], a[96:99], v[0:3]
    v_mfma_f32_16x16x32_bf16 v[4:7], a[56:59], a[100:103], v[4:7]
    ds_read_b64_tr_b16 a[68:69], v98 offset:50816
    ds_read_b64_tr_b16 a[70:71], v98 offset:51584
    ds_read_b64_tr_b16 a[72:73], v98 offset:50848
    ds_read_b64_tr_b16 a[74:75], v98 offset:51616
    v_mfma_f32_16x16x32_bf16 v[16:19], a[56:59], a[104:107], v[16:19]
    v_mfma_f32_16x16x32_bf16 v[20:23], a[56:59], a[108:111], v[20:23]
    ds_read_b64_tr_b16 a[76:77], v98 offset:50880
    ds_read_b64_tr_b16 a[78:79], v98 offset:51648
    buffer_load_dwordx4 v103, s[68:71], s8 offen offset:1024 lds
    v_mfma_f32_16x16x32_bf16 v[32:35], a[60:63], a[96:99], v[32:35]
    v_mfma_f32_16x16x32_bf16 v[36:39], a[60:63], a[100:103], v[36:39]
    v_mfma_f32_16x16x32_bf16 v[48:51], a[60:63], a[104:107], v[48:51]
    v_mfma_f32_16x16x32_bf16 v[52:55], a[60:63], a[108:111], v[52:55]
    v_mfma_f32_16x16x32_bf16 v[64:67], a[64:67], a[96:99], v[64:67]
    v_mfma_f32_16x16x32_bf16 v[68:71], a[64:67], a[100:103], v[68:71]
    v_mfma_f32_16x16x32_bf16 v[80:83], a[64:67], a[104:107], v[80:83]
    v_mfma_f32_16x16x32_bf16 v[84:87], a[64:67], a[108:111], v[84:87]
    s_waitcnt lgkmcnt(0)
    s_nop 0
    v_mfma_f32_16x16x32_bf16 v[8:11], a[68:71], a[96:99], v[8:11]
    v_mfma_f32_16x16x32_bf16 v[12:15], a[68:71], a[100:103], v[12:15]
    s_waitcnt vmcnt(4)
    s_barrier
    ds_read_b64_tr_b16 a[56:57], v98 offset:0
    ds_read_b64_tr_b16 a[58:59], v98 offset:768
    ds_read_b128 a[80:83], v96 offset:0
    ds_read_b128 a[84:87], v96 offset:2048
    v_mfma_f32_16x16x32_bf16 v[24:27], a[68:71], a[104:107], v[24:27]
    v_mfma_f32_16x16x32_bf16 v[28:31], a[68:71], a[108:111], v[28:31]
    ds_read_b128 a[88:91], v96 offset:4096
    ds_read_b128 a[92:95], v96 offset:6144
    ds_read_b64_tr_b16 a[60:61], v98 offset:32
    ds_read_b64_tr_b16 a[62:63], v98 offset:800
    buffer_load_dwordx4 v104, s[68:71], s8 offen offset:2048 lds
    v_mfma_f32_16x16x32_bf16 v[40:43], a[72:75], a[96:99], v[40:43]
    v_mfma_f32_16x16x32_bf16 v[44:47], a[72:75], a[100:103], v[44:47]
    ds_read_b64_tr_b16 a[64:65], v98 offset:64
    ds_read_b64_tr_b16 a[66:67], v98 offset:832
    v_mfma_f32_16x16x32_bf16 v[56:59], a[72:75], a[104:107], v[56:59]
    v_mfma_f32_16x16x32_bf16 v[60:63], a[72:75], a[108:111], v[60:63]
    v_mfma_f32_16x16x32_bf16 v[72:75], a[76:79], a[96:99], v[72:75]
    v_mfma_f32_16x16x32_bf16 v[76:79], a[76:79], a[100:103], v[76:79]
    v_mfma_f32_16x16x32_bf16 v[88:91], a[76:79], a[104:107], v[88:91]
    v_mfma_f32_16x16x32_bf16 v[92:95], a[76:79], a[108:111], v[92:95]
    s_waitcnt lgkmcnt(0)
    s_nop 0
    v_mfma_f32_16x16x32_bf16 v[0:3], a[56:59], a[80:83], v[0:3]
    v_mfma_f32_16x16x32_bf16 v[4:7], a[56:59], a[84:87], v[4:7]
    ds_read_b64_tr_b16 a[68:69], v98 offset:6272
    ds_read_b64_tr_b16 a[70:71], v98 offset:7040
    ds_read_b64_tr_b16 a[72:73], v98 offset:6304
    ds_read_b64_tr_b16 a[74:75], v98 offset:7072
    v_mfma_f32_16x16x32_bf16 v[16:19], a[56:59], a[88:91], v[16:19]
    v_mfma_f32_16x16x32_bf16 v[20:23], a[56:59], a[92:95], v[20:23]
    ds_read_b64_tr_b16 a[76:77], v98 offset:6336
    ds_read_b64_tr_b16 a[78:79], v98 offset:7104
    ds_read_b128 a[96:99], v97 offset:0
    ds_read_b128 a[100:103], v97 offset:2048
    s_add_u32 s76, s76, 1
    s_cmp_eq_u32 s76, 7
    s_cselect_b32 s76, 0, s76
    s_mul_i32 s6, s76, 172032
    s_add_u32 s6, s6, s78
    s_add_u32 m0, s11, 41472
    s_mul_i32 s8, s76, 229376
    buffer_load_dwordx4 v101, s[32:35], s6 offen lds
    v_mfma_f32_16x16x32_bf16 v[32:35], a[60:63], a[80:83], v[32:35]
    v_mfma_f32_16x16x32_bf16 v[36:39], a[60:63], a[84:87], v[36:39]
    v_mfma_f32_16x16x32_bf16 v[48:51], a[60:63], a[88:91], v[48:51]
    v_mfma_f32_16x16x32_bf16 v[52:55], a[60:63], a[92:95], v[52:55]
    s_add_u32 m0, s11, 45568
    s_add_u32 s7, s6, 896
    buffer_load_dwordx4 v101, s[32:35], s7 offen lds
    v_mfma_f32_16x16x32_bf16 v[64:67], a[64:67], a[80:83], v[64:67]
    v_mfma_f32_16x16x32_bf16 v[68:71], a[64:67], a[84:87], v[68:71]
    v_mfma_f32_16x16x32_bf16 v[80:83], a[64:67], a[88:91], v[80:83]
    v_mfma_f32_16x16x32_bf16 v[84:87], a[64:67], a[92:95], v[84:87]
    s_waitcnt lgkmcnt(0)
    s_nop 0
    v_mfma_f32_16x16x32_bf16 v[8:11], a[68:71], a[80:83], v[8:11]
    v_mfma_f32_16x16x32_bf16 v[12:15], a[68:71], a[84:87], v[12:15]
    ds_read_b64_tr_b16 a[56:57], v98 offset:3072
    ds_read_b64_tr_b16 a[58:59], v98 offset:3840
    ds_read_b64_tr_b16 a[60:61], v98 offset:3104
    ds_read_b64_tr_b16 a[62:63], v98 offset:3872
    v_mfma_f32_16x16x32_bf16 v[24:27], a[68:71], a[88:91], v[24:27]
    v_mfma_f32_16x16x32_bf16 v[28:31], a[68:71], a[92:95], v[28:31]
    ds_read_b64_tr_b16 a[64:65], v98 offset:3136
    ds_read_b64_tr_b16 a[66:67], v98 offset:3904
    ds_read_b128 a[104:107], v97 offset:4096
    ds_read_b128 a[108:111], v97 offset:6144
    s_add_u32 m0, s12, 41472
    s_add_u32 s8, s8, s79
    buffer_load_dwordx4 v102, s[68:71], s8 offen lds
    v_mfma_f32_16x16x32_bf16 v[40:43], a[72:75], a[80:83], v[40:43]
    v_mfma_f32_16x16x32_bf16 v[44:47], a[72:75], a[84:87], v[44:47]
    v_mfma_f32_16x16x32_bf16 v[56:59], a[72:75], a[88:91], v[56:59]
    v_mfma_f32_16x16x32_bf16 v[60:63], a[72:75], a[92:95], v[60:63]
    v_mfma_f32_16x16x32_bf16 v[72:75], a[76:79], a[80:83], v[72:75]
    v_mfma_f32_16x16x32_bf16 v[76:79], a[76:79], a[84:87], v[76:79]
    v_mfma_f32_16x16x32_bf16 v[88:91], a[76:79], a[88:91], v[88:91]
    v_mfma_f32_16x16x32_bf16 v[92:95], a[76:79], a[92:95], v[92:95]
    s_waitcnt lgkmcnt(0)
    v_mfma_f32_16x16x32_bf16 v[0:3], a[56:59], a[96:99], v[0:3]
    v_mfma_f32_16x16x32_bf16 v[4:7], a[56:59], a[100:103], v[4:7]
    ds_read_b64_tr_b16 a[68:69], v98 offset:9344
    ds_read_b64_tr_b16 a[70:71], v98 offset:10112
    ds_read_b64_tr_b16 a[72:73], v98 offset:9376
    ds_read_b64_tr_b16 a[74:75], v98 offset:10144
    v_mfma_f32_16x16x32_bf16 v[16:19], a[56:59], a[104:107], v[16:19]
    v_mfma_f32_16x16x32_bf16 v[20:23], a[56:59], a[108:111], v[20:23]
    ds_read_b64_tr_b16 a[76:77], v98 offset:9408
    ds_read_b64_tr_b16 a[78:79], v98 offset:10176
    buffer_load_dwordx4 v103, s[68:71], s8 offen offset:1024 lds
    v_lshl_add_u32 v105, v112, 4, s2
    v_min_u32 v105, 1567, v105
    v_lshlrev_b32_e64 v105, 7, v105
    v_mfma_f32_16x16x32_bf16 v[32:35], a[60:63], a[96:99], v[32:35]
    v_mfma_f32_16x16x32_bf16 v[36:39], a[60:63], a[100:103], v[36:39]
    s_mul_i32 s3, s26, 401408
    s_add_u32 s3, s3, 200704
    v_add_u32 v105, s3, v105
    v_mfma_f32_16x16x32_bf16 v[48:51], a[60:63], a[104:107], v[48:51]
    v_mfma_f32_16x16x32_bf16 v[52:55], a[60:63], a[108:111], v[52:55]
    buffer_load_dwordx4 v104, s[68:71], s8 offen offset:2048 lds
    s_mov_b64 exec, 127
    buffer_load_dword v106, v105, s[44:47], 0 offen
    s_mov_b64 exec, -1
    s_lshl_b32 s3, s26, 8
    s_add_u32 s3, s3, s2
    v_lshl_add_u32 v105, v112, 6, s3
    v_mfma_f32_16x16x32_bf16 v[64:67], a[64:67], a[96:99], v[64:67]
    v_mfma_f32_16x16x32_bf16 v[68:71], a[64:67], a[100:103], v[68:71]
    v_mfma_f32_16x16x32_bf16 v[80:83], a[64:67], a[104:107], v[80:83]
    v_mfma_f32_16x16x32_bf16 v[84:87], a[64:67], a[108:111], v[84:87]
    v_lshlrev_b32 v105, 7, v105
    s_mov_b64 exec, 15
    buffer_load_dword v106, v105, s[48:51], 0 offen
    s_mov_b64 exec, -1
    s_waitcnt lgkmcnt(0)
    v_mfma_f32_16x16x32_bf16 v[8:11], a[68:71], a[96:99], v[8:11]
    v_mfma_f32_16x16x32_bf16 v[12:15], a[68:71], a[100:103], v[12:15]
    s_waitcnt vmcnt(7)
    s_barrier
    ds_read_b64_tr_b16 a[56:57], v98 offset:20736
    ds_read_b64_tr_b16 a[58:59], v98 offset:21504
    ds_read_b128 a[80:83], v96 offset:8192
    ds_read_b128 a[84:87], v96 offset:10240
    v_mfma_f32_16x16x32_bf16 v[24:27], a[68:71], a[104:107], v[24:27]
    v_mfma_f32_16x16x32_bf16 v[28:31], a[68:71], a[108:111], v[28:31]
    ds_read_b128 a[88:91], v96 offset:12288
    ds_read_b128 a[92:95], v96 offset:14336
    ds_read_b64_tr_b16 a[60:61], v98 offset:20768
    ds_read_b64_tr_b16 a[62:63], v98 offset:21536
    s_mov_b32 s66, 25088
    s_mov_b32 s67, 0x20000
    s_and_b32 s9, s26, 1
    s_lshl_b32 s9, s9, 10
    s_add_u32 m0, s9, 161792
    s_mul_i32 s6, s74, 1568
    s_add_u32 s6, s6, s9
    s_nop 0
    buffer_load_dwordx4 v112, s[64:67], s6 offen lds
    v_mfma_f32_16x16x32_bf16 v[40:43], a[72:75], a[96:99], v[40:43]
    v_mfma_f32_16x16x32_bf16 v[44:47], a[72:75], a[100:103], v[44:47]
    ds_read_b64_tr_b16 a[64:65], v98 offset:20800
    ds_read_b64_tr_b16 a[66:67], v98 offset:21568
    v_mfma_f32_16x16x32_bf16 v[56:59], a[72:75], a[104:107], v[56:59]
    v_mfma_f32_16x16x32_bf16 v[60:63], a[72:75], a[108:111], v[60:63]
    v_mfma_f32_16x16x32_bf16 v[72:75], a[76:79], a[96:99], v[72:75]
    v_mfma_f32_16x16x32_bf16 v[76:79], a[76:79], a[100:103], v[76:79]
    v_mfma_f32_16x16x32_bf16 v[88:91], a[76:79], a[104:107], v[88:91]
    v_mfma_f32_16x16x32_bf16 v[92:95], a[76:79], a[108:111], v[92:95]
    s_waitcnt lgkmcnt(0)
    s_nop 0
    v_mfma_f32_16x16x32_bf16 v[0:3], a[56:59], a[80:83], v[0:3]
    v_mfma_f32_16x16x32_bf16 v[4:7], a[56:59], a[84:87], v[4:7]
    ds_read_b64_tr_b16 a[68:69], v98 offset:27008
    ds_read_b64_tr_b16 a[70:71], v98 offset:27776
    ds_read_b64_tr_b16 a[72:73], v98 offset:27040
    ds_read_b64_tr_b16 a[74:75], v98 offset:27808
    v_mfma_f32_16x16x32_bf16 v[16:19], a[56:59], a[88:91], v[16:19]
    v_mfma_f32_16x16x32_bf16 v[20:23], a[56:59], a[92:95], v[20:23]
    ds_read_b64_tr_b16 a[76:77], v98 offset:27072
    ds_read_b64_tr_b16 a[78:79], v98 offset:27840
    ds_read_b128 a[96:99], v97 offset:8192
    ds_read_b128 a[100:103], v97 offset:10240
    s_add_u32 s76, s76, 1
    s_cmp_eq_u32 s76, 7
    s_cselect_b32 s76, 0, s76
    s_mul_i32 s6, s76, 172032
    s_add_u32 s6, s6, s78
    s_add_u32 m0, s11, 0
    s_mul_i32 s8, s76, 229376
    s_nop 0
    buffer_load_dwordx4 v101, s[32:35], s6 offen lds
    v_mfma_f32_16x16x32_bf16 v[32:35], a[60:63], a[80:83], v[32:35]
    v_mfma_f32_16x16x32_bf16 v[36:39], a[60:63], a[84:87], v[36:39]
    v_mfma_f32_16x16x32_bf16 v[48:51], a[60:63], a[88:91], v[48:51]
    v_mfma_f32_16x16x32_bf16 v[52:55], a[60:63], a[92:95], v[52:55]
    s_add_u32 m0, s11, 4096
    s_add_u32 s7, s6, 896
    buffer_load_dwordx4 v101, s[32:35], s7 offen lds
    v_mfma_f32_16x16x32_bf16 v[64:67], a[64:67], a[80:83], v[64:67]
    v_mfma_f32_16x16x32_bf16 v[68:71], a[64:67], a[84:87], v[68:71]
    v_mfma_f32_16x16x32_bf16 v[80:83], a[64:67], a[88:91], v[80:83]
    v_mfma_f32_16x16x32_bf16 v[84:87], a[64:67], a[92:95], v[84:87]
    s_waitcnt lgkmcnt(0)
    s_nop 0
    v_mfma_f32_16x16x32_bf16 v[8:11], a[68:71], a[80:83], v[8:11]
    v_mfma_f32_16x16x32_bf16 v[12:15], a[68:71], a[84:87], v[12:15]
    ds_read_b64_tr_b16 a[56:57], v98 offset:23808
    ds_read_b64_tr_b16 a[58:59], v98 offset:24576
    ds_read_b64_tr_b16 a[60:61], v98 offset:23840
    ds_read_b64_tr_b16 a[62:63], v98 offset:24608
    v_mfma_f32_16x16x32_bf16 v[24:27], a[68:71], a[88:91], v[24:27]
    v_mfma_f32_16x16x32_bf16 v[28:31], a[68:71], a[92:95], v[28:31]
    ds_read_b64_tr_b16 a[64:65], v98 offset:23872
    ds_read_b64_tr_b16 a[66:67], v98 offset:24640
    ds_read_b128 a[104:107], v97 offset:12288
    ds_read_b128 a[108:111], v97 offset:14336
    s_add_u32 m0, s12, 0
    s_add_u32 s8, s8, s79
    buffer_load_dwordx4 v102, s[68:71], s8 offen lds
    v_mfma_f32_16x16x32_bf16 v[40:43], a[72:75], a[80:83], v[40:43]
    v_mfma_f32_16x16x32_bf16 v[44:47], a[72:75], a[84:87], v[44:47]
    v_mfma_f32_16x16x32_bf16 v[56:59], a[72:75], a[88:91], v[56:59]
    v_mfma_f32_16x16x32_bf16 v[60:63], a[72:75], a[92:95], v[60:63]
    v_mfma_f32_16x16x32_bf16 v[72:75], a[76:79], a[80:83], v[72:75]
    v_mfma_f32_16x16x32_bf16 v[76:79], a[76:79], a[84:87], v[76:79]
    v_mfma_f32_16x16x32_bf16 v[88:91], a[76:79], a[88:91], v[88:91]
    v_mfma_f32_16x16x32_bf16 v[92:95], a[76:79], a[92:95], v[92:95]
    s_waitcnt lgkmcnt(0)
    s_nop 0
    v_mfma_f32_16x16x32_bf16 v[0:3], a[56:59], a[96:99], v[0:3]
    v_mfma_f32_16x16x32_bf16 v[4:7], a[56:59], a[100:103], v[4:7]
    ds_read_b64_tr_b16 a[68:69], v98 offset:30080
    ds_read_b64_tr_b16 a[70:71], v98 offset:30848
    ds_read_b64_tr_b16 a[72:73], v98 offset:30112
    ds_read_b64_tr_b16 a[74:75], v98 offset:30880
    v_mfma_f32_16x16x32_bf16 v[16:19], a[56:59], a[104:107], v[16:19]
    v_mfma_f32_16x16x32_bf16 v[20:23], a[56:59], a[108:111], v[20:23]
    ds_read_b64_tr_b16 a[76:77], v98 offset:30144
    ds_read_b64_tr_b16 a[78:79], v98 offset:30912
    buffer_load_dwordx4 v103, s[68:71], s8 offen offset:1024 lds
    v_mfma_f32_16x16x32_bf16 v[32:35], a[60:63], a[96:99], v[32:35]
    v_mfma_f32_16x16x32_bf16 v[36:39], a[60:63], a[100:103], v[36:39]
    v_mfma_f32_16x16x32_bf16 v[48:51], a[60:63], a[104:107], v[48:51]
    v_mfma_f32_16x16x32_bf16 v[52:55], a[60:63], a[108:111], v[52:55]
    v_mfma_f32_16x16x32_bf16 v[64:67], a[64:67], a[96:99], v[64:67]
    v_mfma_f32_16x16x32_bf16 v[68:71], a[64:67], a[100:103], v[68:71]
    v_mfma_f32_16x16x32_bf16 v[80:83], a[64:67], a[104:107], v[80:83]
    v_mfma_f32_16x16x32_bf16 v[84:87], a[64:67], a[108:111], v[84:87]
    s_waitcnt lgkmcnt(0)
    s_nop 0
    v_mfma_f32_16x16x32_bf16 v[8:11], a[68:71], a[96:99], v[8:11]
    v_mfma_f32_16x16x32_bf16 v[12:15], a[68:71], a[100:103], v[12:15]
    s_waitcnt vmcnt(4)
    s_barrier
    ds_read_b64_tr_b16 a[56:57], v98 offset:41472
    ds_read_b64_tr_b16 a[58:59], v98 offset:42240
    ds_read_b128 a[80:83], v96 offset:16384
    ds_read_b128 a[84:87], v96 offset:18432
    v_mfma_f32_16x16x32_bf16 v[24:27], a[68:71], a[104:107], v[24:27]
    v_mfma_f32_16x16x32_bf16 v[28:31], a[68:71], a[108:111], v[28:31]
    ds_read_b128 a[88:91], v96 offset:20480
    ds_read_b128 a[92:95], v96 offset:22528
    ds_read_b64_tr_b16 a[60:61], v98 offset:41504
    ds_read_b64_tr_b16 a[62:63], v98 offset:42272
    buffer_load_dwordx4 v104, s[68:71], s8 offen offset:2048 lds
    v_mfma_f32_16x16x32_bf16 v[40:43], a[72:75], a[96:99], v[40:43]
    v_mfma_f32_16x16x32_bf16 v[44:47], a[72:75], a[100:103], v[44:47]
    ds_read_b64_tr_b16 a[64:65], v98 offset:41536
    ds_read_b64_tr_b16 a[66:67], v98 offset:42304
    v_mfma_f32_16x16x32_bf16 v[56:59], a[72:75], a[104:107], v[56:59]
    v_mfma_f32_16x16x32_bf16 v[60:63], a[72:75], a[108:111], v[60:63]
    v_mfma_f32_16x16x32_bf16 v[72:75], a[76:79], a[96:99], v[72:75]
    v_mfma_f32_16x16x32_bf16 v[76:79], a[76:79], a[100:103], v[76:79]
    v_mfma_f32_16x16x32_bf16 v[88:91], a[76:79], a[104:107], v[88:91]
    v_mfma_f32_16x16x32_bf16 v[92:95], a[76:79], a[108:111], v[92:95]
    s_waitcnt lgkmcnt(0)
    v_mfma_f32_16x16x32_bf16 v[0:3], a[56:59], a[80:83], v[0:3]
    v_mfma_f32_16x16x32_bf16 v[4:7], a[56:59], a[84:87], v[4:7]
    s_and_b32 s3, s2, 7
    s_lshl_b32 s3, s3, 2
    s_lshr_b32 s43, 0x6543210, s3
    s_sub_u32 s3, 28, s3
    s_lshl_b32 s3, 0x6543210, s3
    s_or_b32 s43, s43, s3
    s_lshl_b32 s35, s20, 2
    s_add_u32 s34, s35, s26
    s_mul_i32 s34, s34, 512
    s_add_u32 s34, s34, 13631488
    s_lshl_b32 s35, s35, 1
    s_add_u32 s35, s35, s26
    s_mul_i32 s35, s35, 7168
    s_lshl_b32 s36, s21, 7
    s_add_u32 s35, s35, s36
    s_mul_i32 s37, s20, 294912
    s_mul_i32 s33, s26, 57344
    s_add_u32 s33, s33, s37
    s_mul_i32 s40, s26, 14336
    s_add_u32 s40, s40, 98304
    s_mul_i32 s41, s26, -301056
    s_add_u32 s41, s41, s22
    s_add_u32 s22, s22, 200704
    s_add_u32 s33, s33, 28672
    s_lshl_b32 s36, s26, 14
    s_add_u32 s37, s37, s36
    s_add_u32 s37, s37, 229376
    s_lshl_b32 s39, s74, 2
    s_add_u32 s39, s39, s26
    s_andn2_b32 s3, s39, 1
    s_add_u32 s39, s39, s3
    s_mul_i32 s39, s39, 512
    s_add_u32 s39, s39, 13632896
    s_lshl_b32 s38, s74, 2
    s_add_u32 s38, s38, s26
    s_lshl_b32 s38, s38, 13
    s_add_u32 s38, s38, 10485760
    ds_read_b64_tr_b16 a[68:69], v98 offset:47744
    ds_read_b64_tr_b16 a[70:71], v98 offset:48512
    ds_read_b64_tr_b16 a[72:73], v98 offset:47776
    ds_read_b64_tr_b16 a[74:75], v98 offset:48544
    v_mfma_f32_16x16x32_bf16 v[16:19], a[56:59], a[88:91], v[16:19]
    v_mfma_f32_16x16x32_bf16 v[20:23], a[56:59], a[92:95], v[20:23]
    ds_read_b64_tr_b16 a[76:77], v98 offset:47808
    ds_read_b64_tr_b16 a[78:79], v98 offset:48576
    ds_read_b128 a[96:99], v97 offset:16384
    ds_read_b128 a[100:103], v97 offset:18432
    v_mfma_f32_16x16x32_bf16 v[32:35], a[60:63], a[80:83], v[32:35]
    v_mfma_f32_16x16x32_bf16 v[36:39], a[60:63], a[84:87], v[36:39]
    v_mfma_f32_16x16x32_bf16 v[48:51], a[60:63], a[88:91], v[48:51]
    v_mfma_f32_16x16x32_bf16 v[52:55], a[60:63], a[92:95], v[52:55]
    v_mfma_f32_16x16x32_bf16 v[64:67], a[64:67], a[80:83], v[64:67]
    v_mfma_f32_16x16x32_bf16 v[68:71], a[64:67], a[84:87], v[68:71]
    v_mfma_f32_16x16x32_bf16 v[80:83], a[64:67], a[88:91], v[80:83]
    v_mfma_f32_16x16x32_bf16 v[84:87], a[64:67], a[92:95], v[84:87]
    s_waitcnt lgkmcnt(0)
    s_nop 0
    v_mfma_f32_16x16x32_bf16 v[8:11], a[68:71], a[80:83], v[8:11]
    v_mfma_f32_16x16x32_bf16 v[12:15], a[68:71], a[84:87], v[12:15]
    ds_read_b64_tr_b16 a[56:57], v98 offset:44544
    ds_read_b64_tr_b16 a[58:59], v98 offset:45312
    ds_read_b64_tr_b16 a[60:61], v98 offset:44576
    ds_read_b64_tr_b16 a[62:63], v98 offset:45344
    v_mfma_f32_16x16x32_bf16 v[24:27], a[68:71], a[88:91], v[24:27]
    v_mfma_f32_16x16x32_bf16 v[28:31], a[68:71], a[92:95], v[28:31]
    ds_read_b64_tr_b16 a[64:65], v98 offset:44608
    ds_read_b64_tr_b16 a[66:67], v98 offset:45376
    ds_read_b128 a[104:107], v97 offset:20480
    ds_read_b128 a[108:111], v97 offset:22528
    v_mfma_f32_16x16x32_bf16 v[40:43], a[72:75], a[80:83], v[40:43]
    v_mfma_f32_16x16x32_bf16 v[44:47], a[72:75], a[84:87], v[44:47]
    v_mfma_f32_16x16x32_bf16 v[56:59], a[72:75], a[88:91], v[56:59]
    v_mfma_f32_16x16x32_bf16 v[60:63], a[72:75], a[92:95], v[60:63]
    v_mfma_f32_16x16x32_bf16 v[72:75], a[76:79], a[80:83], v[72:75]
    v_mfma_f32_16x16x32_bf16 v[76:79], a[76:79], a[84:87], v[76:79]
    v_mfma_f32_16x16x32_bf16 v[88:91], a[76:79], a[88:91], v[88:91]
    v_mfma_f32_16x16x32_bf16 v[92:95], a[76:79], a[92:95], v[92:95]
    s_waitcnt lgkmcnt(0)
    s_nop 0
    v_mfma_f32_16x16x32_bf16 v[0:3], a[56:59], a[96:99], v[0:3]
    v_mfma_f32_16x16x32_bf16 v[4:7], a[56:59], a[100:103], v[4:7]
    ds_read_b64_tr_b16 a[68:69], v98 offset:50816
    ds_read_b64_tr_b16 a[70:71], v98 offset:51584
    ds_read_b64_tr_b16 a[72:73], v98 offset:50848
    ds_read_b64_tr_b16 a[74:75], v98 offset:51616
    v_mfma_f32_16x16x32_bf16 v[16:19], a[56:59], a[104:107], v[16:19]
    v_mfma_f32_16x16x32_bf16 v[20:23], a[56:59], a[108:111], v[20:23]
    ds_read_b64_tr_b16 a[76:77], v98 offset:50880
    ds_read_b64_tr_b16 a[78:79], v98 offset:51648
    v_mfma_f32_16x16x32_bf16 v[32:35], a[60:63], a[96:99], v[32:35]
    v_mfma_f32_16x16x32_bf16 v[36:39], a[60:63], a[100:103], v[36:39]
    v_mfma_f32_16x16x32_bf16 v[48:51], a[60:63], a[104:107], v[48:51]
    v_mfma_f32_16x16x32_bf16 v[52:55], a[60:63], a[108:111], v[52:55]
    v_mfma_f32_16x16x32_bf16 v[64:67], a[64:67], a[96:99], v[64:67]
    v_mfma_f32_16x16x32_bf16 v[68:71], a[64:67], a[100:103], v[68:71]
    v_mfma_f32_16x16x32_bf16 v[80:83], a[64:67], a[104:107], v[80:83]
    v_mfma_f32_16x16x32_bf16 v[84:87], a[64:67], a[108:111], v[84:87]
    s_waitcnt lgkmcnt(0)
    s_nop 0
    v_mfma_f32_16x16x32_bf16 v[8:11], a[68:71], a[96:99], v[8:11]
    v_mfma_f32_16x16x32_bf16 v[12:15], a[68:71], a[100:103], v[12:15]
    s_waitcnt vmcnt(0)
    s_barrier
    ds_read_b64_tr_b16 a[56:57], v98 offset:0
    ds_read_b64_tr_b16 a[58:59], v98 offset:768
    ds_read_b128 a[80:83], v96 offset:0
    ds_read_b128 a[84:87], v96 offset:2048
    v_mfma_f32_16x16x32_bf16 v[24:27], a[68:71], a[104:107], v[24:27]
    v_mfma_f32_16x16x32_bf16 v[28:31], a[68:71], a[108:111], v[28:31]
    ds_read_b128 a[88:91], v96 offset:4096
    ds_read_b128 a[92:95], v96 offset:6144
    ds_read_b64_tr_b16 a[60:61], v98 offset:32
    ds_read_b64_tr_b16 a[62:63], v98 offset:800
    v_and_b32 v116, 0xf0, v112
    v_lshlrev_b32 v116, 1, v116
    s_lshl_b32 s15, s27, 2
    v_mfma_f32_16x16x32_bf16 v[40:43], a[72:75], a[96:99], v[40:43]
    v_mfma_f32_16x16x32_bf16 v[44:47], a[72:75], a[100:103], v[44:47]
    ds_read_b64_tr_b16 a[64:65], v98 offset:64
    ds_read_b64_tr_b16 a[66:67], v98 offset:832
    s_add_u32 s15, s15, s26
    s_lshl_b32 s15, s15, 9
    v_mfma_f32_16x16x32_bf16 v[56:59], a[72:75], a[104:107], v[56:59]
    v_mfma_f32_16x16x32_bf16 v[60:63], a[72:75], a[108:111], v[60:63]
    s_add_u32 s15, s15, 12582912
    buffer_load_dwordx4 v[124:127], v116, s[52:55], s15 offen offset:0 sc1
    v_mfma_f32_16x16x32_bf16 v[72:75], a[76:79], a[96:99], v[72:75]
    v_mfma_f32_16x16x32_bf16 v[76:79], a[76:79], a[100:103], v[76:79]
    buffer_load_dwordx4 v[108:111], v116, s[52:55], s15 offen offset:16 sc1
    v_mfma_f32_16x16x32_bf16 v[88:91], a[76:79], a[104:107], v[88:91]
    v_mfma_f32_16x16x32_bf16 v[92:95], a[76:79], a[108:111], v[92:95]
    s_waitcnt lgkmcnt(0)
    s_nop 0
    v_mfma_f32_16x16x32_bf16 v[0:3], a[56:59], a[80:83], v[0:3]
    v_mfma_f32_16x16x32_bf16 v[4:7], a[56:59], a[84:87], v[4:7]
    ds_read_b64_tr_b16 a[68:69], v98 offset:6272
    ds_read_b64_tr_b16 a[70:71], v98 offset:7040
    ds_read_b64_tr_b16 a[72:73], v98 offset:6304
    ds_read_b64_tr_b16 a[74:75], v98 offset:7072
    v_mfma_f32_16x16x32_bf16 v[16:19], a[56:59], a[88:91], v[16:19]
    v_mfma_f32_16x16x32_bf16 v[20:23], a[56:59], a[92:95], v[20:23]
    ds_read_b64_tr_b16 a[76:77], v98 offset:6336
    ds_read_b64_tr_b16 a[78:79], v98 offset:7104
    ds_read_b128 a[96:99], v97 offset:0
    ds_read_b128 a[100:103], v97 offset:2048
    v_mfma_f32_16x16x32_bf16 v[32:35], a[60:63], a[80:83], v[32:35]
    v_mfma_f32_16x16x32_bf16 v[36:39], a[60:63], a[84:87], v[36:39]
    v_mfma_f32_16x16x32_bf16 v[48:51], a[60:63], a[88:91], v[48:51]
    v_mfma_f32_16x16x32_bf16 v[52:55], a[60:63], a[92:95], v[52:55]
    v_mfma_f32_16x16x32_bf16 v[64:67], a[64:67], a[80:83], v[64:67]
    v_mfma_f32_16x16x32_bf16 v[68:71], a[64:67], a[84:87], v[68:71]
    v_mfma_f32_16x16x32_bf16 v[80:83], a[64:67], a[88:91], v[80:83]
    v_mfma_f32_16x16x32_bf16 v[84:87], a[64:67], a[92:95], v[84:87]
    s_waitcnt lgkmcnt(0)
    s_nop 0
    v_mfma_f32_16x16x32_bf16 v[8:11], a[68:71], a[80:83], v[8:11]
    v_mfma_f32_16x16x32_bf16 v[12:15], a[68:71], a[84:87], v[12:15]
    ds_read_b64_tr_b16 a[56:57], v98 offset:3072
    ds_read_b64_tr_b16 a[58:59], v98 offset:3840
    ds_read_b64_tr_b16 a[60:61], v98 offset:3104
    ds_read_b64_tr_b16 a[62:63], v98 offset:3872
    v_mfma_f32_16x16x32_bf16 v[24:27], a[68:71], a[88:91], v[24:27]
    v_mfma_f32_16x16x32_bf16 v[28:31], a[68:71], a[92:95], v[28:31]
    ds_read_b64_tr_b16 a[64:65], v98 offset:3136
    ds_read_b64_tr_b16 a[66:67], v98 offset:3904
    ds_read_b128 a[104:107], v97 offset:4096
    ds_read_b128 a[108:111], v97 offset:6144
    s_waitcnt vmcnt(0)
    v_and_b32 v123, 0x130, v112
    v_lshrrev_b32 v123, 1, v123
    v_and_b32_e64 v116, 0x40, v112
    v_add_u32 v123, v123, v116
    s_mov_b32 vcc_lo, 0xff00ff00
    s_mov_b32 vcc_hi, 0x00ff00ff
    v_mov_b32 v116, 1280
    v_cndmask_b32 v123, v123, v116, vcc
    v_mfma_f32_16x16x32_bf16 v[40:43], a[72:75], a[80:83], v[40:43]
    v_mfma_f32_16x16x32_bf16 v[44:47], a[72:75], a[84:87], v[44:47]
    v_add_u32 v123, 155648, v123
    s_mov_b32 vcc_lo, 0
    s_mov_b32 vcc_hi, -1
    v_cndmask_b32 v136, v125, v127, vcc
    v_cndmask_b32 v140, v109, v111, vcc
    v_cvt_pk_bf16_f32 v136, v136, v136
    v_cvt_pk_bf16_f32 v140, v140, v140
    v_mfma_f32_16x16x32_bf16 v[56:59], a[72:75], a[88:91], v[56:59]
    v_mfma_f32_16x16x32_bf16 v[60:63], a[72:75], a[92:95], v[60:63]
    s_mov_b32 vcc_lo, 0xffff0000
    s_mov_b32 vcc_hi, 0xffff0000
    v_cndmask_b32 v138, 0, v136, vcc
    v_cndmask_b32 v139, 0, v136, vcc
    v_cndmask_b32 v137, v136, 0, vcc
    v_cndmask_b32 v136, v136, 0, vcc
    v_cndmask_b32 v142, 0, v140, vcc
    v_cndmask_b32 v143, 0, v140, vcc
    v_cndmask_b32 v141, v140, 0, vcc
    v_cndmask_b32 v140, v140, 0, vcc
    v_mfma_f32_16x16x32_bf16 v[72:75], a[76:79], a[80:83], v[72:75]
    v_mfma_f32_16x16x32_bf16 v[76:79], a[76:79], a[84:87], v[76:79]
    v_rsq_f32 v129, v124
    v_rsq_f32 v131, v126
    v_rsq_f32 v133, v108
    v_rsq_f32 v135, v110
    v_mul_f32_e64 v132, v129, v129
    v_mfma_f32_16x16x32_bf16 v[88:91], a[76:79], a[88:91], v[88:91]
    v_mfma_f32_16x16x32_bf16 v[92:95], a[76:79], a[92:95], v[92:95]
    v_mul_f32 v128, 0xc0135761, v129
    v_mul_f32_e64 v134, v131, v131
    v_mul_f32 v130, 0xc0135761, v131
    v_mul_f32 v132, 0x3d372713, v132
    v_mul_f32 v134, 0x3d372713, v134
    v_mul_f32_e64 v132, v128, v132
    v_mul_f32 v134, v130, v134
    s_waitcnt lgkmcnt(0)
    v_mfma_f32_16x16x32_bf16 v[0:3], a[56:59], a[96:99], v[0:3]
    v_mfma_f32_16x16x32_bf16 v[4:7], a[56:59], a[100:103], v[4:7]
    ds_read_b64_tr_b16 a[68:69], v98 offset:9344
    ds_read_b64_tr_b16 a[70:71], v98 offset:10112
    ds_read_b64_tr_b16 a[72:73], v98 offset:9376
    ds_read_b64_tr_b16 a[74:75], v98 offset:10144
    v_mfma_f32_16x16x32_bf16 v[16:19], a[56:59], a[104:107], v[16:19]
    v_mfma_f32_16x16x32_bf16 v[20:23], a[56:59], a[108:111], v[20:23]
    ds_read_b64_tr_b16 a[76:77], v98 offset:9408
    ds_read_b64_tr_b16 a[78:79], v98 offset:10176
    v_mfma_f32_16x16x32_bf16 v[32:35], a[60:63], a[96:99], v[32:35]
    v_mfma_f32_16x16x32_bf16 v[36:39], a[60:63], a[100:103], v[36:39]
    v_mfma_f32_16x16x32_bf16 v[48:51], a[60:63], a[104:107], v[48:51]
    v_mfma_f32_16x16x32_bf16 v[52:55], a[60:63], a[108:111], v[52:55]
    v_mfma_f32_16x16x32_bf16 v[64:67], a[64:67], a[96:99], v[64:67]
    v_mfma_f32_16x16x32_bf16 v[68:71], a[64:67], a[100:103], v[68:71]
    v_mfma_f32_16x16x32_bf16 v[80:83], a[64:67], a[104:107], v[80:83]
    v_mfma_f32_16x16x32_bf16 v[84:87], a[64:67], a[108:111], v[84:87]
    s_waitcnt lgkmcnt(0)
    s_nop 0
    v_mfma_f32_16x16x32_bf16 v[8:11], a[68:71], a[96:99], v[8:11]
    v_mfma_f32_16x16x32_bf16 v[12:15], a[68:71], a[100:103], v[12:15]
    s_setprio 3
    s_barrier
    ds_read2_b64 a[56:59], v123 offset0:64 offset1:68
    ds_read2_b64 a[60:63], v123 offset0:96 offset1:100
    ds_read2_b64 a[64:67], v123 offset0:128 offset1:132
    v_mfma_f32_16x16x32_bf16 v[24:27], a[68:71], a[104:107], v[24:27]
    v_mfma_f32_16x16x32_bf16 v[28:31], a[68:71], a[108:111], v[28:31]
    s_bfe_u32 s4, s43, 0x40000
    s_mul_i32 s4, s4, 28672
    s_add_u32 m0, s10, 0
    s_add_u32 s4, s4, s22
    buffer_load_dwordx4 v119, s[44:47], s4 offen offset:0 lds
    v_mfma_f32_16x16x32_bf16 v[40:43], a[72:75], a[96:99], v[40:43]
    v_mfma_f32_16x16x32_bf16 v[44:47], a[72:75], a[100:103], v[44:47]
    buffer_load_dwordx4 v120, s[44:47], s4 offen offset:1024 lds
    v_mfma_f32_16x16x32_bf16 v[56:59], a[72:75], a[104:107], v[56:59]
    v_mfma_f32_16x16x32_bf16 v[60:63], a[72:75], a[108:111], v[60:63]
    buffer_load_dwordx4 v121, s[44:47], s4 offen offset:2048 lds
    v_mfma_f32_16x16x32_bf16 v[72:75], a[76:79], a[96:99], v[72:75]
    v_mfma_f32_16x16x32_bf16 v[76:79], a[76:79], a[100:103], v[76:79]
    buffer_load_dwordx4 v122, s[44:47], s4 offen offset:3072 lds
    v_mfma_f32_16x16x32_bf16 v[88:91], a[76:79], a[104:107], v[88:91]
    v_mfma_f32_16x16x32_bf16 v[92:95], a[76:79], a[108:111], v[92:95]
    s_waitcnt lgkmcnt(0)
    v_mfma_f32_32x32x16_bf16 v[0:15], a[56:59], v[136:139], v[0:15]
    v_mfma_f32_32x32x16_bf16 v[16:31], a[56:59], v[140:143], v[16:31]
    s_bfe_u32 s4, s43, 0x40004
    s_mul_i32 s4, s4, 28672
    s_add_u32 m0, s10, 4096
    s_add_u32 s4, s4, s22
    buffer_load_dwordx4 v119, s[44:47], s4 offen offset:0 lds
    v_mfma_f32_32x32x16_bf16 v[32:47], a[60:63], v[136:139], v[32:47]
    buffer_load_dwordx4 v120, s[44:47], s4 offen offset:1024 lds
    v_mfma_f32_32x32x16_bf16 v[48:63], a[60:63], v[140:143], v[48:63]
    buffer_load_dwordx4 v121, s[44:47], s4 offen offset:2048 lds
    v_mfma_f32_32x32x16_bf16 v[64:79], a[64:67], v[136:139], v[64:79]
    buffer_load_dwordx4 v122, s[44:47], s4 offen offset:3072 lds
    v_mfma_f32_32x32x16_bf16 v[80:95], a[64:67], v[140:143], v[80:95]
    s_setprio 0
    s_nop 4
    s_lshl_b32 s8, s25, 11
    s_add_u32 s8, s8, s23
    s_add_u32 s9, s8, 4096
    v_pk_mul_f32 v[136:137], v[0:1], v[0:1]
    v_pk_mul_f32 v[138:139], v[2:3], v[2:3]
    v_pk_mul_f32 v[140:141], v[4:5], v[4:5]
    v_pk_mul_f32 v[142:143], v[6:7], v[6:7]
    v_pk_fma_f32 v[136:137], v[136:137], v[132:133], v[128:129] op_sel_hi:[1,0,0]
    v_pk_fma_f32 v[138:139], v[138:139], v[132:133], v[128:129] op_sel_hi:[1,0,0]
    v_pk_fma_f32 v[140:141], v[140:141], v[134:135], v[130:131] op_sel_hi:[1,0,0]
    v_pk_fma_f32 v[142:143], v[142:143], v[134:135], v[130:131] op_sel_hi:[1,0,0]
    v_pk_mul_f32 v[136:137], v[0:1], v[136:137]
    v_pk_mul_f32 v[138:139], v[2:3], v[138:139]
    v_pk_mul_f32 v[140:141], v[4:5], v[140:141]
    v_pk_mul_f32 v[142:143], v[6:7], v[142:143]
    v_exp_f32 v136, v136
    v_exp_f32 v137, v137
    v_exp_f32 v138, v138
    v_exp_f32 v139, v139
    v_exp_f32 v140, v140
    v_exp_f32 v141, v141
    v_exp_f32 v142, v142
    v_exp_f32 v143, v143
    v_pk_mul_f32 v[0:1], v[0:1], v[8:9]
    v_pk_mul_f32 v[2:3], v[2:3], v[10:11]
    v_pk_mul_f32 v[4:5], v[4:5], v[12:13]
    v_pk_mul_f32 v[6:7], v[6:7], v[14:15]
    v_pk_fma_f32 v[136:137], v[136:137], v[124:125], v[124:125] op_sel_hi:[1,0,0]
    v_pk_fma_f32 v[138:139], v[138:139], v[124:125], v[124:125] op_sel_hi:[1,0,0]
    v_pk_fma_f32 v[140:141], v[140:141], v[126:127], v[126:127] op_sel_hi:[1,0,0]
    v_pk_fma_f32 v[142:143], v[142:143], v[126:127], v[126:127] op_sel_hi:[1,0,0]
    v_rcp_f32 v136, v136
    v_rcp_f32 v137, v137
    v_rcp_f32 v138, v138
    v_rcp_f32 v139, v139
    v_rcp_f32_e64 v140, v140
    v_rcp_f32 v141, v141
    s_waitcnt vmcnt(4)
    ds_read_b64_tr_b16 a[0:1], v117 offset:0
    ds_read_b64_tr_b16 a[2:3], v117 offset:512
    ds_read_b64_tr_b16 a[4:5], v118 offset:0
    ds_read_b64_tr_b16 a[6:7], v118 offset:512
    ds_read_b64_tr_b16 a[8:9], v117 offset:2048
    ds_read_b64_tr_b16 a[10:11], v117 offset:2560
    ds_read_b64_tr_b16 a[12:13], v118 offset:2048
    ds_read_b64_tr_b16 a[14:15], v118 offset:2560
    v_mov_b32 v116, 160832
L_sy_10:
    ds_read_b128 v[96:99], v116
    s_waitcnt lgkmcnt(0)
    v_min3_u32 v96, v96, v97, v98
    v_min_u32 v96, v96, v99
    v_cmp_eq_u32 vcc, 0, v96
    s_cbranch_vccnz L_sy_10
    s_bfe_u32 s4, s43, 0x40008
    s_mul_i32 s4, s4, 28672
    s_add_u32 m0, s10, 20480
    s_add_u32 s4, s4, s22
    buffer_load_dwordx4 v119, s[44:47], s4 offen offset:0 lds
    buffer_load_dwordx4 v120, s[44:47], s4 offen offset:1024 lds
    buffer_load_dwordx4 v121, s[44:47], s4 offen offset:2048 lds
    buffer_load_dwordx4 v122, s[44:47], s4 offen offset:3072 lds
    s_bfe_u32 s4, s43, 0x4000c
    s_mul_i32 s4, s4, 28672
    s_add_u32 m0, s10, 8192
    s_add_u32 s4, s4, s22
    buffer_load_dwordx4 v119, s[44:47], s4 offen offset:0 lds
    buffer_load_dwordx4 v120, s[44:47], s4 offen offset:1024 lds
    buffer_load_dwordx4 v121, s[44:47], s4 offen offset:2048 lds
    buffer_load_dwordx4 v122, s[44:47], s4 offen offset:3072 lds
    s_bfe_u32 s4, s43, 0x40010
    s_mul_i32 s4, s4, 28672
    s_add_u32 m0, s10, 12288
    s_add_u32 s4, s4, s22
    buffer_load_dwordx4 v119, s[44:47], s4 offen offset:0 lds
    buffer_load_dwordx4 v120, s[44:47], s4 offen offset:1024 lds
    buffer_load_dwordx4 v121, s[44:47], s4 offen offset:2048 lds
    buffer_load_dwordx4 v122, s[44:47], s4 offen offset:3072 lds
    s_bfe_u32 s4, s43, 0x40014
    s_mul_i32 s4, s4, 28672
    s_add_u32 m0, s10, 16384
    s_add_u32 s4, s4, s22
    buffer_load_dwordx4 v119, s[44:47], s4 offen offset:0 lds
    buffer_load_dwordx4 v120, s[44:47], s4 offen offset:1024 lds
    buffer_load_dwordx4 v121, s[44:47], s4 offen offset:2048 lds
    buffer_load_dwordx4 v122, s[44:47], s4 offen offset:3072 lds
    s_bfe_u32 s4, s43, 0x40018
    s_mul_i32 s4, s4, 28672
    s_add_u32 m0, s10, 0
    s_add_u32 s4, s4, s22
    buffer_load_dwordx4 v119, s[44:47], s4 offen offset:0 lds
    buffer_load_dwordx4 v120, s[44:47], s4 offen offset:1024 lds
    buffer_load_dwordx4 v121, s[44:47], s4 offen offset:2048 lds
    buffer_load_dwordx4 v122, s[44:47], s4 offen offset:3072 lds
    v_rcp_f32 v142, v142
    v_rcp_f32 v143, v143
    v_pk_mul_f32 v[0:1], v[0:1], v[136:137]
    v_pk_mul_f32 v[2:3], v[2:3], v[138:139]
    v_pk_mul_f32 v[4:5], v[4:5], v[140:141]
    v_pk_mul_f32 v[6:7], v[6:7], v[142:143]
    v_cvt_pk_bf16_f32 v8, v0, v1
    v_cvt_pk_bf16_f32 v10, v4, v5
    v_cvt_pk_bf16_f32 v9, v2, v3
    v_cvt_pk_bf16_f32 v11, v6, v7
    s_nop 0
    v_permlane16_swap_b32 v8, v10
    v_permlane16_swap_b32 v9, v11
    s_nop 0
    buffer_store_dwordx4 v[8:11], v112, s[52:55], s8 offen offset:0 sc1
    v_pk_mul_f32 v[136:137], v[32:33], v[32:33]
    v_pk_mul_f32 v[138:139], v[34:35], v[34:35]
    v_pk_mul_f32 v[140:141], v[36:37], v[36:37]
    v_pk_mul_f32 v[142:143], v[38:39], v[38:39]
    v_pk_fma_f32 v[136:137], v[136:137], v[132:133], v[128:129] op_sel_hi:[1,0,0]
    v_pk_fma_f32 v[138:139], v[138:139], v[132:133], v[128:129] op_sel_hi:[1,0,0]
    v_pk_fma_f32 v[140:141], v[140:141], v[134:135], v[130:131] op_sel_hi:[1,0,0]
    v_pk_fma_f32 v[142:143], v[142:143], v[134:135], v[130:131] op_sel_hi:[1,0,0]
    v_pk_mul_f32 v[136:137], v[32:33], v[136:137]
    v_pk_mul_f32 v[138:139], v[34:35], v[138:139]
    v_pk_mul_f32 v[140:141], v[36:37], v[140:141]
    v_pk_mul_f32 v[142:143], v[38:39], v[142:143]
    v_exp_f32 v136, v136
    v_exp_f32 v137, v137
    v_exp_f32 v138, v138
    v_exp_f32 v139, v139
    v_exp_f32 v140, v140
    v_exp_f32 v141, v141
    v_exp_f32 v142, v142
    v_exp_f32 v143, v143
    v_pk_mul_f32 v[32:33], v[32:33], v[40:41]
    v_pk_mul_f32 v[34:35], v[34:35], v[42:43]
    v_pk_mul_f32 v[36:37], v[36:37], v[44:45]
    v_pk_mul_f32 v[38:39], v[38:39], v[46:47]
    v_pk_fma_f32 v[136:137], v[136:137], v[124:125], v[124:125] op_sel_hi:[1,0,0]
    v_pk_fma_f32 v[138:139], v[138:139], v[124:125], v[124:125] op_sel_hi:[1,0,0]
    v_pk_fma_f32 v[140:141], v[140:141], v[126:127], v[126:127] op_sel_hi:[1,0,0]
    v_pk_fma_f32 v[142:143], v[142:143], v[126:127], v[126:127] op_sel_hi:[1,0,0]
    v_rcp_f32 v136, v136
    v_rcp_f32 v137, v137
    v_rcp_f32 v138, v138
    v_rcp_f32 v139, v139
    v_rcp_f32 v140, v140
    v_rcp_f32 v141, v141
    v_rcp_f32 v142, v142
    v_rcp_f32 v143, v143
    v_pk_mul_f32 v[32:33], v[32:33], v[136:137]
    v_pk_mul_f32 v[34:35], v[34:35], v[138:139]
    v_pk_mul_f32 v[36:37], v[36:37], v[140:141]
    v_pk_mul_f32 v[38:39], v[38:39], v[142:143]
    v_cvt_pk_bf16_f32 v40, v32, v33
    v_cvt_pk_bf16_f32 v42, v36, v37
    v_cvt_pk_bf16_f32 v41, v34, v35
    v_cvt_pk_bf16_f32 v43, v38, v39
    s_nop 0
    v_permlane16_swap_b32 v40, v42
    v_permlane16_swap_b32 v41, v43
    s_nop 0
    buffer_store_dwordx4 v[40:43], v112, s[52:55], s8 offen offset:2048 sc1
    v_pk_mul_f32 v[136:137], v[64:65], v[64:65]
    v_pk_mul_f32 v[138:139], v[66:67], v[66:67]
    v_pk_mul_f32 v[140:141], v[68:69], v[68:69]
    v_pk_mul_f32 v[142:143], v[70:71], v[70:71]
    v_pk_fma_f32 v[136:137], v[136:137], v[132:133], v[128:129] op_sel_hi:[1,0,0]
    v_pk_fma_f32 v[138:139], v[138:139], v[132:133], v[128:129] op_sel_hi:[1,0,0]
    v_pk_fma_f32 v[140:141], v[140:141], v[134:135], v[130:131] op_sel_hi:[1,0,0]
    v_pk_fma_f32 v[142:143], v[142:143], v[134:135], v[130:131] op_sel_hi:[1,0,0]
    v_pk_mul_f32 v[136:137], v[64:65], v[136:137]
    v_pk_mul_f32 v[138:139], v[66:67], v[138:139]
    v_pk_mul_f32 v[140:141], v[68:69], v[140:141]
    v_pk_mul_f32 v[142:143], v[70:71], v[142:143]
    v_exp_f32 v136, v136
    v_exp_f32 v137, v137
    v_exp_f32 v138, v138
    v_exp_f32 v139, v139
    v_exp_f32 v140, v140
    v_exp_f32 v141, v141
    v_exp_f32 v142, v142
    v_exp_f32 v143, v143
    v_pk_mul_f32 v[64:65], v[64:65], v[72:73]
    v_pk_mul_f32 v[66:67], v[66:67], v[74:75]
    v_pk_mul_f32 v[68:69], v[68:69], v[76:77]
    v_pk_mul_f32 v[70:71], v[70:71], v[78:79]
    v_pk_fma_f32 v[136:137], v[136:137], v[124:125], v[124:125] op_sel_hi:[1,0,0]
    v_pk_fma_f32 v[138:139], v[138:139], v[124:125], v[124:125] op_sel_hi:[1,0,0]
    v_pk_fma_f32 v[140:141], v[140:141], v[126:127], v[126:127] op_sel_hi:[1,0,0]
    v_pk_fma_f32 v[142:143], v[142:143], v[126:127], v[126:127] op_sel_hi:[1,0,0]
    v_rcp_f32 v136, v136
    v_rcp_f32 v137, v137
    v_rcp_f32 v138, v138
    v_rcp_f32 v139, v139
    v_rcp_f32 v140, v140
    v_rcp_f32 v141, v141
    v_rcp_f32 v142, v142
    v_rcp_f32 v143, v143
    v_pk_mul_f32 v[64:65], v[64:65], v[136:137]
    v_pk_mul_f32 v[66:67], v[66:67], v[138:139]
    v_pk_mul_f32 v[68:69], v[68:69], v[140:141]
    v_pk_mul_f32 v[70:71], v[70:71], v[142:143]
    v_cvt_pk_bf16_f32 v72, v64, v65
    v_cvt_pk_bf16_f32 v74, v68, v69
    v_cvt_pk_bf16_f32 v73, v66, v67
    v_cvt_pk_bf16_f32 v75, v70, v71
    s_nop 0
    v_permlane16_swap_b32 v72, v74
    v_permlane16_swap_b32 v73, v75
    buffer_store_dwordx4 v[72:75], v112, s[52:55], s9 offen offset:0 sc1
    v_mul_f32 v132, v133, v133
    v_mul_f32 v128, 0xc0135761, v133
    v_mul_f32_e64 v134, v135, v135
    v_mul_f32 v130, 0xc0135761, v135
    v_mul_f32 v132, 0x3d372713, v132
    v_mul_f32 v134, 0x3d372713, v134
    v_mul_f32 v132, v128, v132
    v_mul_f32 v134, v130, v134
    v_pk_mul_f32 v[136:137], v[16:17], v[16:17]
    v_pk_mul_f32 v[138:139], v[18:19], v[18:19]
    v_pk_mul_f32 v[140:141], v[20:21], v[20:21]
    v_pk_mul_f32 v[142:143], v[22:23], v[22:23]
    v_pk_fma_f32 v[136:137], v[136:137], v[132:133], v[128:129] op_sel_hi:[1,0,0]
    v_pk_fma_f32 v[138:139], v[138:139], v[132:133], v[128:129] op_sel_hi:[1,0,0]
    v_pk_fma_f32 v[140:141], v[140:141], v[134:135], v[130:131] op_sel_hi:[1,0,0]
    v_pk_fma_f32 v[142:143], v[142:143], v[134:135], v[130:131] op_sel_hi:[1,0,0]
    v_pk_mul_f32 v[136:137], v[16:17], v[136:137]
    v_pk_mul_f32 v[138:139], v[18:19], v[138:139]
    v_pk_mul_f32 v[140:141], v[20:21], v[140:141]
    v_pk_mul_f32 v[142:143], v[22:23], v[142:143]
    v_exp_f32 v136, v136
    v_exp_f32 v137, v137
    v_exp_f32 v138, v138
    v_exp_f32 v139, v139
    v_exp_f32 v140, v140
    v_exp_f32 v141, v141
    v_exp_f32 v142, v142
    v_exp_f32 v143, v143
    v_pk_mul_f32 v[16:17], v[16:17], v[24:25]
    v_pk_mul_f32 v[18:19], v[18:19], v[26:27]
    v_pk_mul_f32 v[20:21], v[20:21], v[28:29]
    v_pk_mul_f32 v[22:23], v[22:23], v[30:31]
    v_pk_fma_f32 v[136:137], v[136:137], v[108:109], v[108:109] op_sel_hi:[1,0,0]
    v_pk_fma_f32 v[138:139], v[138:139], v[108:109], v[108:109] op_sel_hi:[1,0,0]
    v_pk_fma_f32 v[140:141], v[140:141], v[110:111], v[110:111] op_sel_hi:[1,0,0]
    v_pk_fma_f32 v[142:143], v[142:143], v[110:111], v[110:111] op_sel_hi:[1,0,0]
    v_rcp_f32 v136, v136
    v_rcp_f32 v137, v137
    v_rcp_f32 v138, v138
    v_rcp_f32 v139, v139
    v_rcp_f32 v140, v140
    v_rcp_f32 v141, v141
    v_rcp_f32 v142, v142
    v_rcp_f32 v143, v143
    v_pk_mul_f32 v[16:17], v[16:17], v[136:137]
    v_pk_mul_f32 v[18:19], v[18:19], v[138:139]
    v_pk_mul_f32 v[20:21], v[20:21], v[140:141]
    v_pk_mul_f32 v[22:23], v[22:23], v[142:143]
    v_cvt_pk_bf16_f32 v24, v16, v17
    v_cvt_pk_bf16_f32 v26, v20, v21
    v_cvt_pk_bf16_f32 v25, v18, v19
    v_cvt_pk_bf16_f32 v27, v22, v23
    s_nop 0
    v_permlane16_swap_b32 v24, v26
    v_permlane16_swap_b32 v25, v27
    s_nop 0
    buffer_store_dwordx4 v[24:27], v112, s[52:55], s8 offen offset:1024 sc1
    v_pk_mul_f32 v[136:137], v[48:49], v[48:49]
    v_pk_mul_f32 v[138:139], v[50:51], v[50:51]
    v_pk_mul_f32 v[140:141], v[52:53], v[52:53]
    v_pk_mul_f32 v[142:143], v[54:55], v[54:55]
    v_pk_fma_f32 v[136:137], v[136:137], v[132:133], v[128:129] op_sel_hi:[1,0,0]
    v_pk_fma_f32 v[138:139], v[138:139], v[132:133], v[128:129] op_sel_hi:[1,0,0]
    v_pk_fma_f32 v[140:141], v[140:141], v[134:135], v[130:131] op_sel_hi:[1,0,0]
    v_pk_fma_f32 v[142:143], v[142:143], v[134:135], v[130:131] op_sel_hi:[1,0,0]
    v_pk_mul_f32 v[136:137], v[48:49], v[136:137]
    v_pk_mul_f32 v[138:139], v[50:51], v[138:139]
    v_pk_mul_f32 v[140:141], v[52:53], v[140:141]
    v_pk_mul_f32 v[142:143], v[54:55], v[142:143]
    v_exp_f32 v136, v136
    v_exp_f32 v137, v137
    v_exp_f32 v138, v138
    v_exp_f32 v139, v139
    v_exp_f32 v140, v140
    v_exp_f32 v141, v141
    v_exp_f32 v142, v142
    v_exp_f32 v143, v143
    v_pk_mul_f32 v[48:49], v[48:49], v[56:57]
    v_pk_mul_f32 v[50:51], v[50:51], v[58:59]
    v_pk_mul_f32 v[52:53], v[52:53], v[60:61]
    v_pk_mul_f32 v[54:55], v[54:55], v[62:63]
    v_pk_fma_f32 v[136:137], v[136:137], v[108:109], v[108:109] op_sel_hi:[1,0,0]
    v_pk_fma_f32 v[138:139], v[138:139], v[108:109], v[108:109] op_sel_hi:[1,0,0]
    v_pk_fma_f32 v[140:141], v[140:141], v[110:111], v[110:111] op_sel_hi:[1,0,0]
    v_pk_fma_f32 v[142:143], v[142:143], v[110:111], v[110:111] op_sel_hi:[1,0,0]
    v_rcp_f32 v136, v136
    v_rcp_f32 v137, v137
    v_rcp_f32 v138, v138
    v_rcp_f32 v139, v139
    v_rcp_f32 v140, v140
    v_rcp_f32 v141, v141
    v_rcp_f32 v142, v142
    v_rcp_f32 v143, v143
    v_pk_mul_f32 v[48:49], v[48:49], v[136:137]
    v_pk_mul_f32 v[50:51], v[50:51], v[138:139]
    v_pk_mul_f32 v[52:53], v[52:53], v[140:141]
    v_pk_mul_f32 v[54:55], v[54:55], v[142:143]
    v_cvt_pk_bf16_f32 v56, v48, v49
    v_cvt_pk_bf16_f32 v58, v52, v53
    v_cvt_pk_bf16_f32 v57, v50, v51
    v_cvt_pk_bf16_f32 v59, v54, v55
    s_nop 0
    v_permlane16_swap_b32 v56, v58
    v_permlane16_swap_b32 v57, v59
    s_nop 0
    buffer_store_dwordx4 v[56:59], v112, s[52:55], s8 offen offset:3072 sc1
    v_pk_mul_f32 v[136:137], v[80:81], v[80:81]
    v_pk_mul_f32 v[138:139], v[82:83], v[82:83]
    v_pk_mul_f32 v[140:141], v[84:85], v[84:85]
    v_pk_mul_f32 v[142:143], v[86:87], v[86:87]
    v_pk_fma_f32 v[136:137], v[136:137], v[132:133], v[128:129] op_sel_hi:[1,0,0]
    v_pk_fma_f32 v[138:139], v[138:139], v[132:133], v[128:129] op_sel_hi:[1,0,0]
    v_pk_fma_f32 v[140:141], v[140:141], v[134:135], v[130:131] op_sel_hi:[1,0,0]
    v_pk_fma_f32 v[142:143], v[142:143], v[134:135], v[130:131] op_sel_hi:[1,0,0]
    v_pk_mul_f32 v[136:137], v[80:81], v[136:137]
    v_pk_mul_f32 v[138:139], v[82:83], v[138:139]
    v_pk_mul_f32 v[140:141], v[84:85], v[140:141]
    v_pk_mul_f32 v[142:143], v[86:87], v[142:143]
    v_exp_f32 v136, v136
    v_exp_f32 v137, v137
    v_exp_f32 v138, v138
    v_exp_f32 v139, v139
    v_exp_f32 v140, v140
    v_exp_f32 v141, v141
    v_exp_f32 v142, v142
    v_exp_f32 v143, v143
    v_pk_mul_f32 v[80:81], v[80:81], v[88:89]
    v_pk_mul_f32 v[82:83], v[82:83], v[90:91]
    v_pk_mul_f32 v[84:85], v[84:85], v[92:93]
    v_pk_mul_f32 v[86:87], v[86:87], v[94:95]
    v_pk_fma_f32 v[136:137], v[136:137], v[108:109], v[108:109] op_sel_hi:[1,0,0]
    v_pk_fma_f32 v[138:139], v[138:139], v[108:109], v[108:109] op_sel_hi:[1,0,0]
    v_pk_fma_f32 v[140:141], v[140:141], v[110:111], v[110:111] op_sel_hi:[1,0,0]
    v_pk_fma_f32 v[142:143], v[142:143], v[110:111], v[110:111] op_sel_hi:[1,0,0]
    v_rcp_f32 v136, v136
    v_rcp_f32 v137, v137
    v_rcp_f32 v138, v138
    v_rcp_f32 v139, v139
    v_rcp_f32 v140, v140
    v_rcp_f32 v141, v141
    v_rcp_f32 v142, v142
    v_rcp_f32 v143, v143
    v_pk_mul_f32 v[80:81], v[80:81], v[136:137]
    v_pk_mul_f32 v[82:83], v[82:83], v[138:139]
    v_pk_mul_f32 v[84:85], v[84:85], v[140:141]
    v_pk_mul_f32 v[86:87], v[86:87], v[142:143]
    v_cvt_pk_bf16_f32 v88, v80, v81
    v_cvt_pk_bf16_f32 v90, v84, v85
    v_cvt_pk_bf16_f32 v89, v82, v83
    v_cvt_pk_bf16_f32 v91, v86, v87
    s_nop 0
    v_permlane16_swap_b32 v88, v90
    v_permlane16_swap_b32 v89, v91
    s_nop 0
    buffer_store_dwordx4 v[88:91], v112, s[52:55], s9 offen offset:1024 sc1
    s_setprio 0
    s_waitcnt vmcnt(6)
    ds_read_b64_tr_b16 a[16:17], v117 offset:4096
    ds_read_b64_tr_b16 a[18:19], v117 offset:4608
    ds_read_b64_tr_b16 a[20:21], v118 offset:4096
    ds_read_b64_tr_b16 a[22:23], v118 offset:4608
    ds_read_b64_tr_b16 a[24:25], v117 offset:6144
    ds_read_b64_tr_b16 a[26:27], v117 offset:6656
    ds_read_b64_tr_b16 a[28:29], v118 offset:6144
    ds_read_b64_tr_b16 a[30:31], v118 offset:6656
    ds_read_b64_tr_b16 a[32:33], v117 offset:20480
    ds_read_b64_tr_b16 a[34:35], v117 offset:20992
    ds_read_b64_tr_b16 a[36:37], v118 offset:20480
    ds_read_b64_tr_b16 a[38:39], v118 offset:20992
    ds_read_b64_tr_b16 a[40:41], v117 offset:22528
    ds_read_b64_tr_b16 a[42:43], v117 offset:23040
    ds_read_b64_tr_b16 a[44:45], v118 offset:22528
    ds_read_b64_tr_b16 a[46:47], v118 offset:23040
    ds_read_b64_tr_b16 a[48:49], v117 offset:8192
    ds_read_b64_tr_b16 a[50:51], v117 offset:8704
    ds_read_b64_tr_b16 a[52:53], v118 offset:8192
    ds_read_b64_tr_b16 a[54:55], v118 offset:8704
    ds_read_b64_tr_b16 a[56:57], v117 offset:10240
    ds_read_b64_tr_b16 a[58:59], v117 offset:10752
    ds_read_b64_tr_b16 a[60:61], v118 offset:10240
    ds_read_b64_tr_b16 a[62:63], v118 offset:10752
    ds_read_b64_tr_b16 a[64:65], v117 offset:12288
    ds_read_b64_tr_b16 a[66:67], v117 offset:12800
    ds_read_b64_tr_b16 a[68:69], v118 offset:12288
    ds_read_b64_tr_b16 a[70:71], v118 offset:12800
    ds_read_b64_tr_b16 a[72:73], v117 offset:14336
    ds_read_b64_tr_b16 a[74:75], v117 offset:14848
    ds_read_b64_tr_b16 a[76:77], v118 offset:14336
    ds_read_b64_tr_b16 a[78:79], v118 offset:14848
    ds_read_b64_tr_b16 a[80:81], v117 offset:16384
    ds_read_b64_tr_b16 a[82:83], v117 offset:16896
    ds_read_b64_tr_b16 a[84:85], v118 offset:16384
    ds_read_b64_tr_b16 a[86:87], v118 offset:16896
    ds_read_b64_tr_b16 a[88:89], v117 offset:18432
    ds_read_b64_tr_b16 a[90:91], v117 offset:18944
    ds_read_b64_tr_b16 a[92:93], v118 offset:18432
    ds_read_b64_tr_b16 a[94:95], v118 offset:18944
    ds_read_b64_tr_b16 a[96:97], v117 offset:0
    ds_read_b64_tr_b16 a[98:99], v117 offset:512
    ds_read_b64_tr_b16 a[100:101], v118 offset:0
    ds_read_b64_tr_b16 a[102:103], v118 offset:512
    ds_read_b64_tr_b16 a[104:105], v117 offset:2048
    ds_read_b64_tr_b16 a[106:107], v117 offset:2560
    ds_read_b64_tr_b16 a[108:109], v118 offset:2048
    ds_read_b64_tr_b16 a[110:111], v118 offset:2560
    s_lshl_b32 s3, s26, 2
    s_add_u32 s3, s3, 160848
    v_mov_b32 v116, s3
    s_mov_b64 exec, 1
    s_waitcnt lgkmcnt(0)
    ds_write_b32 v116, v114
    s_mov_b64 exec, -1
    v_mov_b32 v116, 160784
L_sy_11:
    ds_read_b128 v[0:3], v116
    s_waitcnt lgkmcnt(0)
    v_min3_u32 v0, v0, v1, v2
    v_min_u32_e64 v0, v0, v3
    v_cmp_eq_u32 vcc, 0, v0
    s_cbranch_vccnz L_sy_11
    s_add_u32 m0, s40, 0
    s_add_u32 s5, s41, 0
    buffer_load_dwordx4 v119, s[48:51], s5 offen offset:0 lds
    buffer_load_dwordx4 v120, s[48:51], s5 offen offset:1024 lds
    buffer_load_dwordx4 v121, s[48:51], s5 offen offset:2048 lds
    buffer_load_dwordx4 v122, s[48:51], s5 offen offset:3072 lds
    s_add_u32 m0, s40, 4096
    s_add_u32 s5, s41, 28672
    buffer_load_dwordx4 v119, s[48:51], s5 offen offset:0 lds
    buffer_load_dwordx4 v120, s[48:51], s5 offen offset:1024 lds
    s_waitcnt vmcnt(6)
    s_mov_b32 s42, 1
    s_atomic_add s42, s[52:53], s16
    buffer_load_dwordx4 v121, s[48:51], s5 offen offset:2048 lds
    buffer_load_dwordx4 v122, s[48:51], s5 offen offset:3072 lds
    s_add_u32 m0, s40, 8192
    s_add_u32 s5, s41, 57344
    buffer_load_dwordx4 v119, s[48:51], s5 offen offset:0 lds
    buffer_load_dwordx4 v120, s[48:51], s5 offen offset:1024 lds
    buffer_load_dwordx4 v121, s[48:51], s5 offen offset:2048 lds
    buffer_load_dwordx4 v122, s[48:51], s5 offen offset:3072 lds
    s_add_u32 m0, s40, 12288
    s_add_u32 s5, s41, 86016
    buffer_load_dwordx4 v119, s[48:51], s5 offen offset:0 lds
    buffer_load_dwordx4 v120, s[48:51], s5 offen offset:1024 lds
    s_branch L_waitS
L_QA:
    v_lshlrev_b32 v19, 7, v16
    v_lshl_add_u32 v19, v14, 3, v19
    v_add_u32 v19, 102400, v19
    v_lshrrev_b32_e64 v20, 1, v13
    v_lshl_add_u32 v20, v15, 1, v20
    v_xor_b32_e64 v12, 3, v20
    v_lshl_add_u32 v100, v12, 5, v19
    v_xor_b32_e64 v12, s26, v20
    v_lshl_add_u32 v101, v12, 5, v19
    v_lshlrev_b32_e64 v19, 6, v16
    v_lshl_add_u32 v19, v15, 5, v19
    v_add_u32 v19, 98304, v19
    v_lshl_add_u32 v98, v14, 3, v19
    v_lshrrev_b32 v18, 1, v14
    v_xor_b32 v18, v18, v14
    v_xor_b32_e64 v19, 32, v19
    v_lshl_add_u32 v99, v18, 3, v19
    s_and_b32 s3, s26, 0
    s_lshl_b32 s3, s3, 12
    v_add_u32 v102, s3, v98
    v_add_u32 v103, s3, v99
    s_and_b32 s3, s74, 3
    s_lshl_b32 s3, s3, 2
    s_add_u32 s25, s25, s3
    s_lshl_b32 s75, s72, 3
    s_or_b32 s75, s75, s73
    v_mov_b32 v20, 0
    v_lshrrev_b32 v19, 2, v112
    v_add_u32 v19, 160768, v19
    ds_write_b32 v19, v20
    s_add_u32 s76, s76, 1
    s_cmp_eq_u32 s76, 7
    s_cselect_b32 s76, 0, s76
    s_add_u32 m0, s10, 8192
    s_lshl_b32 s4, s76, 7
    s_add_u32 s4, s4, s77
    buffer_load_dwordx4 v104, s[28:31], s4 offen offset:0 lds
    buffer_load_dwordx4 v105, s[28:31], s4 offen offset:1024 lds
    buffer_load_dwordx4 v106, s[28:31], s4 offen offset:2048 lds
    buffer_load_dwordx4 v107, s[28:31], s4 offen offset:3072 lds
    s_cmp_ge_u32 s14, 32
    s_cbranch_scc1 L_bt_12
    s_and_b32 s3, s2, 1
    s_lshl_b32 s3, s3, 7
    s_mov_b32 s42, 1
    s_waitcnt vmcnt(12)
    s_atomic_add s42, s[60:61], s3
L_bt_12:
    s_waitcnt vmcnt(4) lgkmcnt(0)
    s_barrier
    ds_read_b64_tr_b16 a[64:65], v98 offset:0
    ds_read_b64_tr_b16 a[66:67], v98 offset:256
    ds_read_b128 a[80:83], v96 offset:0
    ds_read_b128 a[84:87], v96 offset:2048
    ds_read_b128 a[88:91], v96 offset:4096
    ds_read_b128 a[92:95], v96 offset:6144
    ds_read_b64_tr_b16 a[68:69], v99 offset:0
    ds_read_b64_tr_b16 a[70:71], v99 offset:256
    s_setprio 2
    s_waitcnt lgkmcnt(0)
    v_mfma_f32_16x16x32_bf16 v[0:3], a[64:67], a[80:83], 0
    v_mfma_f32_16x16x32_bf16 v[4:7], a[64:67], a[84:87], 0
    ds_read_b64_tr_b16 a[72:73], v100 offset:0
    ds_read_b64_tr_b16 a[74:75], v100 offset:512
    ds_read_b64_tr_b16 a[76:77], v100 offset:8192
    ds_read_b64_tr_b16 a[78:79], v100 offset:8704
    ds_read_b128 a[96:99], v97 offset:0
    v_mfma_f32_16x16x32_bf16 v[16:19], a[64:67], a[88:91], 0
    v_mfma_f32_16x16x32_bf16 v[20:23], a[64:67], a[92:95], 0
    ds_read_b128 a[100:103], v97 offset:2048
    ds_read_b64_tr_b16 v[64:65], v101 offset:0
    ds_read_b64_tr_b16 v[66:67], v101 offset:512
    ds_read_b64_tr_b16 v[68:69], v101 offset:4096
    ds_read_b64_tr_b16 v[70:71], v101 offset:4608
    s_add_u32 m0, s10, 12288
    s_add_u32 s4, s4, 28672
    buffer_load_dwordx4 v104, s[28:31], s4 offen offset:0 lds
    buffer_load_dwordx4 v105, s[28:31], s4 offen offset:1024 lds
    v_mfma_f32_16x16x32_bf16 v[8:11], a[68:71], a[80:83], 0
    v_mfma_f32_16x16x32_bf16 v[12:15], a[68:71], a[84:87], 0
    ds_read_b64_tr_b16 v[72:73], v101 offset:8192
    ds_read_b64_tr_b16 v[74:75], v101 offset:8704
    ds_read_b64_tr_b16 v[76:77], v101 offset:12288
    ds_read_b64_tr_b16 v[78:79], v101 offset:12800
    buffer_load_dwordx4 v106, s[28:31], s4 offen offset:2048 lds
    v_mfma_f32_16x16x32_bf16 v[24:27], a[68:71], a[88:91], 0
    v_mfma_f32_16x16x32_bf16 v[28:31], a[68:71], a[92:95], 0
    buffer_load_dwordx4 v107, s[28:31], s4 offen offset:3072 lds
    s_setprio 0
    v_mov_b32 v115, 1073741824
    v_lshrrev_b32 v124, 4, v112
    v_and_b32 v125, 31, v124
    v_lshrrev_b32_e64 v126, 5, v124
    s_lshl_b32 s15, s27, 2
    s_add_u32 s15, s15, s72
    s_lshl_b32 s15, s15, 3
    s_add_u32 s15, s15, s73
    s_lshl_b32 s15, s15, 2
    s_add_u32 s15, s15, s26
    s_mul_i32 s14, s15, 1792
    v_mul_u32_u24 v109, 896, v126
    v_lshl_add_u32 v109, v125, 4, v109
    v_cmp_lt_u32 vcc, 27, v125
    s_and_b32 s6, s15, 7
    s_lshl_b32 s6, s6, 6
    v_cndmask_b32 v109, v109, v115, vcc
    s_setprio 2
    s_waitcnt lgkmcnt(0)
    v_mfma_f32_16x16x32_bf16 v[32:35], a[72:75], a[80:83], 0
    v_mfma_f32_16x16x32_bf16 v[36:39], a[72:75], a[84:87], 0
    ds_read_b64_tr_b16 a[64:65], v98 offset:2048
    ds_read_b64_tr_b16 a[66:67], v98 offset:2304
    ds_read_b64_tr_b16 a[68:69], v99 offset:2048
    ds_read_b64_tr_b16 a[70:71], v99 offset:2304
    ds_read_b128 a[104:107], v97 offset:4096
    v_mfma_f32_16x16x32_bf16 v[48:51], a[72:75], a[88:91], 0
    v_mfma_f32_16x16x32_bf16 v[52:55], a[72:75], a[92:95], 0
    ds_read_b128 a[108:111], v97 offset:6144
    ds_read_b64_tr_b16 v[80:81], v102 offset:0
    ds_read_b64_tr_b16 v[82:83], v102 offset:256
    ds_read_b64_tr_b16 v[84:85], v102 offset:2048
    ds_read_b64_tr_b16 v[86:87], v102 offset:2304
    s_add_u32 s76, s76, 1
    s_cmp_eq_u32 s76, 7
    s_cselect_b32 s76, 0, s76
    s_add_u32 m0, s10, 16384
    s_lshl_b32 s4, s76, 7
    s_add_u32 s4, s4, s77
    s_nop 0
    buffer_load_dwordx4 v104, s[28:31], s4 offen offset:0 lds
    v_mfma_f32_16x16x32_bf16 v[40:43], a[76:79], a[80:83], 0
    v_mfma_f32_16x16x32_bf16 v[44:47], a[76:79], a[84:87], 0
    ds_read_b64_tr_b16 v[88:89], v103 offset:0
    ds_read_b64_tr_b16 v[90:91], v103 offset:256
    ds_read_b64_tr_b16 v[92:93], v103 offset:2048
    ds_read_b64_tr_b16 v[94:95], v103 offset:2304
    buffer_load_dwordx4 v105, s[28:31], s4 offen offset:1024 lds
    v_mfma_f32_16x16x32_bf16 v[56:59], a[76:79], a[88:91], 0
    v_mfma_f32_16x16x32_bf16 v[60:63], a[76:79], a[92:95], 0
    s_setprio 0
    v_cmp_eq_u32 vcc, 0, v125
    v_lshlrev_b32_e64 v126, 5, v126
    s_and_b32 s3, s15, 24
    v_cndmask_b32 v110, v115, v126, vcc
    s_add_u32 s6, s6, s3
    s_lshr_b32 s15, s15, 5
    s_lshl_b32 s15, s15, 9
    s_add_u32 s15, s15, s6
    s_add_u32 s15, s15, 12582912
    s_mov_b32 s54, 268435456
    s_mov_b32 s55, 0x20000
    s_lshl_b32 s16, s23, 2
    s_add_u32 s16, s16, s72
    s_mul_i32 s16, s16, 512
    s_add_u32 s16, s16, 13631488
    s_mul_i32 s23, s23, 294912
    s_setprio 2
    s_waitcnt lgkmcnt(0)
    v_mfma_f32_16x16x32_bf16 v[0:3], a[64:67], a[96:99], v[0:3]
    v_mfma_f32_16x16x32_bf16 v[4:7], a[64:67], a[100:103], v[4:7]
    ds_read_b64_tr_b16 a[72:73], v100 offset:4096
    ds_read_b64_tr_b16 a[74:75], v100 offset:4608
    ds_read_b64_tr_b16 a[76:77], v100 offset:12288
    ds_read_b64_tr_b16 a[78:79], v100 offset:12800
    v_mfma_f32_16x16x32_bf16 v[16:19], a[64:67], a[104:107], v[16:19]
    v_mfma_f32_16x16x32_bf16 v[20:23], a[64:67], a[108:111], v[20:23]
    buffer_load_dwordx4 v106, s[28:31], s4 offen offset:2048 lds
    v_mfma_f32_16x16x32_bf16 v[8:11], a[68:71], a[96:99], v[8:11]
    v_mfma_f32_16x16x32_bf16 v[12:15], a[68:71], a[100:103], v[12:15]
    buffer_load_dwordx4 v107, s[28:31], s4 offen offset:3072 lds
    v_mfma_f32_16x16x32_bf16 v[24:27], a[68:71], a[104:107], v[24:27]
    v_mfma_f32_16x16x32_bf16 v[28:31], a[68:71], a[108:111], v[28:31]
    s_setprio 0
    buffer_load_dwordx4 v[136:139], v109, s[28:31], s14 offen offset:0
    v_mov_b32 v115, 1073741824
    v_mov_b32 v114, 1
    v_lshrrev_b32 v124, 4, v112
    v_and_b32_e64 v125, 31, v124
    s_add_u32 s17, s16, 256
    s_lshl_b32 s1, s74, 12
    s_add_u32 s1, s1, s23
    s_add_u32 s1, s1, 229376
    s_lshl_b32 s13, s75, 3
    s_add_u32 s13, s13, s27
    s_mul_i32 s13, s13, 640
    s_add_u32 s13, s13, 12615680
    v_lshl_add_u32 v108, v125, 2, s13
    s_setprio 2
    v_mov_b32 v132, 0x3f803f80
    v_mov_b32 v133, 0x3f803f80
    v_mov_b32 v134, 0x3f803f80
    v_mov_b32 v135, 0x3f803f80
    s_nop 1
    v_mfma_f32_16x16x32_bf16 a[16:19], v[132:135], v[64:67], 0
    v_mfma_f32_16x16x32_bf16 a[20:23], v[132:135], v[72:75], 0
    v_mfma_f32_16x16x32_bf16 a[24:27], v[132:135], v[80:83], 0
    v_mfma_f32_16x16x32_bf16 a[28:31], v[132:135], v[88:91], 0
    v_mfma_f32_16x16x32_bf16 a[16:19], v[132:135], v[68:71], a[16:19]
    v_mfma_f32_16x16x32_bf16 a[20:23], v[132:135], v[76:79], a[20:23]
    v_mfma_f32_16x16x32_bf16 a[24:27], v[132:135], v[84:87], a[24:27]
    v_mfma_f32_16x16x32_bf16 a[28:31], v[132:135], v[92:95], a[28:31]
    s_waitcnt lgkmcnt(0)
    s_nop 0
    v_mfma_f32_16x16x32_bf16 v[32:35], a[72:75], a[96:99], v[32:35]
    v_mfma_f32_16x16x32_bf16 v[36:39], a[72:75], a[100:103], v[36:39]
    s_waitcnt vmcnt(5)
    s_barrier
    ds_read_b64_tr_b16 a[64:65], v98 offset:20736
    ds_read_b64_tr_b16 a[66:67], v98 offset:20992
    ds_read_b128 a[80:83], v96 offset:8192
    ds_read_b128 a[84:87], v96 offset:10240
    v_mfma_f32_16x16x32_bf16 v[48:51], a[72:75], a[104:107], v[48:51]
    v_mfma_f32_16x16x32_bf16 v[52:55], a[72:75], a[108:111], v[52:55]
    ds_read_b128 a[88:91], v96 offset:12288
    ds_read_b128 a[92:95], v96 offset:14336
    ds_read_b64_tr_b16 a[68:69], v99 offset:20736
    ds_read_b64_tr_b16 a[70:71], v99 offset:20992
    s_add_u32 m0, s10, 20480
    s_add_u32 s4, s4, 28672
    buffer_load_dwordx4 v104, s[28:31], s4 offen offset:0 lds
    v_mfma_f32_16x16x32_bf16 v[40:43], a[76:79], a[96:99], v[40:43]
    v_mfma_f32_16x16x32_bf16 v[44:47], a[76:79], a[100:103], v[44:47]
    buffer_load_dwordx4 v105, s[28:31], s4 offen offset:1024 lds
    v_mfma_f32_16x16x32_bf16 v[56:59], a[76:79], a[104:107], v[56:59]
    v_mfma_f32_16x16x32_bf16 v[60:63], a[76:79], a[108:111], v[60:63]
    s_setprio 0
    s_add_u32 s3, s26, 1
    s_lshl_b32 s3, s3, 7
    v_mov_b32 v128, s3
    s_cmp_lt_u32 s26, 1
    s_cselect_b32 s3, 0, 1073741824
    v_mov_b32_e64 v125, s3
    s_mov_b32 s18, 0
    s_mov_b32 s19, -1
    v_cndmask_b32 v128, v128, v125, s[18:19]
    v_add_u32_e64 v108, v108, v128
    v_accvgpr_read_b32 v130, a16
    v_accvgpr_read_b32 v133, a20
    v_accvgpr_read_b32 v134, a24
    v_accvgpr_read_b32 v135, a28
    s_cmp_eq_u32 s27, 7
    s_cselect_b32 s13, 0, -1
    s_setprio 2
    s_waitcnt lgkmcnt(0)
    v_mfma_f32_16x16x32_bf16 v[0:3], a[64:67], a[80:83], v[0:3]
    v_mfma_f32_16x16x32_bf16 v[4:7], a[64:67], a[84:87], v[4:7]
    ds_read_b64_tr_b16 a[72:73], v100 offset:20736
    ds_read_b64_tr_b16 a[74:75], v100 offset:21248
    ds_read_b64_tr_b16 a[76:77], v100 offset:28928
    ds_read_b64_tr_b16 a[78:79], v100 offset:29440
    v_mfma_f32_16x16x32_bf16 v[16:19], a[64:67], a[88:91], v[16:19]
    v_mfma_f32_16x16x32_bf16 v[20:23], a[64:67], a[92:95], v[20:23]
    ds_read_b128 a[96:99], v97 offset:8192
    ds_read_b128 a[100:103], v97 offset:10240
    buffer_load_dwordx4 v106, s[28:31], s4 offen offset:2048 lds
    v_mfma_f32_16x16x32_bf16 v[8:11], a[68:71], a[80:83], v[8:11]
    v_mfma_f32_16x16x32_bf16 v[12:15], a[68:71], a[84:87], v[12:15]
    buffer_load_dwordx4 v107, s[28:31], s4 offen offset:3072 lds
    v_mfma_f32_16x16x32_bf16 v[24:27], a[68:71], a[88:91], v[24:27]
    v_mfma_f32_16x16x32_bf16 v[28:31], a[68:71], a[92:95], v[28:31]
    s_setprio 0
    s_nop 1
    v_mov_b32_dpp v130, v133 quad_perm:[0,1,2,3] row_mask:2 bank_mask:0xf
    s_nop 1
    v_mov_b32_dpp v130, v134 quad_perm:[0,1,2,3] row_mask:4 bank_mask:0xf
    s_nop 1
    v_mov_b32_dpp v130, v135 quad_perm:[0,1,2,3] row_mask:8 bank_mask:0xf
    v_and_b32_e64 v131, s13, v130
    buffer_store_dword v131, v108, s[52:55], 0 offen sc1
    s_setprio 2
    s_waitcnt lgkmcnt(0)
    v_mfma_f32_16x16x32_bf16 v[32:35], a[72:75], a[80:83], v[32:35]
    v_mfma_f32_16x16x32_bf16 v[36:39], a[72:75], a[84:87], v[36:39]
    ds_read_b64_tr_b16 a[64:65], v98 offset:22784
    ds_read_b64_tr_b16 a[66:67], v98 offset:23040
    ds_read_b64_tr_b16 a[68:69], v99 offset:22784
    ds_read_b64_tr_b16 a[70:71], v99 offset:23040
    v_mfma_f32_16x16x32_bf16 v[48:51], a[72:75], a[88:91], v[48:51]
    v_mfma_f32_16x16x32_bf16 v[52:55], a[72:75], a[92:95], v[52:55]
    ds_read_b128 a[104:107], v97 offset:12288
    ds_read_b128 a[108:111], v97 offset:14336
    s_add_u32 s76, s76, 1
    s_cmp_eq_u32 s76, 7
    s_cselect_b32 s76, 0, s76
    s_add_u32 m0, s10, 0
    s_lshl_b32 s4, s76, 7
    s_add_u32 s4, s4, s77
    buffer_load_dwordx4 v104, s[28:31], s4 offen offset:0 lds
    buffer_load_dwordx4 v[140:143], v109, s[28:31], s14 offen offset:448
    v_mfma_f32_16x16x32_bf16 v[40:43], a[76:79], a[80:83], v[40:43]
    v_mfma_f32_16x16x32_bf16 v[44:47], a[76:79], a[84:87], v[44:47]
    buffer_load_dwordx4 v105, s[28:31], s4 offen offset:1024 lds
    v_mfma_f32_16x16x32_bf16 v[56:59], a[76:79], a[88:91], v[56:59]
    v_mfma_f32_16x16x32_bf16 v[60:63], a[76:79], a[92:95], v[60:63]
    s_waitcnt lgkmcnt(0)
    s_nop 0
    v_mfma_f32_16x16x32_bf16 v[0:3], a[64:67], a[96:99], v[0:3]
    v_mfma_f32_16x16x32_bf16 v[4:7], a[64:67], a[100:103], v[4:7]
    ds_read_b64_tr_b16 a[72:73], v100 offset:24832
    ds_read_b64_tr_b16 a[74:75], v100 offset:25344
    ds_read_b64_tr_b16 a[76:77], v100 offset:33024
    ds_read_b64_tr_b16 a[78:79], v100 offset:33536
    v_mfma_f32_16x16x32_bf16 v[16:19], a[64:67], a[104:107], v[16:19]
    v_mfma_f32_16x16x32_bf16 v[20:23], a[64:67], a[108:111], v[20:23]
    buffer_load_dwordx4 v106, s[28:31], s4 offen offset:2048 lds
    v_mfma_f32_16x16x32_bf16 v[8:11], a[68:71], a[96:99], v[8:11]
    v_mfma_f32_16x16x32_bf16 v[12:15], a[68:71], a[100:103], v[12:15]
    buffer_load_dwordx4 v107, s[28:31], s4 offen offset:3072 lds
    v_mfma_f32_16x16x32_bf16 v[24:27], a[68:71], a[104:107], v[24:27]
    v_mfma_f32_16x16x32_bf16 v[28:31], a[68:71], a[108:111], v[28:31]
    s_waitcnt lgkmcnt(0)
    s_nop 0
    v_mfma_f32_16x16x32_bf16 v[32:35], a[72:75], a[96:99], v[32:35]
    v_mfma_f32_16x16x32_bf16 v[36:39], a[72:75], a[100:103], v[36:39]
    s_waitcnt vmcnt(6)
    s_barrier
    ds_read_b64_tr_b16 a[64:65], v98 offset:41472
    ds_read_b64_tr_b16 a[66:67], v98 offset:41728
    ds_read_b128 a[80:83], v96 offset:16384
    ds_read_b128 a[84:87], v96 offset:18432
    v_mfma_f32_16x16x32_bf16 v[48:51], a[72:75], a[104:107], v[48:51]
    v_mfma_f32_16x16x32_bf16 v[52:55], a[72:75], a[108:111], v[52:55]
    ds_read_b128 a[88:91], v96 offset:20480
    ds_read_b128 a[92:95], v96 offset:22528
    ds_read_b64_tr_b16 a[68:69], v99 offset:41472
    ds_read_b64_tr_b16 a[70:71], v99 offset:41728
    s_add_u32 m0, s10, 4096
    s_add_u32 s4, s4, 28672
    buffer_load_dwordx4 v104, s[28:31], s4 offen offset:0 lds
    v_mfma_f32_16x16x32_bf16 v[40:43], a[76:79], a[96:99], v[40:43]
    v_mfma_f32_16x16x32_bf16 v[44:47], a[76:79], a[100:103], v[44:47]
    buffer_load_dwordx4 v105, s[28:31], s4 offen offset:1024 lds
    v_mfma_f32_16x16x32_bf16 v[56:59], a[76:79], a[104:107], v[56:59]
    v_mfma_f32_16x16x32_bf16 v[60:63], a[76:79], a[108:111], v[60:63]
    s_setprio 0
    s_waitcnt vmcnt(5)
    v_lshlrev_b32_e64 v128, 16, v136
    v_and_b32 v136, 0xffff0000, v136
    v_lshlrev_b32_e64 v129, 16, v137
    v_and_b32 v137, 0xffff0000, v137
    v_lshlrev_b32_e64 v130, 16, v138
    v_and_b32 v138, 0xffff0000, v138
    v_lshlrev_b32_e64 v131, 16, v139
    v_and_b32 v139, 0xffff0000, v139
    v_lshlrev_b32_e64 v132, 16, v140
    v_and_b32 v140, 0xffff0000, v140
    v_lshlrev_b32_e64 v133, 16, v141
    v_and_b32 v141, 0xffff0000, v141
    v_lshlrev_b32_e64 v134, 16, v142
    v_and_b32 v142, 0xffff0000, v142
    v_lshlrev_b32_e64 v135, 16, v143
    s_setprio 2
    s_waitcnt lgkmcnt(0)
    v_mfma_f32_16x16x32_bf16 v[0:3], a[64:67], a[80:83], v[0:3]
    v_mfma_f32_16x16x32_bf16 v[4:7], a[64:67], a[84:87], v[4:7]
    ds_read_b64_tr_b16 a[72:73], v100 offset:41472
    ds_read_b64_tr_b16 a[74:75], v100 offset:41984
    ds_read_b64_tr_b16 a[76:77], v100 offset:49664
    ds_read_b64_tr_b16 a[78:79], v100 offset:50176
    v_mfma_f32_16x16x32_bf16 v[16:19], a[64:67], a[88:91], v[16:19]
    v_mfma_f32_16x16x32_bf16 v[20:23], a[64:67], a[92:95], v[20:23]
    ds_read_b128 a[96:99], v97 offset:16384
    ds_read_b128 a[100:103], v97 offset:18432
    buffer_load_dwordx4 v106, s[28:31], s4 offen offset:2048 lds
    v_mfma_f32_16x16x32_bf16 v[8:11], a[68:71], a[80:83], v[8:11]
    v_mfma_f32_16x16x32_bf16 v[12:15], a[68:71], a[84:87], v[12:15]
    buffer_load_dwordx4 v107, s[28:31], s4 offen offset:3072 lds
    v_mfma_f32_16x16x32_bf16 v[24:27], a[68:71], a[88:91], v[24:27]
    v_mfma_f32_16x16x32_bf16 v[28:31], a[68:71], a[92:95], v[28:31]
    s_setprio 0
    v_and_b32 v143, 0xffff0000, v143
    v_add_f32 v125, v128, v136
    v_add_f32 v124, v129, v137
    v_add_f32 v125, v125, v130
    v_add_f32 v124, v124, v138
    v_add_f32 v125, v125, v131
    v_add_f32 v124, v124, v139
    v_add_f32 v125, v125, v132
    v_add_f32 v124, v124, v140
    v_add_f32 v125, v125, v133
    v_add_f32 v124, v124, v141
    v_add_f32 v125, v125, v134
    v_add_f32 v124, v124, v142
    v_add_f32 v125, v125, v135
    v_add_f32 v124, v124, v143
    v_add_f32 v125, v125, v124
    s_setprio 2
    s_waitcnt lgkmcnt(0)
    v_mfma_f32_16x16x32_bf16 v[32:35], a[72:75], a[80:83], v[32:35]
    v_mfma_f32_16x16x32_bf16 v[36:39], a[72:75], a[84:87], v[36:39]
    ds_read_b64_tr_b16 a[64:65], v98 offset:43520
    ds_read_b64_tr_b16 a[66:67], v98 offset:43776
    ds_read_b64_tr_b16 a[68:69], v99 offset:43520
    ds_read_b64_tr_b16 a[70:71], v99 offset:43776
    v_mfma_f32_16x16x32_bf16 v[48:51], a[72:75], a[88:91], v[48:51]
    v_mfma_f32_16x16x32_bf16 v[52:55], a[72:75], a[92:95], v[52:55]
    ds_read_b128 a[104:107], v97 offset:20480
    ds_read_b128 a[108:111], v97 offset:22528
    s_add_u32 s76, s76, 1
    s_cmp_eq_u32 s76, 7
    s_cselect_b32 s76, 0, s76
    s_add_u32 m0, s10, 8192
    s_lshl_b32 s4, s76, 7
    s_add_u32 s4, s4, s77
    s_nop 0
    buffer_load_dwordx4 v104, s[28:31], s4 offen offset:0 lds
    v_mfma_f32_16x16x32_bf16 v[40:43], a[76:79], a[80:83], v[40:43]
    v_mfma_f32_16x16x32_bf16 v[44:47], a[76:79], a[84:87], v[44:47]
    buffer_load_dwordx4 v105, s[28:31], s4 offen offset:1024 lds
    v_mfma_f32_16x16x32_bf16 v[56:59], a[76:79], a[88:91], v[56:59]
    v_mfma_f32_16x16x32_bf16 v[60:63], a[76:79], a[92:95], v[60:63]
    s_setprio 0
    s_nop 1
    v_add_f32_dpp v125, v125, v125 quad_perm:[1,0,3,2] row_mask:0xf bank_mask:0xf
    s_nop 1
    v_add_f32_dpp v125, v125, v125 quad_perm:[2,3,0,1] row_mask:0xf bank_mask:0xf
    s_nop 1
    v_add_f32_dpp v125, v125, v125 row_half_mirror row_mask:0xf bank_mask:0xf
    s_nop 1
    v_add_f32_dpp v125, v125, v125 row_mirror row_mask:0xf bank_mask:0xf
    v_mov_b32 v127, v125
    s_nop 1
    v_permlane16_swap_b32 v125, v127
    v_add_f32_e64 v125, v125, v127
    v_mul_f32 v125, 0xbb124925, v125
    v_add_f32 v128, v128, v125
    v_add_f32 v136, v136, v125
    v_add_f32_e64 v129, v129, v125
    s_setprio 2
    s_waitcnt lgkmcnt(0)
    v_mfma_f32_16x16x32_bf16 v[0:3], a[64:67], a[96:99], v[0:3]
    v_mfma_f32_16x16x32_bf16 v[4:7], a[64:67], a[100:103], v[4:7]
    ds_read_b64_tr_b16 a[72:73], v100 offset:45568
    ds_read_b64_tr_b16 a[74:75], v100 offset:46080
    ds_read_b64_tr_b16 a[76:77], v100 offset:53760
    ds_read_b64_tr_b16 a[78:79], v100 offset:54272
    v_mfma_f32_16x16x32_bf16 v[16:19], a[64:67], a[104:107], v[16:19]
    v_mfma_f32_16x16x32_bf16 v[20:23], a[64:67], a[108:111], v[20:23]
    buffer_load_dwordx4 v106, s[28:31], s4 offen offset:2048 lds
    v_mfma_f32_16x16x32_bf16 v[8:11], a[68:71], a[96:99], v[8:11]
    v_mfma_f32_16x16x32_bf16 v[12:15], a[68:71], a[100:103], v[12:15]
    buffer_load_dwordx4 v107, s[28:31], s4 offen offset:3072 lds
    v_mfma_f32_16x16x32_bf16 v[24:27], a[68:71], a[104:107], v[24:27]
    v_mfma_f32_16x16x32_bf16 v[28:31], a[68:71], a[108:111], v[28:31]
    s_setprio 0
    v_add_f32 v137, v137, v125
    v_add_f32 v130, v130, v125
    v_add_f32 v138, v138, v125
    v_add_f32 v131, v131, v125
    v_add_f32 v139, v139, v125
    v_add_f32 v132, v132, v125
    v_add_f32 v140, v140, v125
    v_add_f32 v133, v133, v125
    v_add_f32 v141, v141, v125
    v_add_f32 v134, v134, v125
    v_add_f32 v142, v142, v125
    v_add_f32 v135, v135, v125
    v_add_f32 v143, v143, v125
    v_mul_f32 v124, v128, v128
    v_mul_f32 v126, v136, v136
    v_fmac_f32_e64 v124, v129, v129
    s_setprio 2
    s_waitcnt lgkmcnt(0)
    v_mfma_f32_16x16x32_bf16 v[32:35], a[72:75], a[96:99], v[32:35]
    v_mfma_f32_16x16x32_bf16 v[36:39], a[72:75], a[100:103], v[36:39]
    s_waitcnt vmcnt(4)
    s_barrier
    ds_read_b64_tr_b16 a[64:65], v98 offset:0
    ds_read_b64_tr_b16 a[66:67], v98 offset:256
    ds_read_b128 a[80:83], v96 offset:0
    ds_read_b128 a[84:87], v96 offset:2048
    v_mfma_f32_16x16x32_bf16 v[48:51], a[72:75], a[104:107], v[48:51]
    v_mfma_f32_16x16x32_bf16 v[52:55], a[72:75], a[108:111], v[52:55]
    ds_read_b128 a[88:91], v96 offset:4096
    ds_read_b128 a[92:95], v96 offset:6144
    ds_read_b64_tr_b16 a[68:69], v99 offset:0
    ds_read_b64_tr_b16 a[70:71], v99 offset:256
    s_add_u32 m0, s10, 12288
    s_add_u32 s4, s4, 28672
    buffer_load_dwordx4 v104, s[28:31], s4 offen offset:0 lds
    v_mfma_f32_16x16x32_bf16 v[40:43], a[76:79], a[96:99], v[40:43]
    v_mfma_f32_16x16x32_bf16 v[44:47], a[76:79], a[100:103], v[44:47]
    buffer_load_dwordx4 v105, s[28:31], s4 offen offset:1024 lds
    v_mfma_f32_16x16x32_bf16 v[56:59], a[76:79], a[104:107], v[56:59]
    v_mfma_f32_16x16x32_bf16 v[60:63], a[76:79], a[108:111], v[60:63]
    s_setprio 0
    s_mov_b32 s62, 256
    s_mov_b32 s63, 0x20000
    v_lshlrev_b32 v116, 3, v112
    buffer_load_dword v115, v116, s[60:63], 0 offen sc1
    v_fmac_f32 v126, v137, v137
    v_fmac_f32 v124, v130, v130
    v_fmac_f32 v126, v138, v138
    v_fmac_f32 v124, v131, v131
    v_fmac_f32 v126, v139, v139
    v_fmac_f32 v124, v132, v132
    v_fmac_f32 v126, v140, v140
    v_fmac_f32 v124, v133, v133
    v_fmac_f32 v126, v141, v141
    v_fmac_f32 v124, v134, v134
    s_setprio 2
    s_waitcnt lgkmcnt(0)
    v_mfma_f32_16x16x32_bf16 v[0:3], a[64:67], a[80:83], v[0:3]
    v_mfma_f32_16x16x32_bf16 v[4:7], a[64:67], a[84:87], v[4:7]
    ds_read_b64_tr_b16 a[72:73], v100 offset:0
    ds_read_b64_tr_b16 a[74:75], v100 offset:512
    ds_read_b64_tr_b16 a[76:77], v100 offset:8192
    ds_read_b64_tr_b16 a[78:79], v100 offset:8704
    v_mfma_f32_16x16x32_bf16 v[16:19], a[64:67], a[88:91], v[16:19]
    v_mfma_f32_16x16x32_bf16 v[20:23], a[64:67], a[92:95], v[20:23]
    ds_read_b128 a[96:99], v97 offset:0
    ds_read_b128 a[100:103], v97 offset:2048
    buffer_load_dwordx4 v106, s[28:31], s4 offen offset:2048 lds
    v_mfma_f32_16x16x32_bf16 v[8:11], a[68:71], a[80:83], v[8:11]
    v_mfma_f32_16x16x32_bf16 v[12:15], a[68:71], a[84:87], v[12:15]
    buffer_load_dwordx4 v107, s[28:31], s4 offen offset:3072 lds
    v_mfma_f32_16x16x32_bf16 v[24:27], a[68:71], a[88:91], v[24:27]
    v_mfma_f32_16x16x32_bf16 v[28:31], a[68:71], a[92:95], v[28:31]
    s_setprio 0
    v_fmac_f32 v126, v142, v142
    v_fmac_f32 v124, v135, v135
    v_fmac_f32 v126, v143, v143
    s_mov_b32 vcc_lo, 0xf0000000
    s_mov_b32 vcc_hi, 0xf0000000
    v_add_f32_e64 v126, v126, v124
    v_cndmask_b32 v126, v126, 0, vcc
    s_nop 1
    v_add_f32_dpp v126, v126, v126 quad_perm:[1,0,3,2] row_mask:0xf bank_mask:0xf
    s_nop 1
    v_add_f32_dpp v126, v126, v126 quad_perm:[2,3,0,1] row_mask:0xf bank_mask:0xf
    s_nop 1
    v_add_f32_dpp v126, v126, v126 row_half_mirror row_mask:0xf bank_mask:0xf
    s_nop 1
    v_add_f32_dpp v126, v126, v126 row_mirror row_mask:0xf bank_mask:0xf
    v_mov_b32_e64 v127, v126
    s_setprio 2
    s_waitcnt lgkmcnt(0)
    v_mfma_f32_16x16x32_bf16 v[32:35], a[72:75], a[80:83], v[32:35]
    v_mfma_f32_16x16x32_bf16 v[36:39], a[72:75], a[84:87], v[36:39]
    ds_read_b64_tr_b16 a[64:65], v98 offset:2048
    ds_read_b64_tr_b16 a[66:67], v98 offset:2304
    ds_read_b64_tr_b16 a[68:69], v99 offset:2048
    ds_read_b64_tr_b16 a[70:71], v99 offset:2304
    v_mfma_f32_16x16x32_bf16 v[48:51], a[72:75], a[88:91], v[48:51]
    v_mfma_f32_16x16x32_bf16 v[52:55], a[72:75], a[92:95], v[52:55]
    ds_read_b128 a[104:107], v97 offset:4096
    ds_read_b128 a[108:111], v97 offset:6144
    s_add_u32 s76, s76, 1
    s_cmp_eq_u32 s76, 7
    s_cselect_b32 s76, 0, s76
    s_add_u32 m0, s10, 16384
    s_lshl_b32 s4, s76, 7
    s_add_u32 s4, s4, s77
    s_nop 0
    buffer_load_dwordx4 v104, s[28:31], s4 offen offset:0 lds
    v_mfma_f32_16x16x32_bf16 v[40:43], a[76:79], a[80:83], v[40:43]
    v_mfma_f32_16x16x32_bf16 v[44:47], a[76:79], a[84:87], v[44:47]
    buffer_load_dwordx4 v105, s[28:31], s4 offen offset:1024 lds
    v_mfma_f32_16x16x32_bf16 v[56:59], a[76:79], a[88:91], v[56:59]
    v_mfma_f32_16x16x32_bf16 v[60:63], a[76:79], a[92:95], v[60:63]
    s_setprio 0
    s_nop 1
    v_permlane16_swap_b32 v126, v127
    v_add_f32 v126, v126, v127
    v_mov_b32 v124, 0x3727c5ac
    v_fmac_f32 v124, 0x3b124925, v126
    buffer_store_dwordx2 v[124:125], v110, s[52:55], s15 offen sc1
    s_setprio 2
    s_waitcnt lgkmcnt(0)
    v_mfma_f32_16x16x32_bf16 v[0:3], a[64:67], a[96:99], v[0:3]
    v_mfma_f32_16x16x32_bf16 v[4:7], a[64:67], a[100:103], v[4:7]
    ds_read_b64_tr_b16 a[72:73], v100 offset:4096
    ds_read_b64_tr_b16 a[74:75], v100 offset:4608
    ds_read_b64_tr_b16 a[76:77], v100 offset:12288
    ds_read_b64_tr_b16 a[78:79], v100 offset:12800
    v_mfma_f32_16x16x32_bf16 v[16:19], a[64:67], a[104:107], v[16:19]
    v_mfma_f32_16x16x32_bf16 v[20:23], a[64:67], a[108:111], v[20:23]
    buffer_load_dwordx4 v106, s[28:31], s4 offen offset:2048 lds
    v_mfma_f32_16x16x32_bf16 v[8:11], a[68:71], a[96:99], v[8:11]
    v_mfma_f32_16x16x32_bf16 v[12:15], a[68:71], a[100:103], v[12:15]
    buffer_load_dwordx4 v107, s[28:31], s4 offen offset:3072 lds
    v_mfma_f32_16x16x32_bf16 v[24:27], a[68:71], a[104:107], v[24:27]
    v_mfma_f32_16x16x32_bf16 v[28:31], a[68:71], a[108:111], v[28:31]
    s_waitcnt lgkmcnt(0)
    v_mfma_f32_16x16x32_bf16 v[32:35], a[72:75], a[96:99], v[32:35]
    v_mfma_f32_16x16x32_bf16 v[36:39], a[72:75], a[100:103], v[36:39]
    s_waitcnt vmcnt(2)
    v_cmp_gt_u32 vcc, 16, v115
    s_and_b32 s3, vcc_lo, 3
    s_cbranch_scc1 L_in_13f
L_in_13b:
    s_barrier
    ds_read_b64_tr_b16 a[64:65], v98 offset:20736
    ds_read_b64_tr_b16 a[66:67], v98 offset:20992
    ds_read_b128 a[80:83], v96 offset:8192
    ds_read_b128 a[84:87], v96 offset:10240
    v_mfma_f32_16x16x32_bf16 v[48:51], a[72:75], a[104:107], v[48:51]
    v_mfma_f32_16x16x32_bf16 v[52:55], a[72:75], a[108:111], v[52:55]
    ds_read_b128 a[88:91], v96 offset:12288
    ds_read_b128 a[92:95], v96 offset:14336
    ds_read_b64_tr_b16 a[68:69], v99 offset:20736
    ds_read_b64_tr_b16 a[70:71], v99 offset:20992
    s_add_u32 m0, s10, 20480
    s_add_u32 s4, s4, 28672
    buffer_load_dwordx4 v104, s[28:31], s4 offen offset:0 lds
    ds_read_b32 a2, v112
    ds_read_b32 a3, v112
    v_mfma_f32_16x16x32_bf16 v[40:43], a[76:79], a[96:99], v[40:43]
    v_mfma_f32_16x16x32_bf16 v[44:47], a[76:79], a[100:103], v[44:47]
    buffer_load_dwordx4 v105, s[28:31], s4 offen offset:1024 lds
    v_mfma_f32_16x16x32_bf16 v[56:59], a[76:79], a[104:107], v[56:59]
    s_nop 0
    v_mfma_f32_16x16x32_bf16 v[60:63], a[76:79], a[108:111], v[60:63]
    s_setprio 0
    s_mul_i32 s3, s75, 2048
    s_add_u32 s14, s3, 13632384
    s_cmp_lg_u32 s26, 0
    s_cbranch_scc1 L_pb_14
    s_lshl_b32 s3, s27, 2
    s_add_u32 s3, s3, s72
    s_mul_i32 s3, s3, 2048
    s_add_u32 s6, s3, 13631872
    s_mov_b32 s42, 1
    s_atomic_add s42, s[52:53], s6
    s_mov_b32 s42, 1
    s_atomic_add s42, s[52:53], s14
L_pb_14:
    s_mov_b32 s46, 1605632
    s_mov_b32 s47, 0x20000
    s_mov_b32 s50, 401408
    s_mov_b32 s51, 0x20000
    s_mov_b32 s58, 1835008
    s_mov_b32 s59, 0x20000
    s_and_b32 s20, s2, 7
    s_lshl_b32 s20, s20, 2
    s_bfe_u32 s21, s2, 0x20003
    s_or_b32 s20, s20, s21
    s_lshr_b32 s21, s2, 5
    s_lshl_b32 s22, s21, 7
    s_mul_i32 s3, s26, 401408
    s_add_u32 s22, s22, s3
    v_lshrrev_b32_e64 v128, 4, v112
    s_setprio 2
    s_waitcnt lgkmcnt(2)
    v_mfma_f32_16x16x32_bf16 v[0:3], a[64:67], a[80:83], v[0:3]
    v_mfma_f32_16x16x32_bf16 v[4:7], a[64:67], a[84:87], v[4:7]
    ds_read_b64_tr_b16 a[72:73], v100 offset:20736
    ds_read_b64_tr_b16 a[74:75], v100 offset:21248
    ds_read_b64_tr_b16 a[76:77], v100 offset:28928
    ds_read_b64_tr_b16 a[78:79], v100 offset:29440
    v_mfma_f32_16x16x32_bf16 v[16:19], a[64:67], a[88:91], v[16:19]
    v_mfma_f32_16x16x32_bf16 v[20:23], a[64:67], a[92:95], v[20:23]
    ds_read_b128 a[96:99], v97 offset:8192
    ds_read_b128 a[100:103], v97 offset:10240
    buffer_load_dwordx4 v106, s[28:31], s4 offen offset:2048 lds
    ds_read_b32 a2, v112
    ds_read_b32 a3, v112
    v_mfma_f32_16x16x32_bf16 v[8:11], a[68:71], a[80:83], v[8:11]
    v_mfma_f32_16x16x32_bf16 v[12:15], a[68:71], a[84:87], v[12:15]
    buffer_load_dwordx4 v107, s[28:31], s4 offen offset:3072 lds
    v_mfma_f32_16x16x32_bf16 v[24:27], a[68:71], a[88:91], v[24:27]
    v_mfma_f32_16x16x32_bf16 v[28:31], a[68:71], a[92:95], v[28:31]
    s_setprio 0
    v_lshrrev_b32 v129, 3, v128
    v_mul_u32_u24 v130, 896, v129
    v_and_b32 v129, 2, v129
    v_lshlrev_b32 v129, 1, v129
    v_and_b32 v131, 7, v128
    v_xor_b32 v129, v129, v131
    v_lshl_add_u32 v119, v129, 4, v130
    s_cmp_eq_u32 s21, 7
    s_cselect_b32 s3, 1073741824, 0
    v_add_u32_e64 v119, s3, v119
    v_add_u32 v120, 6144, v119
    v_add_u32 v121, 12288, v119
    v_add_u32 v122, 18432, v119
    v_bfe_u32 v129, v128, 2, 2
    v_lshrrev_b32_e64 v130, 5, v128
    v_lshl_add_u32 v130, v130, 3, v129
    s_setprio 2
    s_waitcnt lgkmcnt(2)
    v_mfma_f32_16x16x32_bf16 v[32:35], a[72:75], a[80:83], v[32:35]
    v_mfma_f32_16x16x32_bf16 v[36:39], a[72:75], a[84:87], v[36:39]
    ds_read_b64_tr_b16 a[64:65], v98 offset:22784
    ds_read_b64_tr_b16 a[66:67], v98 offset:23040
    ds_read_b64_tr_b16 a[68:69], v99 offset:22784
    ds_read_b64_tr_b16 a[70:71], v99 offset:23040
    v_mfma_f32_16x16x32_bf16 v[48:51], a[72:75], a[88:91], v[48:51]
    v_mfma_f32_16x16x32_bf16 v[52:55], a[72:75], a[92:95], v[52:55]
    ds_read_b128 a[104:107], v97 offset:12288
    ds_read_b128 a[108:111], v97 offset:14336
    s_add_u32 s76, s76, 1
    s_cmp_eq_u32 s76, 7
    s_cselect_b32 s76, 0, s76
    s_add_u32 m0, s10, 0
    s_lshl_b32 s4, s76, 7
    s_add_u32 s4, s4, s77
    buffer_load_dwordx4 v104, s[28:31], s4 offen offset:0 lds
    ds_read_b32 a2, v112
    ds_read_b32 a3, v112
    v_mfma_f32_16x16x32_bf16 v[40:43], a[76:79], a[80:83], v[40:43]
    v_mfma_f32_16x16x32_bf16 v[44:47], a[76:79], a[84:87], v[44:47]
    buffer_load_dwordx4 v105, s[28:31], s4 offen offset:1024 lds
    v_mfma_f32_16x16x32_bf16 v[56:59], a[76:79], a[88:91], v[56:59]
    v_mfma_f32_16x16x32_bf16 v[60:63], a[76:79], a[92:95], v[60:63]
    s_setprio 0
    v_bfe_u32 v131, v128, 4, 1
    v_and_b32 v132, 3, v128
    v_lshl_add_u32 v131, v131, 2, v132
    v_lshlrev_b32_e64 v132, 7, v130
    v_lshl_add_u32 v132, v131, 3, v132
    v_add_u32 v132, s10, v132
    v_lshrrev_b32 v129, 1, v129
    v_lshl_add_u32 v117, v129, 6, v132
    v_xor_b32_e64 v129, 1, v129
    v_lshl_add_u32 v118, v129, 6, v132
    v_mul_u32_u24_e64 v130, 56, v130
    v_min_u32 v131, 6, v131
    v_lshl_add_u32 v130, v131, 3, v130
    v_add_u32 v123, 161792, v130
    s_and_b32 s3, s2, 7
    s_lshl_b32 s3, s3, 2
    s_lshr_b32 s43, 0x6543210, s3
    s_sub_u32 s3, 28, s3
    s_lshl_b32 s3, 0x6543210, s3
    s_or_b32 s43, s43, s3
    s_lshl_b32 s35, s20, 2
    s_add_u32 s34, s35, s26
    s_mul_i32 s34, s34, 512
    s_add_u32 s34, s34, 13631488
    s_lshl_b32 s35, s35, 1
    s_add_u32 s35, s35, s26
    s_mul_i32 s35, s35, 7168
    s_lshl_b32 s36, s21, 7
    s_add_u32 s35, s35, s36
    s_mul_i32 s37, s20, 294912
    s_mul_i32 s33, s26, 57344
    s_add_u32 s33, s33, s37
    s_mul_i32 s40, s26, 14336
    s_add_u32 s40, s40, 98304
    s_mul_i32 s41, s26, -301056
    s_add_u32 s41, s41, s22
    s_add_u32 s22, s22, 200704
    s_add_u32 s33, s33, 28672
    s_lshl_b32 s36, s26, 14
    s_add_u32 s37, s37, s36
    s_add_u32 s37, s37, 229376
    s_lshl_b32 s39, s74, 2
    s_add_u32 s39, s39, s26
    s_andn2_b32 s3, s39, 1
    s_add_u32 s39, s39, s3
    s_mul_i32 s39, s39, 512
    s_add_u32 s39, s39, 13632896
    s_lshl_b32 s38, s74, 2
    s_add_u32 s38, s38, s26
    s_lshl_b32 s38, s38, 13
    s_add_u32 s38, s38, 10485760
    s_setprio 2
    s_waitcnt lgkmcnt(2)
    v_mfma_f32_16x16x32_bf16 v[0:3], a[64:67], a[96:99], v[0:3]
    v_mfma_f32_16x16x32_bf16 v[4:7], a[64:67], a[100:103], v[4:7]
    ds_read_b64_tr_b16 a[72:73], v100 offset:24832
    ds_read_b64_tr_b16 a[74:75], v100 offset:25344
    ds_read_b64_tr_b16 a[76:77], v100 offset:33024
    ds_read_b64_tr_b16 a[78:79], v100 offset:33536
    v_mfma_f32_16x16x32_bf16 v[16:19], a[64:67], a[104:107], v[16:19]
    v_mfma_f32_16x16x32_bf16 v[20:23], a[64:67], a[108:111], v[20:23]
    buffer_load_dwordx4 v106, s[28:31], s4 offen offset:2048 lds
    v_mfma_f32_16x16x32_bf16 v[8:11], a[68:71], a[96:99], v[8:11]
    v_mfma_f32_16x16x32_bf16 v[12:15], a[68:71], a[100:103], v[12:15]
    buffer_load_dwordx4 v107, s[28:31], s4 offen offset:3072 lds
    v_mfma_f32_16x16x32_bf16 v[24:27], a[68:71], a[104:107], v[24:27]
    v_mfma_f32_16x16x32_bf16 v[28:31], a[68:71], a[108:111], v[28:31]
    s_waitcnt lgkmcnt(0)
    s_nop 0
    v_mfma_f32_16x16x32_bf16 v[32:35], a[72:75], a[96:99], v[32:35]
    v_mfma_f32_16x16x32_bf16 v[36:39], a[72:75], a[100:103], v[36:39]
    s_waitcnt vmcnt(4)
    s_barrier
    ds_read_b64_tr_b16 a[64:65], v98 offset:41472
    ds_read_b64_tr_b16 a[66:67], v98 offset:41728
    ds_read_b128 a[80:83], v96 offset:16384
    ds_read_b128 a[84:87], v96 offset:18432
    v_mfma_f32_16x16x32_bf16 v[48:51], a[72:75], a[104:107], v[48:51]
    v_mfma_f32_16x16x32_bf16 v[52:55], a[72:75], a[108:111], v[52:55]
    ds_read_b128 a[88:91], v96 offset:20480
    ds_read_b128 a[92:95], v96 offset:22528
    ds_read_b64_tr_b16 a[68:69], v99 offset:41472
    ds_read_b64_tr_b16 a[70:71], v99 offset:41728
    s_add_u32 m0, s10, 4096
    s_add_u32 s4, s4, 28672
    buffer_load_dwordx4 v104, s[28:31], s4 offen offset:0 lds
    v_mfma_f32_16x16x32_bf16 v[40:43], a[76:79], a[96:99], v[40:43]
    v_mfma_f32_16x16x32_bf16 v[44:47], a[76:79], a[100:103], v[44:47]
    ds_read_b64_tr_b16 v[88:89], v123 offset:0
    ds_read_b64_tr_b16 v[90:91], v123 offset:224
    ds_read_b64_tr_b16 v[92:93], v123 offset:896
    ds_read_b64_tr_b16 v[94:95], v123 offset:1120
    buffer_load_dwordx4 v105, s[28:31], s4 offen offset:1024 lds
    v_mfma_f32_16x16x32_bf16 v[56:59], a[76:79], a[104:107], v[56:59]
    v_mfma_f32_16x16x32_bf16 v[60:63], a[76:79], a[108:111], v[60:63]
    s_waitcnt lgkmcnt(0)
    s_nop 0
    v_mfma_f32_16x16x32_bf16 v[0:3], a[64:67], a[80:83], v[0:3]
    v_mfma_f32_16x16x32_bf16 v[4:7], a[64:67], a[84:87], v[4:7]
    ds_read_b64_tr_b16 a[72:73], v100 offset:41472
    ds_read_b64_tr_b16 a[74:75], v100 offset:41984
    ds_read_b64_tr_b16 a[76:77], v100 offset:49664
    ds_read_b64_tr_b16 a[78:79], v100 offset:50176
    v_mfma_f32_16x16x32_bf16 v[16:19], a[64:67], a[88:91], v[16:19]
    v_mfma_f32_16x16x32_bf16 v[20:23], a[64:67], a[92:95], v[20:23]
    ds_read_b128 a[96:99], v97 offset:16384
    ds_read_b128 a[100:103], v97 offset:18432
    buffer_load_dwordx4 v106, s[28:31], s4 offen offset:2048 lds
    v_mfma_f32_16x16x32_bf16 v[8:11], a[68:71], a[80:83], v[8:11]
    v_mfma_f32_16x16x32_bf16 v[12:15], a[68:71], a[84:87], v[12:15]
    buffer_load_dwordx4 v107, s[28:31], s4 offen offset:3072 lds
    v_mfma_f32_16x16x32_bf16 v[24:27], a[68:71], a[88:91], v[24:27]
    v_mfma_f32_16x16x32_bf16 v[28:31], a[68:71], a[92:95], v[28:31]
    s_setprio 0
    s_nop 0
    v_mov_b32_dpp v88, v88 quad_perm:[2,3,2,3] row_mask:0xa bank_mask:0x8
    v_mov_b32_dpp v89, v89 quad_perm:[2,3,2,3] row_mask:0xa bank_mask:0x8
    v_mov_b32_dpp v90, v90 quad_perm:[2,3,2,3] row_mask:0xa bank_mask:0x8
    v_mov_b32_dpp v91, v91 quad_perm:[2,3,2,3] row_mask:0xa bank_mask:0x8
    v_mov_b32_dpp v92, v92 quad_perm:[2,3,2,3] row_mask:0xa bank_mask:0x8
    v_mov_b32_dpp v93, v93 quad_perm:[2,3,2,3] row_mask:0xa bank_mask:0x8
    v_mov_b32_dpp v94, v94 quad_perm:[2,3,2,3] row_mask:0xa bank_mask:0x8
    v_mov_b32_dpp v95, v95 quad_perm:[2,3,2,3] row_mask:0xa bank_mask:0x8
    v_cndmask_b32 v94, v94, 0, s[18:19]
    v_cndmask_b32 v95, v95, 0, s[18:19]
    s_setprio 2
    s_waitcnt lgkmcnt(0)
    v_mfma_f32_16x16x32_bf16 v[32:35], a[72:75], a[80:83], v[32:35]
    v_mfma_f32_16x16x32_bf16 v[36:39], a[72:75], a[84:87], v[36:39]
    ds_read_b64_tr_b16 a[64:65], v98 offset:43520
    ds_read_b64_tr_b16 a[66:67], v98 offset:43776
    ds_read_b64_tr_b16 a[68:69], v99 offset:43520
    ds_read_b64_tr_b16 a[70:71], v99 offset:43776
    v_mfma_f32_16x16x32_bf16 v[48:51], a[72:75], a[88:91], v[48:51]
    v_mfma_f32_16x16x32_bf16 v[52:55], a[72:75], a[92:95], v[52:55]
    ds_read_b128 a[104:107], v97 offset:20480
    ds_read_b128 a[108:111], v97 offset:22528
    v_mfma_f32_16x16x32_bf16 v[40:43], a[76:79], a[80:83], v[40:43]
    v_mfma_f32_16x16x32_bf16 v[44:47], a[76:79], a[84:87], v[44:47]
    v_mfma_f32_16x16x32_bf16 v[56:59], a[76:79], a[88:91], v[56:59]
    v_mfma_f32_16x16x32_bf16 v[60:63], a[76:79], a[92:95], v[60:63]
    s_waitcnt lgkmcnt(0)
    s_nop 0
    v_mfma_f32_16x16x32_bf16 v[0:3], a[64:67], a[96:99], v[0:3]
    v_mfma_f32_16x16x32_bf16 v[4:7], a[64:67], a[100:103], v[4:7]
    ds_read_b64_tr_b16 a[72:73], v100 offset:45568
    ds_read_b64_tr_b16 a[74:75], v100 offset:46080
    ds_read_b64_tr_b16 a[76:77], v100 offset:53760
    ds_read_b64_tr_b16 a[78:79], v100 offset:54272
    s_lshl_b32 s3, s27, 2
    s_add_u32 s3, s3, s26
    s_mul_i32 s3, s3, 2048
    s_add_u32 s6, s3, 13631872
    s_load_dword s68, s[52:53], s6
    s_load_dword s69, s[52:53], s14
    ds_read_b32 a2, v112
    ds_read_b32 a3, v112
    v_mfma_f32_16x16x32_bf16 v[16:19], a[64:67], a[104:107], v[16:19]
    v_mfma_f32_16x16x32_bf16 v[20:23], a[64:67], a[108:111], v[20:23]
    v_mfma_f32_16x16x32_bf16 v[8:11], a[68:71], a[96:99], v[8:11]
    v_mfma_f32_16x16x32_bf16 v[12:15], a[68:71], a[100:103], v[12:15]
    v_mfma_f32_16x16x32_bf16 v[24:27], a[68:71], a[104:107], v[24:27]
    v_mfma_f32_16x16x32_bf16 v[28:31], a[68:71], a[108:111], v[28:31]
    s_waitcnt lgkmcnt(2)
    s_nop 0
    v_mfma_f32_16x16x32_bf16 v[32:35], a[72:75], a[96:99], v[32:35]
    v_mfma_f32_16x16x32_bf16 v[36:39], a[72:75], a[100:103], v[36:39]
    s_waitcnt lgkmcnt(0)
    s_min_u32 s3, s68, s69
    s_cmp_lt_u32 s3, 8
    s_cbranch_scc1 L_sc_15f
L_sc_15b:
    s_waitcnt vmcnt(0)
    s_barrier
    ds_read_b64_tr_b16 a[64:65], v98 offset:0
    ds_read_b64_tr_b16 a[66:67], v98 offset:256
    ds_read_b128 a[80:83], v96 offset:0
    ds_read_b128 a[84:87], v96 offset:2048
    v_mfma_f32_16x16x32_bf16 v[48:51], a[72:75], a[104:107], v[48:51]
    v_mfma_f32_16x16x32_bf16 v[52:55], a[72:75], a[108:111], v[52:55]
    ds_read_b128 a[88:91], v96 offset:4096
    ds_read_b128 a[92:95], v96 offset:6144
    ds_read_b64_tr_b16 a[68:69], v99 offset:0
    ds_read_b64_tr_b16 a[70:71], v99 offset:256
    v_mfma_f32_16x16x32_bf16 v[40:43], a[76:79], a[96:99], v[40:43]
    v_mfma_f32_16x16x32_bf16 v[44:47], a[76:79], a[100:103], v[44:47]
    v_mfma_f32_16x16x32_bf16 v[56:59], a[76:79], a[104:107], v[56:59]
    v_mfma_f32_16x16x32_bf16 v[60:63], a[76:79], a[108:111], v[60:63]
    s_setprio 0
    v_and_b32 v116, 0xf0, v112
    v_lshlrev_b32 v116, 1, v116
    s_lshl_b32 s15, s27, 2
    s_add_u32 s15, s15, s26
    s_lshl_b32 s15, s15, 9
    s_add_u32 s15, s15, 12582912
    v_lshrrev_b32 v115, 9, v112
    v_mul_u32_u24 v115, 2560, v115
    v_bfe_u32 v113, v112, 2, 7
    v_add_u32 v113, v113, v115
    s_movk_i32 s3, 512
    s_cmp_lg_u32 s26, 0
    s_cselect_b32 s3, 1073741824, s3
    v_add_u32 v115, s3, v113
    s_mul_i32 s8, s75, 40
    s_add_u32 s8, s8, s26
    s_lshl_b32 s8, s8, 7
    s_add_u32 s8, s8, 12615680
    buffer_load_dwordx4 v[124:127], v116, s[52:55], s15 offen offset:0 sc1
    buffer_load_dwordx4 v[108:111], v116, s[52:55], s15 offen offset:16 sc1
    buffer_load_dword v64, v113, s[52:55], s8 offen offset:0 sc1
    buffer_load_dword v65, v113, s[52:55], s8 offen offset:640 sc1
    buffer_load_dword v66, v113, s[52:55], s8 offen offset:1280 sc1
    buffer_load_dword v67, v113, s[52:55], s8 offen offset:1920 sc1
    buffer_load_dword v68, v115, s[52:55], s8 offen offset:0 sc1
    buffer_load_dword v69, v115, s[52:55], s8 offen offset:640 sc1
    buffer_load_dword v70, v115, s[52:55], s8 offen offset:1280 sc1
    buffer_load_dword v71, v115, s[52:55], s8 offen offset:1920 sc1
    s_setprio 2
    s_waitcnt lgkmcnt(0)
    v_mfma_f32_16x16x32_bf16 v[0:3], a[64:67], a[80:83], v[0:3]
    v_mfma_f32_16x16x32_bf16 v[4:7], a[64:67], a[84:87], v[4:7]
    ds_read_b64_tr_b16 a[72:73], v100 offset:0
    ds_read_b64_tr_b16 a[74:75], v100 offset:512
    ds_read_b64_tr_b16 a[76:77], v100 offset:8192
    ds_read_b64_tr_b16 a[78:79], v100 offset:8704
    v_mfma_f32_16x16x32_bf16 v[16:19], a[64:67], a[88:91], v[16:19]
    v_mfma_f32_16x16x32_bf16 v[20:23], a[64:67], a[92:95], v[20:23]
    ds_read_b128 a[96:99], v97 offset:0
    ds_read_b128 a[100:103], v97 offset:2048
    v_mfma_f32_16x16x32_bf16 v[8:11], a[68:71], a[80:83], v[8:11]
    v_mfma_f32_16x16x32_bf16 v[12:15], a[68:71], a[84:87], v[12:15]
    v_mfma_f32_16x16x32_bf16 v[24:27], a[68:71], a[88:91], v[24:27]
    v_mfma_f32_16x16x32_bf16 v[28:31], a[68:71], a[92:95], v[28:31]
    s_waitcnt lgkmcnt(0)
    s_nop 0
    v_mfma_f32_16x16x32_bf16 v[32:35], a[72:75], a[80:83], v[32:35]
    v_mfma_f32_16x16x32_bf16 v[36:39], a[72:75], a[84:87], v[36:39]
    ds_read_b64_tr_b16 a[64:65], v98 offset:2048
    ds_read_b64_tr_b16 a[66:67], v98 offset:2304
    ds_read_b64_tr_b16 a[68:69], v99 offset:2048
    ds_read_b64_tr_b16 a[70:71], v99 offset:2304
    v_mfma_f32_16x16x32_bf16 v[48:51], a[72:75], a[88:91], v[48:51]
    v_mfma_f32_16x16x32_bf16 v[52:55], a[72:75], a[92:95], v[52:55]
    ds_read_b128 a[104:107], v97 offset:4096
    ds_read_b128 a[108:111], v97 offset:6144
    v_mfma_f32_16x16x32_bf16 v[40:43], a[76:79], a[80:83], v[40:43]
    v_mfma_f32_16x16x32_bf16 v[44:47], a[76:79], a[84:87], v[44:47]
    v_mfma_f32_16x16x32_bf16 v[56:59], a[76:79], a[88:91], v[56:59]
    v_mfma_f32_16x16x32_bf16 v[60:63], a[76:79], a[92:95], v[60:63]
    s_setprio 0
    s_waitcnt vmcnt(0)
    v_add_f32 v64, v64, v65
    v_add_f32 v66, v66, v67
    v_add_f32_e64 v64, v64, v66
    v_cvt_pk_bf16_f32 v65, v64, v64
    v_lshlrev_b32 v65, 16, v65
    v_sub_f32 v65, v64, v65
    v_cvt_pk_bf16_f32 v64, v64, v65
    v_add_f32 v68, v68, v69
    v_add_f32 v70, v70, v71
    v_add_f32_e64 v68, v68, v70
    v_cvt_pk_bf16_f32 v69, v68, v68
    v_lshlrev_b32 v69, 16, v69
    v_sub_f32 v69, v68, v69
    v_cvt_pk_bf16_f32 v68, v68, v69
    v_bfe_u32 v115, v112, 1, 8
    v_lshrrev_b32 v116, 9, v112
    v_lshl_add_u32 v115, v116, 2, v115
    s_lshl_b32 s3, s26, 8
    s_add_u32 s3, s3, 155648
    v_add_u32 v115, s3, v115
    v_mov_b32 v66, 0
    ds_write_b32 v115, v64
    ds_write_b32 v115, v68 offset:1024
    ds_write_b32 v115, v66 offset:2048
    v_and_b32 v123, 0x130, v112
    v_lshrrev_b32 v123, 1, v123
    v_and_b32 v116, 0x40, v112
    v_add_u32 v123, v123, v116
    s_mov_b32 vcc_lo, 0xff00ff00
    s_mov_b32 vcc_hi, 0x00ff00ff
    v_mov_b32 v116, 1280
    v_cndmask_b32 v123, v123, v116, vcc
    v_add_u32 v123, 155648, v123
    s_mov_b32 vcc_lo, 0
    s_mov_b32 vcc_hi, -1
    v_cndmask_b32 v136, v125, v127, vcc
    v_cndmask_b32 v140, v109, v111, vcc
    v_cvt_pk_bf16_f32 v136, v136, v136
    v_cvt_pk_bf16_f32 v140, v140, v140
    s_mov_b32 vcc_lo, 0xffff0000
    s_mov_b32 vcc_hi, 0xffff0000
    v_cndmask_b32 v138, 0, v136, vcc
    v_cndmask_b32 v139, 0, v136, vcc
    v_cndmask_b32 v137, v136, 0, vcc
    v_cndmask_b32 v136, v136, 0, vcc
    v_cndmask_b32 v142, 0, v140, vcc
    v_cndmask_b32 v143, 0, v140, vcc
    v_cndmask_b32 v141, v140, 0, vcc
    v_cndmask_b32 v140, v140, 0, vcc
    v_rsq_f32 v129, v124
    v_rsq_f32 v131, v126
    v_rsq_f32 v133, v108
    v_rsq_f32 v135, v110
    v_mul_f32_e64 v132, v129, v129
    v_mul_f32 v128, 0xc0135761, v129
    v_mul_f32_e64 v134, v131, v131
    v_mul_f32 v130, 0xc0135761, v131
    v_mul_f32 v132, 0x3d372713, v132
    v_mul_f32 v134, 0x3d372713, v134
    v_mul_f32 v132, v128, v132
    v_mul_f32 v134, v130, v134
    s_setprio 2
    s_waitcnt lgkmcnt(0)
    v_mfma_f32_16x16x32_bf16 v[0:3], a[64:67], a[96:99], v[0:3]
    v_mfma_f32_16x16x32_bf16 v[4:7], a[64:67], a[100:103], v[4:7]
    ds_read_b64_tr_b16 a[72:73], v100 offset:4096
    ds_read_b64_tr_b16 a[74:75], v100 offset:4608
    ds_read_b64_tr_b16 a[76:77], v100 offset:12288
    ds_read_b64_tr_b16 a[78:79], v100 offset:12800
    v_mfma_f32_16x16x32_bf16 v[16:19], a[64:67], a[104:107], v[16:19]
    v_mfma_f32_16x16x32_bf16 v[20:23], a[64:67], a[108:111], v[20:23]
    v_mfma_f32_16x16x32_bf16 v[8:11], a[68:71], a[96:99], v[8:11]
    v_mfma_f32_16x16x32_bf16 v[12:15], a[68:71], a[100:103], v[12:15]
    v_mfma_f32_16x16x32_bf16 v[24:27], a[68:71], a[104:107], v[24:27]
    v_mfma_f32_16x16x32_bf16 v[28:31], a[68:71], a[108:111], v[28:31]
    s_waitcnt lgkmcnt(0)
    v_mfma_f32_16x16x32_bf16 v[32:35], a[72:75], a[96:99], v[32:35]
    v_mfma_f32_16x16x32_bf16 v[36:39], a[72:75], a[100:103], v[36:39]
    s_barrier
    ds_read2_b64 a[68:71], v123 offset0:128 offset1:132
    ds_read2_b64 a[64:67], v123 offset0:0 offset1:4
    v_mfma_f32_16x16x32_bf16 v[48:51], a[72:75], a[104:107], v[48:51]
    v_mfma_f32_16x16x32_bf16 v[52:55], a[72:75], a[108:111], v[52:55]
    s_bfe_u32 s4, s43, 0x40000
    s_mul_i32 s4, s4, 28672
    s_add_u32 m0, s10, 0
    s_add_u32 s4, s4, s22
    buffer_load_dwordx4 v119, s[44:47], s4 offen offset:0 lds
    buffer_load_dwordx4 v120, s[44:47], s4 offen offset:1024 lds
    v_mfma_f32_16x16x32_bf16 v[40:43], a[76:79], a[96:99], v[40:43]
    v_mfma_f32_16x16x32_bf16 v[44:47], a[76:79], a[100:103], v[44:47]
    buffer_load_dwordx4 v121, s[44:47], s4 offen offset:2048 lds
    v_mfma_f32_16x16x32_bf16 v[56:59], a[76:79], a[104:107], v[56:59]
    v_mfma_f32_16x16x32_bf16 v[60:63], a[76:79], a[108:111], v[60:63]
    buffer_load_dwordx4 v122, s[44:47], s4 offen offset:3072 lds
    s_waitcnt lgkmcnt(0)
    s_nop 4
    v_mfma_f32_32x32x16_bf16 v[32:47], a[68:71], v[136:139], v[32:47]
    s_barrier
    v_mfma_f32_32x32x16_bf16 v[48:63], a[68:71], v[140:143], v[48:63]
    s_bfe_u32 s4, s43, 0x40004
    s_mul_i32 s4, s4, 28672
    s_add_u32 m0, s10, 4096
    s_add_u32 s4, s4, s22
    buffer_load_dwordx4 v119, s[44:47], s4 offen offset:0 lds
    buffer_load_dwordx4 v120, s[44:47], s4 offen offset:1024 lds
    v_mfma_f32_32x32x16_bf16 v[0:15], a[64:67], v[136:139], v[0:15]
    buffer_load_dwordx4 v121, s[44:47], s4 offen offset:2048 lds
    v_mfma_f32_32x32x16_bf16 v[16:31], a[64:67], v[140:143], v[16:31]
    buffer_load_dwordx4 v122, s[44:47], s4 offen offset:3072 lds
    s_setprio 1
    s_add_u32 s8, s25, 3
    s_lshl_b32 s8, s8, 11
    s_add_u32 s8, s8, s23
    s_nop 3
    s_add_u32 m0, s40, 0
    s_add_u32 s5, s41, 0
    s_nop 0
    buffer_load_dwordx4 v119, s[48:51], s5 offen offset:0 lds
    buffer_load_dwordx4 v120, s[48:51], s5 offen offset:1024 lds
    buffer_load_dwordx4 v121, s[48:51], s5 offen offset:2048 lds
    buffer_load_dwordx4 v122, s[48:51], s5 offen offset:3072 lds
    v_pk_mul_f32 v[136:137], v[32:33], v[32:33]
    v_pk_mul_f32 v[138:139], v[34:35], v[34:35]
    v_pk_mul_f32 v[140:141], v[36:37], v[36:37]
    v_pk_mul_f32 v[142:143], v[38:39], v[38:39]
    v_pk_fma_f32 v[136:137], v[136:137], v[132:133], v[128:129] op_sel_hi:[1,0,0]
    v_pk_fma_f32 v[138:139], v[138:139], v[132:133], v[128:129] op_sel_hi:[1,0,0]
    v_pk_fma_f32 v[140:141], v[140:141], v[134:135], v[130:131] op_sel_hi:[1,0,0]
    v_pk_fma_f32 v[142:143], v[142:143], v[134:135], v[130:131] op_sel_hi:[1,0,0]
    v_pk_mul_f32 v[136:137], v[32:33], v[136:137]
    v_pk_mul_f32 v[138:139], v[34:35], v[138:139]
    v_pk_mul_f32 v[140:141], v[36:37], v[140:141]
    v_pk_mul_f32 v[142:143], v[38:39], v[142:143]
    v_exp_f32 v136, v136
    v_exp_f32 v137, v137
    v_exp_f32 v138, v138
    v_exp_f32 v139, v139
    v_exp_f32 v140, v140
    v_exp_f32 v141, v141
    v_exp_f32 v142, v142
    v_exp_f32 v143, v143
    v_pk_mul_f32 v[32:33], v[32:33], v[40:41]
    v_pk_mul_f32 v[34:35], v[34:35], v[42:43]
    v_pk_mul_f32 v[36:37], v[36:37], v[44:45]
    v_pk_mul_f32 v[38:39], v[38:39], v[46:47]
    v_pk_fma_f32 v[136:137], v[136:137], v[124:125], v[124:125] op_sel_hi:[1,0,0]
    v_pk_fma_f32 v[138:139], v[138:139], v[124:125], v[124:125] op_sel_hi:[1,0,0]
    v_pk_fma_f32 v[140:141], v[140:141], v[126:127], v[126:127] op_sel_hi:[1,0,0]
    v_pk_fma_f32 v[142:143], v[142:143], v[126:127], v[126:127] op_sel_hi:[1,0,0]
    v_rcp_f32 v136, v136
    v_rcp_f32 v137, v137
    v_rcp_f32 v138, v138
    v_rcp_f32 v139, v139
    v_rcp_f32 v140, v140
    v_rcp_f32 v141, v141
    v_rcp_f32 v142, v142
    v_rcp_f32 v143, v143
    v_pk_mul_f32 v[32:33], v[32:33], v[136:137]
    v_pk_mul_f32 v[34:35], v[34:35], v[138:139]
    v_pk_mul_f32 v[36:37], v[36:37], v[140:141]
    v_pk_mul_f32 v[38:39], v[38:39], v[142:143]
    v_cvt_pk_bf16_f32 v40, v32, v33
    v_cvt_pk_bf16_f32 v42, v36, v37
    v_cvt_pk_bf16_f32 v41, v34, v35
    v_cvt_pk_bf16_f32 v43, v38, v39
    s_nop 0
    v_permlane16_swap_b32 v40, v42
    v_permlane16_swap_b32 v41, v43
    v_mul_f32 v132, v133, v133
    v_mul_f32 v128, 0xc0135761, v133
    v_mul_f32_e64 v134, v135, v135
    v_mul_f32 v130, 0xc0135761, v135
    v_mul_f32 v132, 0x3d372713, v132
    v_mul_f32 v134, 0x3d372713, v134
    v_mul_f32 v132, v128, v132
    v_mul_f32 v134, v130, v134
    v_pk_mul_f32 v[136:137], v[48:49], v[48:49]
    v_pk_mul_f32 v[138:139], v[50:51], v[50:51]
    v_pk_mul_f32 v[140:141], v[52:53], v[52:53]
    v_pk_mul_f32 v[142:143], v[54:55], v[54:55]
    v_pk_fma_f32 v[136:137], v[136:137], v[132:133], v[128:129] op_sel_hi:[1,0,0]
    v_pk_fma_f32 v[138:139], v[138:139], v[132:133], v[128:129] op_sel_hi:[1,0,0]
    v_pk_fma_f32 v[140:141], v[140:141], v[134:135], v[130:131] op_sel_hi:[1,0,0]
    v_pk_fma_f32 v[142:143], v[142:143], v[134:135], v[130:131] op_sel_hi:[1,0,0]
    v_pk_mul_f32 v[136:137], v[48:49], v[136:137]
    v_pk_mul_f32 v[138:139], v[50:51], v[138:139]
    v_pk_mul_f32 v[140:141], v[52:53], v[140:141]
    v_pk_mul_f32 v[142:143], v[54:55], v[142:143]
    v_exp_f32 v136, v136
    v_exp_f32 v137, v137
    v_exp_f32 v138, v138
    v_exp_f32 v139, v139
    v_exp_f32 v140, v140
    v_exp_f32 v141, v141
    v_exp_f32 v142, v142
    v_exp_f32 v143, v143
    v_pk_mul_f32 v[48:49], v[48:49], v[56:57]
    v_pk_mul_f32 v[50:51], v[50:51], v[58:59]
    v_pk_mul_f32 v[52:53], v[52:53], v[60:61]
    v_pk_mul_f32 v[54:55], v[54:55], v[62:63]
    v_pk_fma_f32 v[136:137], v[136:137], v[108:109], v[108:109] op_sel_hi:[1,0,0]
    v_pk_fma_f32 v[138:139], v[138:139], v[108:109], v[108:109] op_sel_hi:[1,0,0]
    v_pk_fma_f32 v[140:141], v[140:141], v[110:111], v[110:111] op_sel_hi:[1,0,0]
    v_pk_fma_f32 v[142:143], v[142:143], v[110:111], v[110:111] op_sel_hi:[1,0,0]
    v_rcp_f32 v136, v136
    v_rcp_f32 v137, v137
    v_rcp_f32 v138, v138
    v_rcp_f32 v139, v139
    v_rcp_f32 v140, v140
    v_rcp_f32 v141, v141
    v_rcp_f32 v142, v142
    v_rcp_f32 v143, v143
    v_pk_mul_f32 v[48:49], v[48:49], v[136:137]
    v_pk_mul_f32 v[50:51], v[50:51], v[138:139]
    v_pk_mul_f32 v[52:53], v[52:53], v[140:141]
    v_pk_mul_f32 v[54:55], v[54:55], v[142:143]
    v_cvt_pk_bf16_f32 v56, v48, v49
    v_cvt_pk_bf16_f32 v58, v52, v53
    v_cvt_pk_bf16_f32 v57, v50, v51
    v_cvt_pk_bf16_f32 v59, v54, v55
    s_nop 0
    v_permlane16_swap_b32 v56, v58
    v_permlane16_swap_b32 v57, v59
    s_setprio 0
    buffer_store_dwordx4 v[40:43], v112, s[52:55], s8 offen offset:0 sc1
    buffer_store_dwordx4 v[56:59], v112, s[52:55], s8 offen offset:1024 sc1
    s_add_u32 m0, s40, 4096
    s_add_u32 s5, s41, 28672
    buffer_load_dwordx4 v119, s[48:51], s5 offen offset:0 lds
    buffer_load_dwordx4 v120, s[48:51], s5 offen offset:1024 lds
    buffer_load_dwordx4 v121, s[48:51], s5 offen offset:2048 lds
    buffer_load_dwordx4 v122, s[48:51], s5 offen offset:3072 lds
    s_waitcnt vmcnt(14)
    s_nop 0
    ds_read_b64_tr_b16 a[0:1], v117 offset:0
    ds_read_b64_tr_b16 a[2:3], v117 offset:512
    ds_read_b64_tr_b16 a[4:5], v118 offset:0
    ds_read_b64_tr_b16 a[6:7], v118 offset:512
    ds_read_b64_tr_b16 a[8:9], v117 offset:2048
    ds_read_b64_tr_b16 a[10:11], v117 offset:2560
    ds_read_b64_tr_b16 a[12:13], v118 offset:2048
    ds_read_b64_tr_b16 a[14:15], v118 offset:2560
    v_mov_b32 v116, 160832
L_sy_16:
    ds_read_b128 v[96:99], v116
    s_waitcnt lgkmcnt(0)
    v_min3_u32 v96, v96, v97, v98
    v_min_u32 v96, v96, v99
    v_cmp_eq_u32 vcc, 0, v96
    s_cbranch_vccnz L_sy_16
    s_waitcnt vmcnt(4)
    s_mov_b32 s42, 1
    s_atomic_add s42, s[52:53], s16
    s_bfe_u32 s4, s43, 0x40008
    s_mul_i32 s4, s4, 28672
    s_add_u32 m0, s10, 20480
    s_add_u32 s4, s4, s22
    buffer_load_dwordx4 v119, s[44:47], s4 offen offset:0 lds
    buffer_load_dwordx4 v120, s[44:47], s4 offen offset:1024 lds
    buffer_load_dwordx4 v121, s[44:47], s4 offen offset:2048 lds
    buffer_load_dwordx4 v122, s[44:47], s4 offen offset:3072 lds
    s_bfe_u32 s4, s43, 0x4000c
    s_mul_i32 s4, s4, 28672
    s_add_u32 m0, s10, 8192
    s_add_u32 s4, s4, s22
    buffer_load_dwordx4 v119, s[44:47], s4 offen offset:0 lds
    buffer_load_dwordx4 v120, s[44:47], s4 offen offset:1024 lds
    buffer_load_dwordx4 v121, s[44:47], s4 offen offset:2048 lds
    buffer_load_dwordx4 v122, s[44:47], s4 offen offset:3072 lds
    s_bfe_u32 s4, s43, 0x40010
    s_mul_i32 s4, s4, 28672
    s_add_u32 m0, s10, 12288
    s_add_u32 s4, s4, s22
    buffer_load_dwordx4 v119, s[44:47], s4 offen offset:0 lds
    buffer_load_dwordx4 v120, s[44:47], s4 offen offset:1024 lds
    buffer_load_dwordx4 v121, s[44:47], s4 offen offset:2048 lds
    buffer_load_dwordx4 v122, s[44:47], s4 offen offset:3072 lds
    s_bfe_u32 s4, s43, 0x40014
    s_mul_i32 s4, s4, 28672
    s_add_u32 m0, s10, 16384
    s_add_u32 s4, s4, s22
    buffer_load_dwordx4 v119, s[44:47], s4 offen offset:0 lds
    buffer_load_dwordx4 v120, s[44:47], s4 offen offset:1024 lds
    buffer_load_dwordx4 v121, s[44:47], s4 offen offset:2048 lds
    buffer_load_dwordx4 v122, s[44:47], s4 offen offset:3072 lds
    s_bfe_u32 s4, s43, 0x40018
    s_mul_i32 s4, s4, 28672
    s_add_u32 m0, s10, 0
    s_add_u32 s4, s4, s22
    buffer_load_dwordx4 v119, s[44:47], s4 offen offset:0 lds
    buffer_load_dwordx4 v120, s[44:47], s4 offen offset:1024 lds
    buffer_load_dwordx4 v121, s[44:47], s4 offen offset:2048 lds
    buffer_load_dwordx4 v122, s[44:47], s4 offen offset:3072 lds
    s_add_u32 m0, s40, 8192
    s_add_u32 s5, s41, 57344
    buffer_load_dwordx4 v119, s[48:51], s5 offen offset:0 lds
    buffer_load_dwordx4 v120, s[48:51], s5 offen offset:1024 lds
    buffer_load_dwordx4 v121, s[48:51], s5 offen offset:2048 lds
    buffer_load_dwordx4 v122, s[48:51], s5 offen offset:3072 lds
    s_add_u32 m0, s40, 12288
    s_add_u32 s5, s41, 86016
    buffer_load_dwordx4 v119, s[48:51], s5 offen offset:0 lds
    buffer_load_dwordx4 v120, s[48:51], s5 offen offset:1024 lds
    v_cvt_pk_bf16_f32 v64, v0, v1
    v_cvt_pk_bf16_f32 v65, v2, v3
    v_cvt_pk_bf16_f32 v66, v4, v5
    v_cvt_pk_bf16_f32 v67, v6, v7
    v_cvt_pk_bf16_f32 v68, v8, v9
    v_cvt_pk_bf16_f32 v69, v10, v11
    v_cvt_pk_bf16_f32 v70, v12, v13
    v_cvt_pk_bf16_f32 v71, v14, v15
    v_cvt_pk_bf16_f32 v72, v16, v17
    v_cvt_pk_bf16_f32 v73, v18, v19
    v_cvt_pk_bf16_f32 v74, v20, v21
    v_cvt_pk_bf16_f32 v75, v22, v23
    v_cvt_pk_bf16_f32 v76, v24, v25
    v_cvt_pk_bf16_f32 v77, v26, v27
    v_cvt_pk_bf16_f32 v78, v28, v29
    v_cvt_pk_bf16_f32 v79, v30, v31
    v_permlane16_swap_b32 v64, v66
    v_permlane16_swap_b32 v65, v67
    v_permlane16_swap_b32 v68, v70
    v_permlane16_swap_b32 v69, v71
    v_permlane16_swap_b32 v72, v74
    v_permlane16_swap_b32 v73, v75
    v_permlane16_swap_b32 v76, v78
    v_permlane16_swap_b32 v77, v79
    s_nop 1
    v_mfma_f32_32x32x16_bf16 v[0:15], v[88:91], v[64:67], 0
    v_mfma_f32_32x32x16_bf16 v[0:15], v[92:95], v[68:71], v[0:15]
    v_mfma_f32_32x32x16_bf16 v[16:31], v[88:91], v[72:75], 0
    v_mfma_f32_32x32x16_bf16 v[16:31], v[92:95], v[76:79], v[16:31]
    s_nop 9
    v_max3_f32 v136, v0, v1, v2
    v_min3_f32 v138, v0, v1, v2
    v_max3_f32 v140, v16, v17, v18
    v_min3_f32 v142, v16, v17, v18
    v_max3_f32 v136, v136, v3, v4
    v_min3_f32 v138, v138, v3, v4
    v_max3_f32 v140, v140, v19, v20
    v_min3_f32 v142, v142, v19, v20
    v_max3_f32 v136, v136, v5, v6
    v_min3_f32 v138, v138, v5, v6
    v_max3_f32 v140, v140, v21, v22
    v_min3_f32 v142, v142, v21, v22
    v_max3_f32 v136, v136, v7, v8
    v_min3_f32 v138, v138, v7, v8
    v_max3_f32 v140, v140, v23, v24
    v_min3_f32 v142, v142, v23, v24
    v_max3_f32 v136, v136, v9, v10
    v_min3_f32 v138, v138, v9, v10
    v_max3_f32 v140, v140, v25, v26
    v_min3_f32 v142, v142, v25, v26
    v_max3_f32 v136, v136, v11, v12
    v_min3_f32 v138, v138, v11, v12
    v_max3_f32 v140, v140, v27, v28
    v_min3_f32 v142, v142, v27, v28
    v_max_f32 v137, v136, v13
    v_min_f32 v139, v138, v13
    v_max_f32 v141, v140, v29
    v_min_f32 v143, v142, v29
    v_max_f32 v136, v136, v13
    v_min_f32 v138, v138, v13
    v_max_f32 v140, v140, v29
    v_min_f32 v142, v142, v29
    s_mov_b32 vcc_lo, 0xffff0000
    s_mov_b32 vcc_hi, 0xffff0000
    v_cndmask_b32 v128, v129, v131, vcc
    v_cndmask_b32 v130, v133, v135, vcc
    v_mul_f32 v128, 0x3fb8aa3b, v128
    v_mul_f32 v130, 0x3fb8aa3b, v130
    v_permlane32_swap_b32 v136, v137
    v_permlane32_swap_b32 v138, v139
    v_permlane32_swap_b32 v140, v141
    v_permlane32_swap_b32 v142, v143
    v_max_f32 v136, v136, v137
    v_min_f32 v138, v138, v139
    v_max_f32 v140, v140, v141
    v_min_f32 v142, v142, v143
    v_mul_f32 v136, v136, v128
    v_mul_f32 v138, v138, v128
    v_mul_f32 v140, v140, v130
    v_mul_f32 v142, v142, v130
    v_pk_fma_f32 v[32:33], v[0:1], v[128:129], v[138:139] op_sel_hi:[1,0,0] neg_lo:[1,0,0] neg_hi:[1,0,0]
    v_pk_fma_f32 v[34:35], v[2:3], v[128:129], v[138:139] op_sel_hi:[1,0,0] neg_lo:[1,0,0] neg_hi:[1,0,0]
    v_pk_fma_f32 v[36:37], v[4:5], v[128:129], v[138:139] op_sel_hi:[1,0,0] neg_lo:[1,0,0] neg_hi:[1,0,0]
    v_pk_fma_f32 v[38:39], v[6:7], v[128:129], v[138:139] op_sel_hi:[1,0,0] neg_lo:[1,0,0] neg_hi:[1,0,0]
    v_pk_fma_f32 v[40:41], v[8:9], v[128:129], v[138:139] op_sel_hi:[1,0,0] neg_lo:[1,0,0] neg_hi:[1,0,0]
    v_pk_fma_f32 v[42:43], v[10:11], v[128:129], v[138:139] op_sel_hi:[1,0,0] neg_lo:[1,0,0] neg_hi:[1,0,0]
    v_pk_fma_f32 v[44:45], v[12:13], v[128:129], v[138:139] op_sel_hi:[1,0,0] neg_lo:[1,0,0] neg_hi:[1,0,0]
    v_pk_fma_f32 v[0:1], v[0:1], v[128:129], v[136:137] op_sel_hi:[1,0,0] neg_lo:[0,0,1] neg_hi:[0,0,1]
    v_pk_fma_f32 v[2:3], v[2:3], v[128:129], v[136:137] op_sel_hi:[1,0,0] neg_lo:[0,0,1] neg_hi:[0,0,1]
    v_pk_fma_f32 v[4:5], v[4:5], v[128:129], v[136:137] op_sel_hi:[1,0,0] neg_lo:[0,0,1] neg_hi:[0,0,1]
    v_pk_fma_f32 v[6:7], v[6:7], v[128:129], v[136:137] op_sel_hi:[1,0,0] neg_lo:[0,0,1] neg_hi:[0,0,1]
    v_pk_fma_f32 v[8:9], v[8:9], v[128:129], v[136:137] op_sel_hi:[1,0,0] neg_lo:[0,0,1] neg_hi:[0,0,1]
    v_pk_fma_f32 v[10:11], v[10:11], v[128:129], v[136:137] op_sel_hi:[1,0,0] neg_lo:[0,0,1] neg_hi:[0,0,1]
    v_pk_fma_f32 v[12:13], v[12:13], v[128:129], v[136:137] op_sel_hi:[1,0,0] neg_lo:[0,0,1] neg_hi:[0,0,1]
    v_exp_f32 v32, v32
    v_exp_f32 v33, v33
    v_exp_f32 v34, v34
    v_exp_f32 v35, v35
    v_exp_f32 v36, v36
    v_exp_f32 v37, v37
    v_exp_f32 v38, v38
    v_exp_f32 v39, v39
    v_exp_f32 v40, v40
    v_exp_f32 v41, v41
    v_exp_f32 v42, v42
    v_exp_f32 v43, v43
    v_exp_f32 v44, v44
    v_exp_f32 v45, v45
    v_exp_f32 v0, v0
    v_exp_f32 v1, v1
    v_exp_f32 v2, v2
    v_exp_f32 v3, v3
    v_exp_f32 v4, v4
    v_exp_f32 v5, v5
    v_exp_f32 v6, v6
    v_exp_f32 v7, v7
    v_exp_f32 v8, v8
    v_exp_f32 v9, v9
    v_exp_f32 v10, v10
    v_exp_f32 v11, v11
    v_exp_f32 v12, v12
    v_exp_f32 v13, v13
    v_pk_add_f32 v[106:107], v[32:33], v[34:35]
    v_pk_add_f32 v[104:105], v[0:1], v[2:3]
    v_pk_add_f32 v[106:107], v[106:107], v[36:37]
    v_pk_add_f32 v[104:105], v[104:105], v[4:5]
    v_pk_add_f32 v[106:107], v[106:107], v[38:39]
    v_pk_add_f32 v[104:105], v[104:105], v[6:7]
    v_pk_add_f32 v[106:107], v[106:107], v[40:41]
    v_pk_add_f32 v[104:105], v[104:105], v[8:9]
    v_pk_add_f32 v[106:107], v[106:107], v[42:43]
    v_pk_add_f32 v[104:105], v[104:105], v[10:11]
    v_pk_add_f32 v[106:107], v[106:107], v[44:45]
    v_pk_add_f32 v[104:105], v[104:105], v[12:13]
    v_add_f32 v138, v106, v107
    v_add_f32 v139, v106, v107
    v_add_f32 v136, v104, v105
    v_add_f32 v137, v104, v105
    s_waitcnt lgkmcnt(0)
    v_permlane32_swap_b32 v138, v139
    v_permlane32_swap_b32 v136, v137
    v_add_f32 v138, v138, v139
    v_add_f32 v136, v136, v137
    v_rcp_f32 v138, v138
    v_rcp_f32 v136, v136
    v_mov_b32 v71, 0
    v_mov_b32_e64 v79, 0
    v_pk_mul_f32 v[0:1], v[0:1], v[136:137] op_sel_hi:[1,0]
    v_pk_mul_f32 v[2:3], v[2:3], v[136:137] op_sel_hi:[1,0]
    v_pk_mul_f32 v[4:5], v[4:5], v[136:137] op_sel_hi:[1,0]
    v_pk_mul_f32 v[6:7], v[6:7], v[136:137] op_sel_hi:[1,0]
    v_pk_mul_f32 v[8:9], v[8:9], v[136:137] op_sel_hi:[1,0]
    v_pk_mul_f32 v[10:11], v[10:11], v[136:137] op_sel_hi:[1,0]
    v_pk_mul_f32 v[12:13], v[12:13], v[136:137] op_sel_hi:[1,0]
    v_pk_mul_f32 v[32:33], v[32:33], v[138:139] op_sel_hi:[1,0]
    v_pk_mul_f32 v[34:35], v[34:35], v[138:139] op_sel_hi:[1,0]
    v_pk_mul_f32 v[36:37], v[36:37], v[138:139] op_sel_hi:[1,0]
    v_pk_mul_f32 v[38:39], v[38:39], v[138:139] op_sel_hi:[1,0]
    v_pk_mul_f32 v[40:41], v[40:41], v[138:139] op_sel_hi:[1,0]
    v_pk_mul_f32 v[42:43], v[42:43], v[138:139] op_sel_hi:[1,0]
    v_pk_mul_f32 v[44:45], v[44:45], v[138:139] op_sel_hi:[1,0]
    v_cvt_pk_bf16_f32 v64, v0, v1
    v_cvt_pk_bf16_f32 v65, v2, v3
    v_cvt_pk_bf16_f32 v66, v4, v5
    v_cvt_pk_bf16_f32 v67, v6, v7
    v_cvt_pk_bf16_f32 v68, v8, v9
    v_cvt_pk_bf16_f32 v69, v10, v11
    v_cvt_pk_bf16_f32 v70, v12, v13
    v_cvt_pk_bf16_f32 v72, v32, v33
    v_cvt_pk_bf16_f32 v73, v34, v35
    v_cvt_pk_bf16_f32 v74, v36, v37
    v_cvt_pk_bf16_f32 v75, v38, v39
    v_cvt_pk_bf16_f32 v76, v40, v41
    v_cvt_pk_bf16_f32 v77, v42, v43
    v_cvt_pk_bf16_f32 v78, v44, v45
    v_pk_fma_f32 v[48:49], v[16:17], v[130:131], v[142:143] op_sel_hi:[1,0,0] neg_lo:[1,0,0] neg_hi:[1,0,0]
    v_pk_fma_f32 v[50:51], v[18:19], v[130:131], v[142:143] op_sel_hi:[1,0,0] neg_lo:[1,0,0] neg_hi:[1,0,0]
    v_pk_fma_f32 v[52:53], v[20:21], v[130:131], v[142:143] op_sel_hi:[1,0,0] neg_lo:[1,0,0] neg_hi:[1,0,0]
    v_pk_fma_f32 v[54:55], v[22:23], v[130:131], v[142:143] op_sel_hi:[1,0,0] neg_lo:[1,0,0] neg_hi:[1,0,0]
    v_pk_fma_f32 v[56:57], v[24:25], v[130:131], v[142:143] op_sel_hi:[1,0,0] neg_lo:[1,0,0] neg_hi:[1,0,0]
    v_pk_fma_f32 v[58:59], v[26:27], v[130:131], v[142:143] op_sel_hi:[1,0,0] neg_lo:[1,0,0] neg_hi:[1,0,0]
    v_pk_fma_f32 v[60:61], v[28:29], v[130:131], v[142:143] op_sel_hi:[1,0,0] neg_lo:[1,0,0] neg_hi:[1,0,0]
    v_pk_fma_f32 v[16:17], v[16:17], v[130:131], v[140:141] op_sel_hi:[1,0,0] neg_lo:[0,0,1] neg_hi:[0,0,1]
    v_pk_fma_f32 v[18:19], v[18:19], v[130:131], v[140:141] op_sel_hi:[1,0,0] neg_lo:[0,0,1] neg_hi:[0,0,1]
    v_pk_fma_f32 v[20:21], v[20:21], v[130:131], v[140:141] op_sel_hi:[1,0,0] neg_lo:[0,0,1] neg_hi:[0,0,1]
    v_pk_fma_f32 v[22:23], v[22:23], v[130:131], v[140:141] op_sel_hi:[1,0,0] neg_lo:[0,0,1] neg_hi:[0,0,1]
    v_pk_fma_f32 v[24:25], v[24:25], v[130:131], v[140:141] op_sel_hi:[1,0,0] neg_lo:[0,0,1] neg_hi:[0,0,1]
    v_pk_fma_f32 v[26:27], v[26:27], v[130:131], v[140:141] op_sel_hi:[1,0,0] neg_lo:[0,0,1] neg_hi:[0,0,1]
    v_pk_fma_f32 v[28:29], v[28:29], v[130:131], v[140:141] op_sel_hi:[1,0,0] neg_lo:[0,0,1] neg_hi:[0,0,1]
    v_exp_f32 v48, v48
    v_exp_f32 v49, v49
    v_exp_f32 v50, v50
    v_exp_f32 v51, v51
    v_exp_f32 v52, v52
    v_exp_f32 v53, v53
    v_exp_f32 v54, v54
    v_exp_f32 v55, v55
    v_exp_f32 v56, v56
    v_exp_f32 v57, v57
    v_exp_f32 v58, v58
    v_exp_f32 v59, v59
    v_exp_f32 v60, v60
    v_exp_f32 v61, v61
    v_exp_f32 v16, v16
    v_exp_f32 v17, v17
    v_exp_f32 v18, v18
    v_exp_f32 v19, v19
    v_exp_f32 v20, v20
    v_exp_f32 v21, v21
    v_exp_f32 v22, v22
    v_exp_f32 v23, v23
    v_exp_f32 v24, v24
    v_exp_f32 v25, v25
    v_exp_f32 v26, v26
    v_exp_f32 v27, v27
    v_exp_f32 v28, v28
    v_exp_f32 v29, v29
    v_pk_add_f32 v[110:111], v[48:49], v[50:51]
    v_pk_add_f32 v[108:109], v[16:17], v[18:19]
    v_pk_add_f32 v[110:111], v[110:111], v[52:53]
    v_pk_add_f32 v[108:109], v[108:109], v[20:21]
    v_pk_add_f32 v[110:111], v[110:111], v[54:55]
    v_pk_add_f32 v[108:109], v[108:109], v[22:23]
    v_pk_add_f32 v[110:111], v[110:111], v[56:57]
    v_pk_add_f32 v[108:109], v[108:109], v[24:25]
    v_pk_add_f32 v[110:111], v[110:111], v[58:59]
    v_pk_add_f32 v[108:109], v[108:109], v[26:27]
    v_pk_add_f32 v[110:111], v[110:111], v[60:61]
    v_pk_add_f32 v[108:109], v[108:109], v[28:29]
    v_add_f32 v142, v110, v111
    v_add_f32 v143, v110, v111
    v_add_f32 v140, v108, v109
    v_add_f32 v141, v108, v109
    s_waitcnt lgkmcnt(0)
    v_permlane32_swap_b32 v142, v143
    v_permlane32_swap_b32 v140, v141
    v_add_f32 v142, v142, v143
    v_add_f32 v140, v140, v141
    v_rcp_f32 v142, v142
    v_rcp_f32 v140, v140
    v_mov_b32 v87, 0
    v_mov_b32_e64 v95, 0
    v_pk_mul_f32 v[16:17], v[16:17], v[140:141] op_sel_hi:[1,0]
    v_pk_mul_f32 v[18:19], v[18:19], v[140:141] op_sel_hi:[1,0]
    v_pk_mul_f32 v[20:21], v[20:21], v[140:141] op_sel_hi:[1,0]
    v_pk_mul_f32 v[22:23], v[22:23], v[140:141] op_sel_hi:[1,0]
    v_pk_mul_f32 v[24:25], v[24:25], v[140:141] op_sel_hi:[1,0]
    v_pk_mul_f32 v[26:27], v[26:27], v[140:141] op_sel_hi:[1,0]
    v_pk_mul_f32 v[28:29], v[28:29], v[140:141] op_sel_hi:[1,0]
    v_pk_mul_f32 v[48:49], v[48:49], v[142:143] op_sel_hi:[1,0]
    v_pk_mul_f32 v[50:51], v[50:51], v[142:143] op_sel_hi:[1,0]
    v_pk_mul_f32 v[52:53], v[52:53], v[142:143] op_sel_hi:[1,0]
    v_pk_mul_f32 v[54:55], v[54:55], v[142:143] op_sel_hi:[1,0]
    v_pk_mul_f32 v[56:57], v[56:57], v[142:143] op_sel_hi:[1,0]
    v_pk_mul_f32 v[58:59], v[58:59], v[142:143] op_sel_hi:[1,0]
    v_pk_mul_f32 v[60:61], v[60:61], v[142:143] op_sel_hi:[1,0]
    v_cvt_pk_bf16_f32 v80, v16, v17
    v_cvt_pk_bf16_f32 v81, v18, v19
    v_cvt_pk_bf16_f32 v82, v20, v21
    v_cvt_pk_bf16_f32 v83, v22, v23
    v_cvt_pk_bf16_f32 v84, v24, v25
    v_cvt_pk_bf16_f32 v85, v26, v27
    v_cvt_pk_bf16_f32 v86, v28, v29
    v_cvt_pk_bf16_f32 v88, v48, v49
    v_cvt_pk_bf16_f32 v89, v50, v51
    v_cvt_pk_bf16_f32 v90, v52, v53
    v_cvt_pk_bf16_f32 v91, v54, v55
    v_cvt_pk_bf16_f32 v92, v56, v57
    v_cvt_pk_bf16_f32 v93, v58, v59
    v_cvt_pk_bf16_f32 v94, v60, v61
    s_waitcnt vmcnt(6)
    s_nop 0
    ds_read_b64_tr_b16 a[16:17], v117 offset:4096
    ds_read_b64_tr_b16 a[18:19], v117 offset:4608
    ds_read_b64_tr_b16 a[20:21], v118 offset:4096
    ds_read_b64_tr_b16 a[22:23], v118 offset:4608
    ds_read_b64_tr_b16 a[24:25], v117 offset:6144
    ds_read_b64_tr_b16 a[26:27], v117 offset:6656
    ds_read_b64_tr_b16 a[28:29], v118 offset:6144
    ds_read_b64_tr_b16 a[30:31], v118 offset:6656
    ds_read_b64_tr_b16 a[32:33], v117 offset:20480
    ds_read_b64_tr_b16 a[34:35], v117 offset:20992
    ds_read_b64_tr_b16 a[36:37], v118 offset:20480
    ds_read_b64_tr_b16 a[38:39], v118 offset:20992
    ds_read_b64_tr_b16 a[40:41], v117 offset:22528
    ds_read_b64_tr_b16 a[42:43], v117 offset:23040
    ds_read_b64_tr_b16 a[44:45], v118 offset:22528
    ds_read_b64_tr_b16 a[46:47], v118 offset:23040
    ds_read_b64_tr_b16 a[48:49], v117 offset:8192
    ds_read_b64_tr_b16 a[50:51], v117 offset:8704
    ds_read_b64_tr_b16 a[52:53], v118 offset:8192
    ds_read_b64_tr_b16 a[54:55], v118 offset:8704
    ds_read_b64_tr_b16 a[56:57], v117 offset:10240
    ds_read_b64_tr_b16 a[58:59], v117 offset:10752
    ds_read_b64_tr_b16 a[60:61], v118 offset:10240
    ds_read_b64_tr_b16 a[62:63], v118 offset:10752
    ds_read_b64_tr_b16 a[64:65], v117 offset:12288
    ds_read_b64_tr_b16 a[66:67], v117 offset:12800
    ds_read_b64_tr_b16 a[68:69], v118 offset:12288
    ds_read_b64_tr_b16 a[70:71], v118 offset:12800
    ds_read_b64_tr_b16 a[72:73], v117 offset:14336
    ds_read_b64_tr_b16 a[74:75], v117 offset:14848
    ds_read_b64_tr_b16 a[76:77], v118 offset:14336
    ds_read_b64_tr_b16 a[78:79], v118 offset:14848
    ds_read_b64_tr_b16 a[80:81], v117 offset:16384
    ds_read_b64_tr_b16 a[82:83], v117 offset:16896
    ds_read_b64_tr_b16 a[84:85], v118 offset:16384
    ds_read_b64_tr_b16 a[86:87], v118 offset:16896
    ds_read_b64_tr_b16 a[88:89], v117 offset:18432
    ds_read_b64_tr_b16 a[90:91], v117 offset:18944
    ds_read_b64_tr_b16 a[92:93], v118 offset:18432
    ds_read_b64_tr_b16 a[94:95], v118 offset:18944
    ds_read_b64_tr_b16 a[96:97], v117 offset:0
    ds_read_b64_tr_b16 a[98:99], v117 offset:512
    ds_read_b64_tr_b16 a[100:101], v118 offset:0
    ds_read_b64_tr_b16 a[102:103], v118 offset:512
    ds_read_b64_tr_b16 a[104:105], v117 offset:2048
    ds_read_b64_tr_b16 a[106:107], v117 offset:2560
    ds_read_b64_tr_b16 a[108:109], v118 offset:2048
    ds_read_b64_tr_b16 a[110:111], v118 offset:2560
    s_lshl_b32 s3, s26, 2
    s_add_u32 s3, s3, 160848
    v_mov_b32 v116, s3
    s_mov_b64 exec, 1
    s_waitcnt lgkmcnt(0)
    ds_write_b32 v116, v114
    s_mov_b64 exec, -1
    s_setprio 1
    s_mov_b32 s24, 0
L_kq_17:
    s_add_u32 s24, s24, 1
    s_cmp_gt_u32 s24, 200000
    s_cbranch_scc1 L_kq_17x
    s_load_dword s68, s[52:53], s39 glc
L_kq_17c:
    s_waitcnt lgkmcnt(0)
    s_cmp_lt_u32 s68, 8
    s_cbranch_scc1 L_kq_17
L_kq_17x:
    s_add_u32 s8, s38, 4096
    buffer_load_dwordx4 v[16:19], v112, s[52:55], s38 offen offset:0 sc1
    buffer_load_dwordx4 v[20:23], v112, s[52:55], s38 offen offset:1024 sc1
    buffer_load_dwordx4 v[24:27], v112, s[52:55], s38 offen offset:2048 sc1
    buffer_load_dwordx4 v[28:31], v112, s[52:55], s38 offen offset:3072 sc1
    buffer_load_dwordx4 v[32:35], v112, s[52:55], s8 offen offset:0 sc1
    buffer_load_dwordx4 v[36:39], v112, s[52:55], s8 offen offset:1024 sc1
    buffer_load_dwordx4 v[40:43], v112, s[52:55], s8 offen offset:2048 sc1
    buffer_load_dwordx4 v[44:47], v112, s[52:55], s8 offen offset:3072 sc1
    v_add_u32 v96, 155648, v112
    s_lshl_b32 s3, s26, 10
    v_add_u32 v97, s3, v96
    s_waitcnt vmcnt(7)
    v_lshlrev_b32 v0, 16, v16
    v_and_b32 v1, 0xffff0000, v16
    v_lshlrev_b32_e64 v2, 16, v17
    v_and_b32 v3, 0xffff0000, v17
    v_lshlrev_b32_e64 v4, 16, v18
    v_and_b32 v5, 0xffff0000, v18
    v_lshlrev_b32_e64 v6, 16, v19
    v_and_b32 v7, 0xffff0000, v19
    s_waitcnt vmcnt(6)
    v_lshlrev_b32 v8, 16, v20
    v_and_b32 v20, 0xffff0000, v20
    v_lshlrev_b32_e64 v9, 16, v21
    v_and_b32 v21, 0xffff0000, v21
    v_lshlrev_b32_e64 v10, 16, v22
    v_and_b32 v22, 0xffff0000, v22
    v_lshlrev_b32_e64 v11, 16, v23
    v_and_b32 v23, 0xffff0000, v23
    v_add_f32 v0, v0, v8
    v_add_f32 v1, v1, v20
    v_add_f32 v2, v2, v9
    v_add_f32 v3, v3, v21
    v_add_f32 v4, v4, v10
    v_add_f32 v5, v5, v22
    v_add_f32 v6, v6, v11
    v_add_f32 v7, v7, v23
    s_waitcnt vmcnt(5)
    v_lshlrev_b32 v8, 16, v24
    v_and_b32 v24, 0xffff0000, v24
    v_lshlrev_b32_e64 v9, 16, v25
    v_and_b32 v25, 0xffff0000, v25
    v_lshlrev_b32_e64 v10, 16, v26
    v_and_b32 v26, 0xffff0000, v26
    v_lshlrev_b32_e64 v11, 16, v27
    v_and_b32 v27, 0xffff0000, v27
    v_add_f32 v0, v0, v8
    v_add_f32 v1, v1, v24
    v_add_f32 v2, v2, v9
    v_add_f32 v3, v3, v25
    v_add_f32 v4, v4, v10
    v_add_f32 v5, v5, v26
    v_add_f32 v6, v6, v11
    v_add_f32 v7, v7, v27
    s_waitcnt vmcnt(4)
    v_lshlrev_b32 v8, 16, v28
    v_and_b32 v28, 0xffff0000, v28
    v_lshlrev_b32_e64 v9, 16, v29
    v_and_b32 v29, 0xffff0000, v29
    v_lshlrev_b32_e64 v10, 16, v30
    v_and_b32 v30, 0xffff0000, v30
    v_lshlrev_b32_e64 v11, 16, v31
    v_and_b32 v31, 0xffff0000, v31
    v_add_f32 v0, v0, v8
    v_add_f32 v1, v1, v28
    v_add_f32 v2, v2, v9
    v_add_f32 v3, v3, v29
    v_add_f32 v4, v4, v10
    v_add_f32 v5, v5, v30
    v_add_f32 v6, v6, v11
    v_add_f32 v7, v7, v31
    s_waitcnt vmcnt(3)
    v_lshlrev_b32 v8, 16, v32
    v_and_b32 v32, 0xffff0000, v32
    v_lshlrev_b32_e64 v9, 16, v33
    v_and_b32 v33, 0xffff0000, v33
    v_lshlrev_b32_e64 v10, 16, v34
    v_and_b32 v34, 0xffff0000, v34
    v_lshlrev_b32_e64 v11, 16, v35
    v_and_b32 v35, 0xffff0000, v35
    v_add_f32 v0, v0, v8
    v_add_f32 v1, v1, v32
    v_add_f32 v2, v2, v9
    v_add_f32 v3, v3, v33
    v_add_f32 v4, v4, v10
    v_add_f32 v5, v5, v34
    v_add_f32 v6, v6, v11
    v_add_f32 v7, v7, v35
    s_waitcnt vmcnt(2)
    v_lshlrev_b32 v8, 16, v36
    v_and_b32 v36, 0xffff0000, v36
    v_lshlrev_b32_e64 v9, 16, v37
    v_and_b32 v37, 0xffff0000, v37
    v_lshlrev_b32_e64 v10, 16, v38
    v_and_b32 v38, 0xffff0000, v38
    v_lshlrev_b32_e64 v11, 16, v39
    v_and_b32 v39, 0xffff0000, v39
    v_add_f32 v0, v0, v8
    v_add_f32 v1, v1, v36
    v_add_f32 v2, v2, v9
    v_add_f32 v3, v3, v37
    v_add_f32 v4, v4, v10
    v_add_f32 v5, v5, v38
    v_add_f32 v6, v6, v11
    v_add_f32 v7, v7, v39
    s_waitcnt vmcnt(1)
    v_lshlrev_b32 v8, 16, v40
    v_and_b32 v40, 0xffff0000, v40
    v_lshlrev_b32_e64 v9, 16, v41
    v_and_b32 v41, 0xffff0000, v41
    v_lshlrev_b32_e64 v10, 16, v42
    v_and_b32 v42, 0xffff0000, v42
    v_lshlrev_b32_e64 v11, 16, v43
    v_and_b32 v43, 0xffff0000, v43
    v_add_f32 v0, v0, v8
    v_add_f32 v1, v1, v40
    v_add_f32 v2, v2, v9
    v_add_f32 v3, v3, v41
    v_add_f32 v4, v4, v10
    v_add_f32 v5, v5, v42
    v_add_f32 v6, v6, v11
    v_add_f32 v7, v7, v43
    s_waitcnt vmcnt(0)
    v_lshlrev_b32 v8, 16, v44
    v_and_b32 v44, 0xffff0000, v44
    v_lshlrev_b32_e64 v9, 16, v45
    v_and_b32 v45, 0xffff0000, v45
    v_lshlrev_b32_e64 v10, 16, v46
    v_and_b32 v46, 0xffff0000, v46
    v_lshlrev_b32_e64 v11, 16, v47
    v_and_b32 v47, 0xffff0000, v47
    v_add_f32 v0, v0, v8
    v_add_f32 v1, v1, v44
    v_add_f32 v2, v2, v9
    v_add_f32 v3, v3, v45
    v_add_f32 v4, v4, v10
    v_add_f32 v5, v5, v46
    v_add_f32 v6, v6, v11
    v_add_f32 v7, v7, v47
    v_cvt_pk_bf16_f32 v8, v0, v1
    v_cvt_pk_bf16_f32 v9, v2, v3
    v_cvt_pk_bf16_f32 v10, v4, v5
    v_cvt_pk_bf16_f32 v11, v6, v7
    ds_write_b128 v97, v[8:11]
    s_lshl_b32 s3, s26, 2
    s_add_u32 s3, s3, 160768
    v_mov_b32 v116, s3
    s_mov_b64 exec, 1
    s_waitcnt lgkmcnt(0)
    ds_write_b32 v116, v114
    s_mov_b64 exec, -1
    v_mov_b32 v116, 160768
L_sy_18:
    ds_read_b128 v[12:15], v116
    s_waitcnt lgkmcnt(0)
    v_min3_u32 v12, v12, v13, v14
    v_min_u32_e64 v12, v12, v15
    v_cmp_eq_u32 vcc, 0, v12
    s_cbranch_vccnz L_sy_18
    ds_read_b128 v[16:19], v96 offset:0
    ds_read_b128 v[20:23], v96 offset:1024
    ds_read_b128 v[24:27], v96 offset:2048
    ds_read_b128 v[28:31], v96 offset:3072
    s_waitcnt lgkmcnt(0)
    s_add_u32 s3, s34, 0
    s_load_dword s69, s[52:53], s3 glc
    s_add_u32 s3, s34, 128
    s_load_dword s70, s[52:53], s3 glc
    v_mfma_f32_32x32x16_bf16 v[32:47], v[16:19], v[64:67], 0
    v_mfma_f32_32x32x16_bf16 v[32:47], v[20:23], v[68:71], v[32:47]
    v_mfma_f32_32x32x16_bf16 v[32:47], v[24:27], v[72:75], v[32:47]
    v_mfma_f32_32x32x16_bf16 v[32:47], v[28:31], v[76:79], v[32:47]
    v_mfma_f32_32x32x16_bf16 v[48:63], v[16:19], v[80:83], 0
    v_mfma_f32_32x32x16_bf16 v[48:63], v[20:23], v[84:87], v[48:63]
    v_mfma_f32_32x32x16_bf16 v[48:63], v[24:27], v[88:91], v[48:63]
    v_mfma_f32_32x32x16_bf16 v[48:63], v[28:31], v[92:95], v[48:63]
    s_nop 7
    v_mov_b32 v136, v44
    v_mov_b32_e64 v137, v44
    v_cndmask_b32 v44, v44, 0, s[18:19]
    s_nop 0
    v_permlane32_swap_b32 v136, v137
    v_add_f32 v136, 0x358637bd, v137
    v_rcp_f32 v136, v136
    s_nop 0
    v_mul_f32 v32, v32, v136
    v_mul_f32 v33, v33, v136
    v_mul_f32 v34, v34, v136
    v_mul_f32 v35, v35, v136
    v_mul_f32 v36, v36, v136
    v_mul_f32 v37, v37, v136
    v_mul_f32 v38, v38, v136
    v_mul_f32 v39, v39, v136
    v_mul_f32 v40, v40, v136
    v_mul_f32 v41, v41, v136
    v_mul_f32 v42, v42, v136
    v_mul_f32 v43, v43, v136
    v_mul_f32 v44, v44, v136
    v_mul_f32 v45, v45, v136
    v_mul_f32 v46, v46, v136
    v_mul_f32 v47, v47, v136
    v_cvt_pk_bf16_f32 v32, v32, v33
    v_cvt_pk_bf16_f32 v33, v34, v35
    v_cvt_pk_bf16_f32 v34, v36, v37
    v_cvt_pk_bf16_f32 v35, v38, v39
    v_cvt_pk_bf16_f32 v36, v40, v41
    v_cvt_pk_bf16_f32 v37, v42, v43
    v_cvt_pk_bf16_f32 v38, v44, v45
    v_cvt_pk_bf16_f32 v39, v46, v47
    buffer_store_dwordx4 v[32:35], v112, s[52:55], s1 offen offset:0 sc1
    buffer_store_dwordx4 v[36:39], v112, s[52:55], s1 offen offset:2048 sc1
    v_mov_b32 v136, v60
    v_mov_b32 v137, v60
    v_cndmask_b32 v60, v60, 0, s[18:19]
    s_nop 0
    v_permlane32_swap_b32 v136, v137
    v_add_f32 v136, 0x358637bd, v137
    v_rcp_f32 v136, v136
    s_nop 0
    v_mul_f32 v48, v48, v136
    v_mul_f32 v49, v49, v136
    v_mul_f32 v50, v50, v136
    v_mul_f32 v51, v51, v136
    v_mul_f32 v52, v52, v136
    v_mul_f32 v53, v53, v136
    v_mul_f32 v54, v54, v136
    v_mul_f32 v55, v55, v136
    v_mul_f32 v56, v56, v136
    v_mul_f32 v57, v57, v136
    v_mul_f32 v58, v58, v136
    v_mul_f32 v59, v59, v136
    v_mul_f32 v60, v60, v136
    v_mul_f32 v61, v61, v136
    v_mul_f32 v62, v62, v136
    v_mul_f32 v63, v63, v136
    v_cvt_pk_bf16_f32 v48, v48, v49
    v_cvt_pk_bf16_f32 v49, v50, v51
    v_cvt_pk_bf16_f32 v50, v52, v53
    v_cvt_pk_bf16_f32 v51, v54, v55
    v_cvt_pk_bf16_f32 v52, v56, v57
    v_cvt_pk_bf16_f32 v53, v58, v59
    v_cvt_pk_bf16_f32 v54, v60, v61
    v_cvt_pk_bf16_f32 v55, v62, v63
    buffer_store_dwordx4 v[48:51], v112, s[52:55], s1 offen offset:1024 sc1
    buffer_store_dwordx4 v[52:55], v112, s[52:55], s1 offen offset:3072 sc1
    s_setprio 0
    s_cmp_eq_u32 s21, 7
    s_cbranch_scc1 L_os_19
    s_waitcnt lgkmcnt(0)
    s_cmp_lt_u32 s69, 8
    s_cbranch_scc1 L_os_19
    s_cmp_lt_u32 s70, 4
    s_cbranch_scc1 L_os_19
    s_bfe_u32 s36, s43, 0x40000
    s_lshl_b32 s36, s36, 12
    s_add_u32 s36, s36, s33
    buffer_load_dwordx4 v[64:67], v112, s[52:55], s36 offen offset:0 sc1
    buffer_load_dwordx4 v[68:71], v112, s[52:55], s36 offen offset:1024 sc1
    buffer_load_dwordx4 v[72:75], v112, s[52:55], s36 offen offset:2048 sc1
    buffer_load_dwordx4 v[76:79], v112, s[52:55], s36 offen offset:3072 sc1
    s_bfe_u32 s36, s43, 0x40004
    s_lshl_b32 s36, s36, 12
    s_add_u32 s36, s36, s33
    buffer_load_dwordx4 v[80:83], v112, s[52:55], s36 offen offset:0 sc1
    buffer_load_dwordx4 v[84:87], v112, s[52:55], s36 offen offset:1024 sc1
    buffer_load_dwordx4 v[88:91], v112, s[52:55], s36 offen offset:2048 sc1
    buffer_load_dwordx4 v[92:95], v112, s[52:55], s36 offen offset:3072 sc1
    s_waitcnt vmcnt(8)
    s_mov_b32 s42, 1
    s_atomic_add s42, s[52:53], s17
    s_branch L_tailS
L_os_19:
    s_waitcnt vmcnt(0)
    s_mov_b32 s42, 1
    s_atomic_add s42, s[52:53], s17
    s_cmp_eq_u32 s21, 7
    s_cbranch_scc1 L_endS
    s_branch L_waitS
L_waitS:
    s_add_u32 s3, s34, 0
    s_load_dword s69, s[52:53], s3 glc
    s_mov_b32 s24, 0
L_hS_20:
    s_add_u32 s24, s24, 1
    s_cmp_gt_u32 s24, 200000
    s_cbranch_scc1 L_hS_20x
    s_add_u32 s3, s34, 128
    s_load_dword s68, s[52:53], s3 glc
L_hS_20c:
    s_waitcnt lgkmcnt(0)
    s_cmp_lt_u32 s68, 4
    s_cbranch_scc1 L_hS_20
L_hS_20x:
    s_mov_b32 s68, s69
    s_mov_b32 s24, 0
    s_branch L_hP_21c
L_hP_21:
    s_add_u32 s24, s24, 1
    s_cmp_gt_u32 s24, 200000
    s_cbranch_scc1 L_hP_21x
    s_add_u32 s3, s34, 0
    s_load_dword s68, s[52:53], s3 glc
L_hP_21c:
    s_waitcnt lgkmcnt(0)
    s_cmp_lt_u32 s68, 8
    s_cbranch_scc1 L_hP_21
L_hP_21x:
    s_bfe_u32 s36, s43, 0x40000
    s_lshl_b32 s36, s36, 12
    s_add_u32 s36, s36, s33
    buffer_load_dwordx4 v[64:67], v112, s[52:55], s36 offen offset:0 sc1
    buffer_load_dwordx4 v[68:71], v112, s[52:55], s36 offen offset:1024 sc1
    buffer_load_dwordx4 v[72:75], v112, s[52:55], s36 offen offset:2048 sc1
    buffer_load_dwordx4 v[76:79], v112, s[52:55], s36 offen offset:3072 sc1
    s_bfe_u32 s36, s43, 0x40004
    s_lshl_b32 s36, s36, 12
    s_add_u32 s36, s36, s33
    buffer_load_dwordx4 v[80:83], v112, s[52:55], s36 offen offset:0 sc1
    buffer_load_dwordx4 v[84:87], v112, s[52:55], s36 offen offset:1024 sc1
    buffer_load_dwordx4 v[88:91], v112, s[52:55], s36 offen offset:2048 sc1
    buffer_load_dwordx4 v[92:95], v112, s[52:55], s36 offen offset:3072 sc1
L_tailS:
    v_bfe_u32 v119, v112, 4, 5
    v_lshrrev_b32 v120, 9, v112
    v_and_b32 v121, 7, v119
    v_xor_b32 v120, v120, v121
    v_lshlrev_b32 v119, 8, v119
    v_lshl_add_u32 v119, v120, 4, v119
    v_add_u32 v128, s10, v119
    v_xor_b32 v129, 32, v128
    v_xor_b32_e64 v130, 64, v128
    v_xor_b32 v131, 96, v128
    s_sub_u32 s3, s40, s10
    v_add_u32 v124, s3, v117
    v_add_u32 v125, s3, v118
    v_add_u32 v132, s3, v128
    v_add_u32 v133, s3, v129
    v_add_u32 v134, s3, v130
    v_add_u32_e64 v135, s3, v131
    v_and_b32 v119, 0x200, v112
    v_sub_u32 v124, v124, v119
    v_sub_u32 v125, v125, v119
    v_sub_u32 v126, v124, v119
    v_sub_u32 v127, v125, v119
    s_waitcnt vmcnt(7) lgkmcnt(0)
    v_mfma_f32_32x32x16_bf16 v[0:15], a[0:3], v[64:67], 0
    s_bfe_u32 s36, s43, 0x40008
    s_lshl_b32 s36, s36, 12
    s_add_u32 s36, s36, s33
    buffer_load_dwordx4 v[96:99], v112, s[52:55], s36 offen offset:0 sc1
    v_mfma_f32_32x32x16_bf16 v[32:47], a[4:7], v[64:67], 0
    s_waitcnt vmcnt(7)
    v_mfma_f32_32x32x16_bf16 v[16:31], a[0:3], v[68:71], 0
    buffer_load_dwordx4 v[100:103], v112, s[52:55], s36 offen offset:1024 sc1
    v_mfma_f32_32x32x16_bf16 v[48:63], a[4:7], v[68:71], 0
    s_waitcnt vmcnt(7)
    v_mfma_f32_32x32x16_bf16 v[0:15], a[8:11], v[72:75], v[0:15]
    buffer_load_dwordx4 v[104:107], v112, s[52:55], s36 offen offset:2048 sc1
    v_mfma_f32_32x32x16_bf16 v[32:47], a[12:15], v[72:75], v[32:47]
    s_waitcnt vmcnt(7)
    v_mfma_f32_32x32x16_bf16 v[16:31], a[8:11], v[76:79], v[16:31]
    buffer_load_dwordx4 v[108:111], v112, s[52:55], s36 offen offset:3072 sc1
    v_mfma_f32_32x32x16_bf16 v[48:63], a[12:15], v[76:79], v[48:63]
    s_waitcnt vmcnt(7)
    v_mfma_f32_32x32x16_bf16 v[0:15], a[16:19], v[80:83], v[0:15]
    s_bfe_u32 s36, s43, 0x4000c
    s_lshl_b32 s36, s36, 12
    s_add_u32 s36, s36, s33
    buffer_load_dwordx4 v[64:67], v112, s[52:55], s36 offen offset:0 sc1
    v_mfma_f32_32x32x16_bf16 v[32:47], a[20:23], v[80:83], v[32:47]
    s_waitcnt vmcnt(7)
    v_mfma_f32_32x32x16_bf16 v[16:31], a[16:19], v[84:87], v[16:31]
    buffer_load_dwordx4 v[68:71], v112, s[52:55], s36 offen offset:1024 sc1
    v_mfma_f32_32x32x16_bf16 v[48:63], a[20:23], v[84:87], v[48:63]
    s_waitcnt vmcnt(7)
    v_mfma_f32_32x32x16_bf16 v[0:15], a[24:27], v[88:91], v[0:15]
    buffer_load_dwordx4 v[72:75], v112, s[52:55], s36 offen offset:2048 sc1
    v_mfma_f32_32x32x16_bf16 v[32:47], a[28:31], v[88:91], v[32:47]
    s_waitcnt vmcnt(7)
    v_mfma_f32_32x32x16_bf16 v[16:31], a[24:27], v[92:95], v[16:31]
    buffer_load_dwordx4 v[76:79], v112, s[52:55], s36 offen offset:3072 sc1
    v_mfma_f32_32x32x16_bf16 v[48:63], a[28:31], v[92:95], v[48:63]
    s_waitcnt vmcnt(7)
    v_mfma_f32_32x32x16_bf16 v[0:15], a[32:35], v[96:99], v[0:15]
    s_bfe_u32 s36, s43, 0x40010
    s_lshl_b32 s36, s36, 12
    s_add_u32 s36, s36, s33
    buffer_load_dwordx4 v[80:83], v112, s[52:55], s36 offen offset:0 sc1
    v_mfma_f32_32x32x16_bf16 v[32:47], a[36:39], v[96:99], v[32:47]
    s_waitcnt vmcnt(7)
    v_mfma_f32_32x32x16_bf16 v[16:31], a[32:35], v[100:103], v[16:31]
    buffer_load_dwordx4 v[84:87], v112, s[52:55], s36 offen offset:1024 sc1
    v_mfma_f32_32x32x16_bf16 v[48:63], a[36:39], v[100:103], v[48:63]
    s_waitcnt vmcnt(7)
    v_mfma_f32_32x32x16_bf16 v[0:15], a[40:43], v[104:107], v[0:15]
    buffer_load_dwordx4 v[88:91], v112, s[52:55], s36 offen offset:2048 sc1
    v_mfma_f32_32x32x16_bf16 v[32:47], a[44:47], v[104:107], v[32:47]
    s_waitcnt vmcnt(7)
    v_mfma_f32_32x32x16_bf16 v[16:31], a[40:43], v[108:111], v[16:31]
    buffer_load_dwordx4 v[92:95], v112, s[52:55], s36 offen offset:3072 sc1
    v_mfma_f32_32x32x16_bf16 v[48:63], a[44:47], v[108:111], v[48:63]
    s_waitcnt vmcnt(7)
    v_mfma_f32_32x32x16_bf16 v[0:15], a[48:51], v[64:67], v[0:15]
    s_bfe_u32 s36, s43, 0x40014
    s_lshl_b32 s36, s36, 12
    s_add_u32 s36, s36, s33
    buffer_load_dwordx4 v[96:99], v112, s[52:55], s36 offen offset:0 sc1
    v_mfma_f32_32x32x16_bf16 v[32:47], a[52:55], v[64:67], v[32:47]
    s_waitcnt vmcnt(7)
    v_mfma_f32_32x32x16_bf16 v[16:31], a[48:51], v[68:71], v[16:31]
    buffer_load_dwordx4 v[100:103], v112, s[52:55], s36 offen offset:1024 sc1
    v_mfma_f32_32x32x16_bf16 v[48:63], a[52:55], v[68:71], v[48:63]
    s_waitcnt vmcnt(7)
    v_mfma_f32_32x32x16_bf16 v[0:15], a[56:59], v[72:75], v[0:15]
    s_add_u32 s3, s34, 256
    s_load_dword s68, s[52:53], s3 glc
    buffer_load_dwordx4 v[104:107], v112, s[52:55], s36 offen offset:2048 sc1
    v_mfma_f32_32x32x16_bf16 v[32:47], a[60:63], v[72:75], v[32:47]
    s_waitcnt vmcnt(7)
    v_mfma_f32_32x32x16_bf16 v[16:31], a[56:59], v[76:79], v[16:31]
    buffer_load_dwordx4 v[108:111], v112, s[52:55], s36 offen offset:3072 sc1
    v_mfma_f32_32x32x16_bf16 v[48:63], a[60:63], v[76:79], v[48:63]
    s_waitcnt vmcnt(7)
    v_mfma_f32_32x32x16_bf16 v[0:15], a[64:67], v[80:83], v[0:15]
    s_bfe_u32 s36, s43, 0x40018
    s_lshl_b32 s36, s36, 12
    s_add_u32 s36, s36, s33
    buffer_load_dwordx4 v[64:67], v112, s[52:55], s36 offen offset:0 sc1
    v_mfma_f32_32x32x16_bf16 v[32:47], a[68:71], v[80:83], v[32:47]
    s_waitcnt vmcnt(7)
    v_mfma_f32_32x32x16_bf16 v[16:31], a[64:67], v[84:87], v[16:31]
    buffer_load_dwordx4 v[68:71], v112, s[52:55], s36 offen offset:1024 sc1
    ds_read_b64_tr_b16 a[0:1], v124 offset:0
    ds_read_b64_tr_b16 a[2:3], v124 offset:1024
    ds_read_b64_tr_b16 a[4:5], v125 offset:0
    ds_read_b64_tr_b16 a[6:7], v125 offset:1024
    v_mfma_f32_32x32x16_bf16 v[48:63], a[68:71], v[84:87], v[48:63]
    s_waitcnt vmcnt(7)
    v_mfma_f32_32x32x16_bf16 v[0:15], a[72:75], v[88:91], v[0:15]
    buffer_load_dwordx4 v[72:75], v112, s[52:55], s36 offen offset:2048 sc1
    ds_read_b64_tr_b16 a[8:9], v124 offset:2048
    ds_read_b64_tr_b16 a[10:11], v126 offset:3072
    ds_read_b64_tr_b16 a[12:13], v125 offset:2048
    ds_read_b64_tr_b16 a[14:15], v127 offset:3072
    v_mfma_f32_32x32x16_bf16 v[32:47], a[76:79], v[88:91], v[32:47]
    s_waitcnt vmcnt(7)
    v_mfma_f32_32x32x16_bf16 v[16:31], a[72:75], v[92:95], v[16:31]
    buffer_load_dwordx4 v[76:79], v112, s[52:55], s36 offen offset:3072 sc1
    ds_read_b64_tr_b16 a[16:17], v124 offset:3584
    ds_read_b64_tr_b16 a[18:19], v124 offset:4608
    ds_read_b64_tr_b16 a[20:21], v125 offset:3584
    ds_read_b64_tr_b16 a[22:23], v125 offset:4608
    v_mfma_f32_32x32x16_bf16 v[48:63], a[76:79], v[92:95], v[48:63]
    s_waitcnt vmcnt(7)
    v_mfma_f32_32x32x16_bf16 v[0:15], a[80:83], v[96:99], v[0:15]
    s_mov_b32 s24, 0
    s_branch L_go_22c
L_go_22:
    s_add_u32 s24, s24, 1
    s_cmp_gt_u32 s24, 200000
    s_cbranch_scc1 L_go_22x
    s_add_u32 s3, s34, 256
    s_load_dword s68, s[52:53], s3 glc
L_go_22c:
    s_waitcnt lgkmcnt(0)
    s_cmp_lt_u32 s68, 4
    s_cbranch_scc1 L_go_22
L_go_22x:
    s_mov_b32 s36, s37
    buffer_load_dwordx4 v[80:83], v112, s[52:55], s36 offen offset:0 sc1
    ds_read_b64_tr_b16 a[24:25], v124 offset:5632
    ds_read_b64_tr_b16 a[26:27], v126 offset:6656
    ds_read_b64_tr_b16 a[28:29], v125 offset:5632
    ds_read_b64_tr_b16 a[30:31], v127 offset:6656
    v_mfma_f32_32x32x16_bf16 v[32:47], a[84:87], v[96:99], v[32:47]
    s_waitcnt vmcnt(7)
    v_mfma_f32_32x32x16_bf16 v[16:31], a[80:83], v[100:103], v[16:31]
    buffer_load_dwordx4 v[84:87], v112, s[52:55], s36 offen offset:2048 sc1
    ds_read_b64_tr_b16 a[32:33], v124 offset:7168
    ds_read_b64_tr_b16 a[34:35], v124 offset:8192
    ds_read_b64_tr_b16 a[36:37], v125 offset:7168
    ds_read_b64_tr_b16 a[38:39], v125 offset:8192
    v_mfma_f32_32x32x16_bf16 v[48:63], a[84:87], v[100:103], v[48:63]
    s_waitcnt vmcnt(7)
    s_nop 0
    v_mfma_f32_32x32x16_bf16 v[0:15], a[88:91], v[104:107], v[0:15]
    s_add_u32 s36, s36, 4096
    buffer_load_dwordx4 v[88:91], v112, s[52:55], s36 offen offset:0 sc1
    ds_read_b64_tr_b16 a[40:41], v124 offset:9216
    ds_read_b64_tr_b16 a[42:43], v126 offset:10240
    ds_read_b64_tr_b16 a[44:45], v125 offset:9216
    ds_read_b64_tr_b16 a[46:47], v127 offset:10240
    v_mfma_f32_32x32x16_bf16 v[32:47], a[92:95], v[104:107], v[32:47]
    s_waitcnt vmcnt(7)
    v_mfma_f32_32x32x16_bf16 v[16:31], a[88:91], v[108:111], v[16:31]
    buffer_load_dwordx4 v[92:95], v112, s[52:55], s36 offen offset:2048 sc1
    ds_read_b64_tr_b16 a[48:49], v124 offset:10752
    ds_read_b64_tr_b16 a[50:51], v124 offset:11776
    ds_read_b64_tr_b16 a[52:53], v125 offset:10752
    ds_read_b64_tr_b16 a[54:55], v125 offset:11776
    v_mfma_f32_32x32x16_bf16 v[48:63], a[92:95], v[108:111], v[48:63]
    s_waitcnt vmcnt(7)
    v_mfma_f32_32x32x16_bf16 v[0:15], a[96:99], v[64:67], v[0:15]
    s_add_u32 s36, s36, 4096
    buffer_load_dwordx4 v[96:99], v112, s[52:55], s36 offen offset:0 sc1
    ds_read_b64_tr_b16 a[56:57], v124 offset:12800
    ds_read_b64_tr_b16 a[58:59], v126 offset:13824
    ds_read_b64_tr_b16 a[60:61], v125 offset:12800
    ds_read_b64_tr_b16 a[62:63], v127 offset:13824
    v_mfma_f32_32x32x16_bf16 v[32:47], a[100:103], v[64:67], v[32:47]
    s_waitcnt vmcnt(7)
    v_mfma_f32_32x32x16_bf16 v[16:31], a[96:99], v[68:71], v[16:31]
    buffer_load_dwordx4 v[100:103], v112, s[52:55], s36 offen offset:2048 sc1
    v_mfma_f32_32x32x16_bf16 v[48:63], a[100:103], v[68:71], v[48:63]
    s_waitcnt vmcnt(7)
    v_mfma_f32_32x32x16_bf16 v[0:15], a[104:107], v[72:75], v[0:15]
    s_add_u32 s36, s36, 4096
    buffer_load_dwordx4 v[104:107], v112, s[52:55], s36 offen offset:0 sc1
    v_mfma_f32_32x32x16_bf16 v[32:47], a[108:111], v[72:75], v[32:47]
    s_waitcnt vmcnt(7)
    s_nop 0
    v_mfma_f32_32x32x16_bf16 v[16:31], a[104:107], v[76:79], v[16:31]
    buffer_load_dwordx4 v[108:111], v112, s[52:55], s36 offen offset:2048 sc1
    v_mfma_f32_32x32x16_bf16 v[48:63], a[108:111], v[76:79], v[48:63]
    s_waitcnt vmcnt(7) lgkmcnt(0)
    v_mfma_f32_32x32x16_bf16 v[0:15], a[0:3], v[80:83], v[0:15]
    s_mov_b32 s36, s37
    buffer_load_dwordx4 v[64:67], v112, s[52:55], s36 offen offset:1024 sc1
    v_mfma_f32_32x32x16_bf16 v[32:47], a[4:7], v[80:83], v[32:47]
    s_waitcnt vmcnt(7)
    v_mfma_f32_32x32x16_bf16 v[0:15], a[8:11], v[84:87], v[0:15]
    buffer_load_dwordx4 v[68:71], v112, s[52:55], s36 offen offset:3072 sc1
    v_mfma_f32_32x32x16_bf16 v[32:47], a[12:15], v[84:87], v[32:47]
    s_waitcnt vmcnt(7)
    v_mfma_f32_32x32x16_bf16 v[0:15], a[16:19], v[88:91], v[0:15]
    s_add_u32 s36, s36, 4096
    buffer_load_dwordx4 v[72:75], v112, s[52:55], s36 offen offset:1024 sc1
    v_mfma_f32_32x32x16_bf16 v[32:47], a[20:23], v[88:91], v[32:47]
    s_waitcnt vmcnt(7)
    v_mfma_f32_32x32x16_bf16 v[0:15], a[24:27], v[92:95], v[0:15]
    buffer_load_dwordx4 v[76:79], v112, s[52:55], s36 offen offset:3072 sc1
    v_mfma_f32_32x32x16_bf16 v[32:47], a[28:31], v[92:95], v[32:47]
    s_waitcnt vmcnt(7)
    v_mfma_f32_32x32x16_bf16 v[0:15], a[32:35], v[96:99], v[0:15]
    s_add_u32 s36, s36, 4096
    buffer_load_dwordx4 v[80:83], v112, s[52:55], s36 offen offset:1024 sc1
    v_mfma_f32_32x32x16_bf16 v[32:47], a[36:39], v[96:99], v[32:47]
    s_waitcnt vmcnt(7)
    v_mfma_f32_32x32x16_bf16 v[0:15], a[40:43], v[100:103], v[0:15]
    buffer_load_dwordx4 v[84:87], v112, s[52:55], s36 offen offset:3072 sc1
    v_mfma_f32_32x32x16_bf16 v[32:47], a[44:47], v[100:103], v[32:47]
    s_waitcnt vmcnt(7)
    v_mfma_f32_32x32x16_bf16 v[0:15], a[48:51], v[104:107], v[0:15]
    s_add_u32 s36, s36, 4096
    buffer_load_dwordx4 v[88:91], v112, s[52:55], s36 offen offset:1024 sc1
    v_mfma_f32_32x32x16_bf16 v[32:47], a[52:55], v[104:107], v[32:47]
    s_waitcnt vmcnt(7)
    v_mfma_f32_32x32x16_bf16 v[0:15], a[56:59], v[108:111], v[0:15]
    buffer_load_dwordx4 v[92:95], v112, s[52:55], s36 offen offset:3072 sc1
    v_mfma_f32_32x32x16_bf16 v[32:47], a[60:63], v[108:111], v[32:47]
    s_waitcnt vmcnt(7)
    v_mfma_f32_32x32x16_bf16 v[16:31], a[0:3], v[64:67], v[16:31]
    s_nop 8
    ds_write_b128 v128, v[0:3] offset:0
    v_mfma_f32_32x32x16_bf16 v[48:63], a[4:7], v[64:67], v[48:63]
    ds_write_b128 v129, v[4:7] offset:0
    s_waitcnt vmcnt(6)
    v_mfma_f32_32x32x16_bf16 v[16:31], a[8:11], v[68:71], v[16:31]
    ds_write_b128 v130, v[8:11] offset:0
    v_mfma_f32_32x32x16_bf16 v[48:63], a[12:15], v[68:71], v[48:63]
    ds_write_b128 v131, v[12:15] offset:0
    s_waitcnt vmcnt(5)
    v_mfma_f32_32x32x16_bf16 v[16:31], a[16:19], v[72:75], v[16:31]
    ds_write_b128 v128, v[32:35] offset:128
    v_mfma_f32_32x32x16_bf16 v[48:63], a[20:23], v[72:75], v[48:63]
    ds_write_b128 v129, v[36:39] offset:128
    s_waitcnt vmcnt(4)
    v_mfma_f32_32x32x16_bf16 v[16:31], a[24:27], v[76:79], v[16:31]
    ds_write_b128 v130, v[40:43] offset:128
    v_mfma_f32_32x32x16_bf16 v[48:63], a[28:31], v[76:79], v[48:63]
    ds_write_b128 v131, v[44:47] offset:128
    s_waitcnt vmcnt(3)
    v_mfma_f32_32x32x16_bf16 v[16:31], a[32:35], v[80:83], v[16:31]
    s_waitcnt vmcnt(2)
    v_mfma_f32_32x32x16_bf16 v[16:31], a[40:43], v[84:87], v[16:31]
    s_waitcnt vmcnt(1)
    v_mfma_f32_32x32x16_bf16 v[16:31], a[48:51], v[88:91], v[16:31]
    s_waitcnt vmcnt(0)
    v_mfma_f32_32x32x16_bf16 v[16:31], a[56:59], v[92:95], v[16:31]
    s_waitcnt lgkmcnt(0)
    s_barrier
    v_mfma_f32_32x32x16_bf16 v[48:63], a[36:39], v[80:83], v[48:63]
    v_mfma_f32_32x32x16_bf16 v[48:63], a[44:47], v[84:87], v[48:63]
    v_mfma_f32_32x32x16_bf16 v[48:63], a[52:55], v[88:91], v[48:63]
    v_mfma_f32_32x32x16_bf16 v[48:63], a[60:63], v[92:95], v[48:63]
    s_nop 5
    ds_write_b128 v132, v[16:19] offset:0
    ds_write_b128 v133, v[20:23] offset:0
    ds_write_b128 v134, v[24:27] offset:0
    ds_write_b128 v135, v[28:31] offset:0
    s_nop 1
    ds_write_b128 v132, v[48:51] offset:128
    ds_write_b128 v133, v[52:55] offset:128
    ds_write_b128 v134, v[56:59] offset:128
    ds_write_b128 v135, v[60:63] offset:128
    s_waitcnt lgkmcnt(0)
    s_barrier
L_endS:
    s_endpgm
L_in_13f:
    s_mov_b32 s24, 0
L_in_13l:
    buffer_load_dword v115, v116, s[60:63], 0 offen sc1
    s_add_u32 s24, s24, 1
    s_waitcnt vmcnt(0)
    v_cmp_gt_u32 vcc, 16, v115
    s_and_b32 s3, vcc_lo, 3
    s_cbranch_scc0 L_in_13b
    s_cmp_lt_u32 s24, 200000
    s_cbranch_scc1 L_in_13l
    s_branch L_in_13b
L_sc_15f:
    s_mov_b32 s24, 0
    v_mov_b32_e64 v116, s6
    v_writelane_b32 v116, s14, 1
L_sc_15l:
    s_sleep 4
    s_mov_b64 exec, 3
    buffer_load_dword v115, v116, s[52:55], 0 offen sc1
    s_add_u32 s24, s24, 1
    s_waitcnt vmcnt(0)
    v_cmp_gt_u32 vcc, 8, v115
    s_mov_b64 exec, -1
    s_cbranch_vccz L_sc_15b
    s_cmp_lt_u32 s24, 200000
    s_cbranch_scc1 L_sc_15l
    s_branch L_sc_15b
L_codeend:
.section .rodata,"a"
.p2align 6
.amdhsa_kernel parallel_sum__linear_kernel_hedgehog__glu_gated_geglu__prompt_kernel
  .amdhsa_next_free_vgpr 256
  .amdhsa_next_free_sgpr 102
  .amdhsa_accum_offset 144
  .amdhsa_group_segment_fixed_size 0
  .amdhsa_kernarg_size 88
  .amdhsa_user_sgpr_count 2
  .amdhsa_user_sgpr_kernarg_segment_ptr 1
  .amdhsa_system_sgpr_workgroup_id_x 1
  .amdhsa_float_denorm_mode_32 3
.end_amdhsa_kernel
```
